```python
import torch

def _softmax(x, axis=-1):
    return torch.softmax(x, dim=axis)
def _gelu(x):
    return torch.nn.functional.gelu(x, approximate="tanh")
def _silu(x):
    return torch.nn.functional.silu(x)
def _sigmoid(x):
    return torch.sigmoid(x)
def _layernorm(x, axis=-1, eps=1e-5):
    m = x.mean(dim=axis, keepdim=True)
    v = x.var(dim=axis, keepdim=True, unbiased=False)
    return (x - m) / torch.sqrt(v + eps)
def _scatter_add(tgt, idx, src, axis=0):
    return tgt.clone().index_add_(axis, idx, src)
def _segment_sum(src, seg, n):
    out = torch.zeros((n,) + src.shape[1:], dtype=src.dtype)
    return out.index_add_(0, seg, src)
def _pad(x, pw):
    flat = tuple(v for pair in reversed(pw) for v in pair)
    return torch.nn.functional.pad(x, flat)

kernel_name = 'interleave_layers__sliding_local_dilated__sliding_local_dilated__prompt'

def setup_inputs():

    _w = (lambda a: (lambda t: t.to(torch.bfloat16) if t.is_floating_point() else t)(torch.as_tensor(a)))
    def _A_setup():
        B, S, D = 1, 2048, 1024
        return {
            "x": _w((lambda *s: torch.randn(*s, dtype=torch.bfloat16) * 0.05)(B, S, D)),
            "wqkv": _w((lambda *s: torch.randn(*s, dtype=torch.bfloat16) * 0.05)(D, 3 * D)),
            "wo": _w((lambda *s: torch.randn(*s, dtype=torch.bfloat16) * 0.05)(D, D)),
        }
    _A_in = _A_setup()

    def _B_setup():
        B, S, D = 1, 2048, 1024
        return {
            "x": _w((lambda *s: torch.randn(*s, dtype=torch.bfloat16) * 0.05)(B, S, D)),
            "wqkv": _w((lambda *s: torch.randn(*s, dtype=torch.bfloat16) * 0.05)(D, 3 * D)),
            "wo": _w((lambda *s: torch.randn(*s, dtype=torch.bfloat16) * 0.05)(D, D)),
        }
    _B_in = _B_setup()

    return {
        "A_x": _A_in["x"],
        "A_wqkv": _A_in["wqkv"],
        "A_wo": _A_in["wo"],
        "B_x": _B_in["x"],
        "B_wqkv": _B_in["wqkv"],
        "B_wo": _B_in["wo"],
    }

def reference(A_x, A_wqkv, A_wo, B_x, B_wqkv, B_wo):
    def _A_ref(x, wqkv, wo):
        B, S, D = x.shape
        H = 32; Dh = D // H
        W, dil = 8, 2
        qkv = (lambda x, *d: x.permute(*d))((x @ wqkv).reshape(B, S, 3, H, Dh), 2, 0, 3, 1, 4)
        q, k, v = qkv[0], qkv[1], qkv[2]
        scale = Dh ** -0.5
        pos = torch.arange(S)
        off = torch.arange(W) * dil
        idx = pos[:, None] - off[None, :]
        mask = idx >= 0
        idx_c = torch.where(mask, idx, 0).reshape(-1)
        kg = k[:, :, idx_c, :].reshape(B, H, S, W, Dh)
        vg = v[:, :, idx_c, :].reshape(B, H, S, W, Dh)
        logits = torch.einsum("bhsd,bhswd->bhsw", q, kg) * scale
        logits = torch.where(mask[None, None, :, :], logits, -1e9)
        attn = _softmax(logits, axis=-1)
        o = torch.einsum("bhsw,bhswd->bhsd", attn, vg)
        return (lambda x, *d: x.permute(*d))(o, 0, 2, 1, 3).reshape(B, S, D) @ wo

    def _B_ref(x, wqkv, wo):
        B, S, D = x.shape
        H = 32; Dh = D // H
        W, dil = 8, 2
        qkv = (lambda x, *d: x.permute(*d))((x @ wqkv).reshape(B, S, 3, H, Dh), 2, 0, 3, 1, 4)
        q, k, v = qkv[0], qkv[1], qkv[2]
        scale = Dh ** -0.5
        pos = torch.arange(S)
        off = torch.arange(W) * dil
        idx = pos[:, None] - off[None, :]
        mask = idx >= 0
        idx_c = torch.where(mask, idx, 0).reshape(-1)
        kg = k[:, :, idx_c, :].reshape(B, H, S, W, Dh)
        vg = v[:, :, idx_c, :].reshape(B, H, S, W, Dh)
        logits = torch.einsum("bhsd,bhswd->bhsw", q, kg) * scale
        logits = torch.where(mask[None, None, :, :], logits, -1e9)
        attn = _softmax(logits, axis=-1)
        o = torch.einsum("bhsw,bhswd->bhsd", attn, vg)
        return (lambda x, *d: x.permute(*d))(o, 0, 2, 1, 3).reshape(B, S, D) @ wo

    x = A_x
    x = x + _A_ref(_layernorm(x, axis=-1), A_wqkv, A_wo)
    x = x + _B_ref(_layernorm(x, axis=-1), B_wqkv, B_wo)
    x = x + _A_ref(_layernorm(x, axis=-1), A_wqkv, A_wo)
    x = x + _B_ref(_layernorm(x, axis=-1), B_wqkv, B_wo)
    return x
```

```asm
; @launch grid=(256,1,1) block=(512,1,1) lds=162048
.amdgcn_target "amdgcn-amd-amdhsa--gfx950"
.text
.globl interleave_layers__sliding_local_dilated__sliding_local_dilated__prompt_kernel
.p2align 8
.type interleave_layers__sliding_local_dilated__sliding_local_dilated__prompt_kernel,@function
interleave_layers__sliding_local_dilated__sliding_local_dilated__prompt_kernel:
    s_cmp_ge_u32 s2, 256
    s_cbranch_scc1 k_done
    s_getpc_b64 s[98:99]
pc_base:
    s_lshr_b32 s3, s2, 3
    s_lshl_b32 s3, s3, 6
    v_lshrrev_b32 v255, 3, v0
    v_add_u32 v255, s3, v255
    v_lshlrev_b32 v255, 6, v255
    v_min_u32 v255, k_done-pc_base, v255
    v_add_co_u32 v254, vcc, s98, v255
    v_mov_b32 v255, s99
    s_nop 0
    v_addc_co_u32 v255, vcc, 0, v255, vcc
    global_load_dword v255, v[254:255], off
    s_load_dwordx2 s[16:17], s[0:1], 0
    s_load_dwordx2 s[28:29], s[0:1], 8
    s_load_dwordx2 s[32:33], s[0:1], 16
    s_load_dwordx2 s[30:31], s[0:1], 32
    s_load_dwordx2 s[34:35], s[0:1], 40
    s_load_dwordx2 s[20:21], s[0:1], 48
    s_load_dwordx2 s[24:25], s[0:1], 56
    s_load_dwordx2 s[4:5], s[0:1], 64
    s_and_b32 s45, s2, 7
    s_lshr_b32 s46, s2, 3
    s_and_b32 s36, s45, 3
    s_lshl_b32 s36, s36, 2
    s_and_b32 s47, s46, 3
    s_add_u32 s36, s36, s47
    s_lshr_b32 s37, s45, 2
    s_lshl_b32 s37, s37, 3
    s_lshr_b32 s47, s46, 2
    s_add_u32 s37, s37, s47
    s_and_b32 s38, s45, 3
    s_lshl_b32 s38, s38, 2
    s_and_b32 s47, s46, 3
    s_add_u32 s38, s38, s47
    s_lshr_b32 s39, s45, 2
    s_lshl_b32 s39, s39, 3
    s_lshr_b32 s47, s46, 2
    s_add_u32 s39, s39, s47
    v_lshrrev_b32 v1, 6, v0
    s_nop 0
    v_readfirstlane_b32 s40, v1
    s_nop 0
    s_lshr_b32 s41, s40, 1
    s_and_b32 s41, s41, 1
    s_mov_b32 s42, 0
    s_waitcnt lgkmcnt(0)
    s_and_b32 s5, s5, 0xffff
    s_mov_b32 s6, 67108864
    s_mov_b32 s7, 131072
    s_and_b32 s17, s17, 0xffff
    s_mov_b32 s18, 4194304
    s_mov_b32 s19, 131072
    s_and_b32 s21, s21, 0xffff
    s_mov_b32 s22, 4194304
    s_mov_b32 s23, 131072
    s_and_b32 s25, s25, 0xffff
    s_mov_b32 s26, 256
    s_mov_b32 s27, 131072
    s_and_b32 s29, s29, 0xffff
    s_and_b32 s31, s31, 0xffff
    s_and_b32 s33, s33, 0xffff
    s_and_b32 s35, s35, 0xffff
    s_mov_b32 s10, 6291456
    s_mov_b32 s11, 131072
    s_mov_b32 s14, 2097152
    s_mov_b32 s15, 131072
    s_bitcmp1_b32 s42, 0
    s_cselect_b32 s8, s30, s28
    s_cselect_b32 s9, s31, s29
    s_cselect_b32 s12, s34, s32
    s_cselect_b32 s13, s35, s33
    s_mov_b32 s45, 35684352
    s_load_dword s43, s[4:5], s45
    s_cmp_eq_u32 s40, 4
    s_cbranch_scc1 prod_w0
    s_cmp_eq_u32 s40, 5
    s_cbranch_scc1 prod_w1
    s_cmp_eq_u32 s40, 6
    s_cbranch_scc1 prod_w2
    s_cmp_eq_u32 s40, 7
    s_cbranch_scc1 prod_w3
    v_and_b32 v9, 63, v0
    v_and_b32 v233, 15, v9
    v_lshrrev_b32 v117, 4, v9
    v_and_b32 v118, 1, v117
    v_lshlrev_b32 v118, 1, v118
    v_lshrrev_b32 v119, 1, v117
    v_add_u32 v118, v118, v119
    v_lshlrev_b32 v222, 4, v118
    v_lshl_add_u32 v222, v233, 12, v222
    v_lshlrev_b32 v223, 8, v118
    v_lshl_add_u32 v223, v233, 4, v223
    v_lshlrev_b32 v224, 3, v233
    v_lshlrev_b32 v4, 4, v9
    s_lshl_b32 s45, s38, 7
    s_and_b32 s49, s40, 1
    s_lshl_b32 s49, s49, 6
    s_add_u32 s45, s45, s49
    s_lshr_b32 s49, s40, 1
    s_add_u32 s45, s45, s49
    s_lshl_b32 s45, s45, 11
    s_lshl_b32 s49, s39, 7
    s_add_u32 s45, s45, s49
    s_add_u32 s46, s45, 65536
    buffer_load_dwordx4 v[204:207], v222, s[16:19], s45 offen offset:0
    buffer_load_dwordx4 v[208:211], v222, s[16:19], s45 offen offset:64
    buffer_load_dwordx4 v[212:215], v222, s[16:19], s46 offen offset:0
    buffer_load_dwordx4 v[216:219], v222, s[16:19], s46 offen offset:64
    v_lshrrev_b32 v118, 2, v233
    v_lshl_add_u32 v119, v117, 3, v118
    v_lshlrev_b32 v5, 7, v119
    v_and_b32 v119, 3, v233
    v_lshl_add_u32 v5, v119, 3, v5
    v_lshrrev_b32 v118, 1, v118
    v_and_b32 v119, 1, v117
    v_lshl_add_u32 v118, v119, 1, v118
    v_xor_b32 v119, 0, v118
    v_lshl_add_u32 v225, v119, 5, v5
    v_add_u32 v229, 0x10000, v225
    v_xor_b32 v119, 1, v118
    v_lshl_add_u32 v226, v119, 5, v5
    v_add_u32 v230, 0x10000, v226
    v_xor_b32 v119, 2, v118
    v_lshl_add_u32 v227, v119, 5, v5
    v_add_u32 v231, 0x10000, v227
    v_xor_b32 v119, 3, v118
    v_lshl_add_u32 v228, v119, 5, v5
    v_add_u32 v232, 0x10000, v228
    s_lshl_b32 s45, s41, 1
    v_xor_b32 v118, s45, v118
    v_xor_b32 v119, 1, v118
    v_lshl_add_u32 v6, v119, 5, v5
    v_lshl_add_u32 v5, v118, 5, v5
    v_lshlrev_b32 v116, 2, v117
    v_add_u32 v119, 0, v116
    v_cmp_le_u32 s[64:65], v119, v233
    v_sub_u32 v119, v233, v119
    v_and_b32 v119, 15, v119
    v_cmp_gt_u32 s[72:73], 8, v119
    s_nop 0
    s_and_b64 s[80:81], s[72:73], s[64:65]
    s_cmp_eq_u32 s36, 0
    s_cselect_b64 s[80:81], s[80:81], s[72:73]
    v_add_u32 v119, 1, v116
    v_cmp_le_u32 s[66:67], v119, v233
    v_sub_u32 v119, v233, v119
    v_and_b32 v119, 15, v119
    v_cmp_gt_u32 s[74:75], 8, v119
    s_nop 0
    s_and_b64 s[82:83], s[74:75], s[66:67]
    s_cmp_eq_u32 s36, 0
    s_cselect_b64 s[82:83], s[82:83], s[74:75]
    v_add_u32 v119, 2, v116
    v_cmp_le_u32 s[68:69], v119, v233
    v_sub_u32 v119, v233, v119
    v_and_b32 v119, 15, v119
    v_cmp_gt_u32 s[76:77], 8, v119
    s_nop 0
    s_and_b64 s[84:85], s[76:77], s[68:69]
    s_cmp_eq_u32 s36, 0
    s_cselect_b64 s[84:85], s[84:85], s[76:77]
    v_add_u32 v119, 3, v116
    v_cmp_le_u32 s[70:71], v119, v233
    v_sub_u32 v119, v233, v119
    v_and_b32 v119, 15, v119
    v_cmp_gt_u32 s[78:79], 8, v119
    s_nop 0
    s_and_b64 s[86:87], s[78:79], s[70:71]
    s_cmp_eq_u32 s36, 0
    s_cselect_b64 s[86:87], s[86:87], s[78:79]
    v_mov_b32 v118, 0xffff
    v_mov_b32 v116, 0xffff0000
    v_cndmask_b32 v220, 0, v118, s[64:65]
    v_cndmask_b32 v119, 0, v116, s[66:67]
    v_or_b32 v220, v220, v119
    v_cndmask_b32 v221, 0, v118, s[68:69]
    v_cndmask_b32 v119, 0, v116, s[70:71]
    v_or_b32 v221, v221, v119
    v_and_b32 v118, 3, v233
    v_cmp_eq_u32 s[88:89], 1, v118
    v_cmp_eq_u32 s[90:91], 2, v118
    v_cmp_eq_u32 s[92:93], 3, v118
    v_lshrrev_b32 v118, 2, v233
    v_cmp_eq_u32 s[94:95], v118, v117
    s_mov_b32 s54, 0x3e8293ee
    s_mov_b32 s53, 0xffff0000
    v_lshrrev_b32 v118, 1, v233
    v_xor_b32 v118, v118, v117
    v_lshlrev_b32 v118, 4, v118
    v_lshl_add_u32 v10, v233, 7, v118
    v_xor_b32 v11, 64, v10
    s_add_u32 s48, s42, 0
    s_lshl_b32 s45, s48, 22
    s_lshl_b32 s49, s38, 18
    s_add_u32 s45, s45, s49
    s_lshl_b32 s49, s39, 14
    s_add_u32 s45, s45, s49
    s_lshl_b32 s49, s40, 12
    s_add_u32 s45, s45, s49
    s_lshl_b32 s47, s48, 18
    s_lshl_b32 s49, s38, 14
    s_add_u32 s47, s47, s49
    s_lshl_b32 s49, s39, 10
    s_add_u32 s47, s47, s49
    s_lshl_b32 s49, s40, 8
    s_add_u32 s47, s47, s49
    s_add_u32 s47, s47, 33554432
    s_lshl_b32 s50, s38, 9
    s_lshl_b32 s49, s40, 7
    s_add_u32 s50, s50, s49
    s_lshl_b32 s49, s39, 2
    s_add_u32 s50, s50, s49
    s_add_u32 s50, s50, 35651584
    s_mov_b32 s55, 2
    s_waitcnt vmcnt(0)
    v_mov_b32 v116, 0x3f803f80
    v_mov_b32 v117, 0x3f803f80
    v_mov_b32 v118, 0x3f803f80
    v_mov_b32 v119, 0x3f803f80
    s_nop 1
    v_mfma_f32_16x16x32_bf16 v[120:123], v[116:119], v[204:207], 0
    v_mfma_f32_16x16x32_bf16 v[124:127], v[204:207], v[204:207], 0
    v_mfma_f32_16x16x32_bf16 v[128:131], v[116:119], v[212:215], 0
    v_mfma_f32_16x16x32_bf16 v[132:135], v[212:215], v[212:215], 0
    v_mfma_f32_16x16x32_bf16 v[120:123], v[116:119], v[208:211], v[120:123]
    v_mfma_f32_16x16x32_bf16 v[124:127], v[208:211], v[208:211], v[124:127]
    v_mfma_f32_16x16x32_bf16 v[128:131], v[116:119], v[216:219], v[128:131]
    v_mfma_f32_16x16x32_bf16 v[132:135], v[216:219], v[216:219], v[132:135]
    s_nop 5
    v_cndmask_b32 v121, v124, v125, s[88:89]
    v_cndmask_b32 v121, v121, v126, s[90:91]
    v_cndmask_b32 v121, v121, v127, s[92:93]
    v_cndmask_b32 v129, v132, v133, s[88:89]
    v_cndmask_b32 v129, v129, v134, s[90:91]
    v_cndmask_b32 v129, v129, v135, s[92:93]
    s_mov_b64 exec, s[94:95]
    buffer_store_dwordx2 v[120:121], v224, s[4:7], s47 offen offset:0 sc1
    buffer_store_dwordx2 v[128:129], v224, s[4:7], s47 offen offset:128 sc1
    s_mov_b64 exec, -1
    v_permlane16_swap_b32 v204, v206
    v_permlane16_swap_b32 v205, v207
    v_permlane16_swap_b32 v208, v210
    v_permlane16_swap_b32 v209, v211
    v_permlane16_swap_b32 v212, v214
    v_permlane16_swap_b32 v213, v215
    v_permlane16_swap_b32 v216, v218
    v_permlane16_swap_b32 v217, v219
    s_waitcnt lgkmcnt(0)
    s_add_u32 s43, s43, 256
    s_add_u32 s44, s43, 1
    s_bitcmp1_b32 s40, 0
    s_cbranch_scc1 a_cons_p1
a_cons_p0:
    s_cmp_lg_u32 s42, 0
    s_cbranch_scc1 a_nozero_p0
    v_mov_b32 v12, 0
    v_mov_b32 v13, 0
    v_mov_b32 v14, 0
    v_mov_b32 v15, 0
    v_mov_b32 v16, 0
    v_mov_b32 v17, 0
    v_mov_b32 v18, 0
    v_mov_b32 v19, 0
    v_mov_b32 v20, 0
    v_mov_b32 v21, 0
    v_mov_b32 v22, 0
    v_mov_b32 v23, 0
    v_mov_b32 v24, 0
    v_mov_b32 v25, 0
    v_mov_b32 v26, 0
    v_mov_b32 v27, 0
    v_mov_b32 v28, 0
    v_mov_b32 v29, 0
    v_mov_b32 v30, 0
    v_mov_b32 v31, 0
    v_mov_b32 v32, 0
    v_mov_b32 v33, 0
    v_mov_b32 v34, 0
    v_mov_b32 v35, 0
    v_mov_b32 v36, 0
    v_mov_b32 v37, 0
    v_mov_b32 v38, 0
    v_mov_b32 v39, 0
    v_mov_b32 v40, 0
    v_mov_b32 v41, 0
    v_mov_b32 v42, 0
    v_mov_b32 v43, 0
    v_mov_b32 v44, 0
    v_mov_b32 v45, 0
    v_mov_b32 v46, 0
    v_mov_b32 v47, 0
    v_mov_b32 v48, 0
    v_mov_b32 v49, 0
    v_mov_b32 v50, 0
    v_mov_b32 v51, 0
    v_mov_b32 v52, 0
    v_mov_b32 v53, 0
    v_mov_b32 v54, 0
    v_mov_b32 v55, 0
    v_mov_b32 v56, 0
    v_mov_b32 v57, 0
    v_mov_b32 v58, 0
    v_mov_b32 v59, 0
    v_mov_b32 v60, 0
    v_mov_b32 v61, 0
    v_mov_b32 v62, 0
    v_mov_b32 v63, 0
    v_mov_b32 v64, 0
    v_mov_b32 v65, 0
    v_mov_b32 v66, 0
    v_mov_b32 v67, 0
    v_mov_b32 v68, 0
    v_mov_b32 v69, 0
    v_mov_b32 v70, 0
    v_mov_b32 v71, 0
    v_mov_b32 v72, 0
    v_mov_b32 v73, 0
    v_mov_b32 v74, 0
    v_mov_b32 v75, 0
    v_mov_b32 v76, 0
    v_mov_b32 v77, 0
    v_mov_b32 v78, 0
    v_mov_b32 v79, 0
    v_mov_b32 v80, 0
    v_mov_b32 v81, 0
    v_mov_b32 v82, 0
    v_mov_b32 v83, 0
    v_mov_b32 v84, 0
    v_mov_b32 v85, 0
    v_mov_b32 v86, 0
    v_mov_b32 v87, 0
    v_mov_b32 v88, 0
    v_mov_b32 v89, 0
    v_mov_b32 v90, 0
    v_mov_b32 v91, 0
    v_mov_b32 v92, 0
    v_mov_b32 v93, 0
    v_mov_b32 v94, 0
    v_mov_b32 v95, 0
    v_mov_b32 v96, 0
    v_mov_b32 v97, 0
    v_mov_b32 v98, 0
    v_mov_b32 v99, 0
    v_mov_b32 v100, 0
    v_mov_b32 v101, 0
    v_mov_b32 v102, 0
    v_mov_b32 v103, 0
    v_mov_b32 v104, 0
    v_mov_b32 v105, 0
    v_mov_b32 v106, 0
    v_mov_b32 v107, 0
a_nozero_p0:
    s_mov_b32 s58, 0
    s_mov_b32 s59, 55296
    v_mov_b32 v1, v10
    v_mov_b32 v254, v11
    v_add_u32 v2, s59, v5
    v_add_u32 v3, s59, v6
    s_mov_b32 s60, 0
    s_cmp_eq_u32 s42, 0
    s_cbranch_scc1 a_first_p0
    s_waitcnt lgkmcnt(0)
    s_barrier
    ds_read_b64_tr_b16 v[116:117], v2 offset:0
    ds_read_b64_tr_b16 v[118:119], v2 offset:512
    ds_read_b128 v[140:143], v1 offset:0
    ds_read_b128 v[144:147], v1 offset:2048
    ds_read_b128 v[148:151], v1 offset:4096
    ds_read_b128 v[152:155], v1 offset:6144
    ds_read_b64_tr_b16 v[120:121], v3 offset:0
    ds_read_b64_tr_b16 v[122:123], v3 offset:512
    ds_read_b64_tr_b16 v[124:125], v2 offset:8192
    ds_read_b64_tr_b16 v[126:127], v2 offset:8704
    ds_read_b64_tr_b16 v[128:129], v3 offset:8192
    ds_read_b64_tr_b16 v[130:131], v3 offset:8704
    ds_read_b64_tr_b16 v[132:133], v2 offset:16384
    ds_read_b64_tr_b16 v[134:135], v2 offset:16896
    ds_read_b64_tr_b16 v[136:137], v3 offset:16384
    ds_read_b64_tr_b16 v[138:139], v3 offset:16896
    s_waitcnt lgkmcnt(0)
    v_mfma_f32_16x16x32_bf16 v[12:15], v[116:119], v[140:143], 0
    ds_read_b64_tr_b16 v[160:161], v2 offset:4096
    v_mfma_f32_16x16x32_bf16 v[16:19], v[116:119], v[144:147], 0
    ds_read_b64_tr_b16 v[162:163], v2 offset:4608
    v_mfma_f32_16x16x32_bf16 v[20:23], v[116:119], v[148:151], 0
    ds_read_b128 v[184:187], v254 offset:0
    v_mfma_f32_16x16x32_bf16 v[24:27], v[116:119], v[152:155], 0
    ds_read_b128 v[188:191], v254 offset:2048
    v_mfma_f32_16x16x32_bf16 v[28:31], v[120:123], v[140:143], 0
    ds_read_b128 v[192:195], v254 offset:4096
    v_mfma_f32_16x16x32_bf16 v[32:35], v[120:123], v[144:147], 0
    ds_read_b128 v[196:199], v254 offset:6144
    v_mfma_f32_16x16x32_bf16 v[36:39], v[120:123], v[148:151], 0
    ds_read_b64_tr_b16 v[164:165], v3 offset:4096
    v_mfma_f32_16x16x32_bf16 v[40:43], v[120:123], v[152:155], 0
    ds_read_b64_tr_b16 v[166:167], v3 offset:4608
    v_mfma_f32_16x16x32_bf16 v[44:47], v[124:127], v[140:143], 0
    ds_read_b64_tr_b16 v[168:169], v2 offset:12288
    v_mfma_f32_16x16x32_bf16 v[48:51], v[124:127], v[144:147], 0
    ds_read_b64_tr_b16 v[170:171], v2 offset:12800
    v_mfma_f32_16x16x32_bf16 v[52:55], v[124:127], v[148:151], 0
    ds_read_b64_tr_b16 v[172:173], v3 offset:12288
    v_mfma_f32_16x16x32_bf16 v[56:59], v[124:127], v[152:155], 0
    ds_read_b64_tr_b16 v[174:175], v3 offset:12800
    v_mfma_f32_16x16x32_bf16 v[60:63], v[128:131], v[140:143], 0
    ds_read_b64_tr_b16 v[176:177], v2 offset:20480
    v_mfma_f32_16x16x32_bf16 v[64:67], v[128:131], v[144:147], 0
    ds_read_b64_tr_b16 v[178:179], v2 offset:20992
    v_mfma_f32_16x16x32_bf16 v[68:71], v[128:131], v[148:151], 0
    ds_read_b64_tr_b16 v[180:181], v3 offset:20480
    v_mfma_f32_16x16x32_bf16 v[72:75], v[128:131], v[152:155], 0
    ds_read_b64_tr_b16 v[182:183], v3 offset:20992
    v_mfma_f32_16x16x32_bf16 v[76:79], v[140:143], v[132:135], 0
    s_add_u32 s58, s58, 18432
    v_mfma_f32_16x16x32_bf16 v[80:83], v[144:147], v[132:135], 0
    s_add_u32 s59, s59, 24576
    v_mfma_f32_16x16x32_bf16 v[84:87], v[148:151], v[132:135], 0
    s_cmp_eq_u32 s58, 55296
    v_mfma_f32_16x16x32_bf16 v[88:91], v[152:155], v[132:135], 0
    s_cselect_b32 s58, 0, s58
    v_mfma_f32_16x16x32_bf16 v[92:95], v[140:143], v[136:139], 0
    s_cmp_eq_u32 s59, 153600
    v_mfma_f32_16x16x32_bf16 v[96:99], v[144:147], v[136:139], 0
    s_cselect_b32 s59, 55296, s59
    v_mfma_f32_16x16x32_bf16 v[100:103], v[148:151], v[136:139], 0
    v_add_u32 v1, s58, v10
    v_mfma_f32_16x16x32_bf16 v[104:107], v[152:155], v[136:139], 0
    v_add_u32 v254, s58, v11
    v_add_u32 v2, s59, v5
    v_add_u32 v3, s59, v6
    s_waitcnt lgkmcnt(0)
    v_mfma_f32_16x16x32_bf16 v[12:15], v[160:163], v[184:187], v[12:15]
    v_mfma_f32_16x16x32_bf16 v[16:19], v[160:163], v[188:191], v[16:19]
    v_mfma_f32_16x16x32_bf16 v[20:23], v[160:163], v[192:195], v[20:23]
    v_mfma_f32_16x16x32_bf16 v[24:27], v[160:163], v[196:199], v[24:27]
    v_mfma_f32_16x16x32_bf16 v[28:31], v[164:167], v[184:187], v[28:31]
    v_mfma_f32_16x16x32_bf16 v[32:35], v[164:167], v[188:191], v[32:35]
    v_mfma_f32_16x16x32_bf16 v[36:39], v[164:167], v[192:195], v[36:39]
    v_mfma_f32_16x16x32_bf16 v[40:43], v[164:167], v[196:199], v[40:43]
    v_mfma_f32_16x16x32_bf16 v[44:47], v[168:171], v[184:187], v[44:47]
    v_mfma_f32_16x16x32_bf16 v[48:51], v[168:171], v[188:191], v[48:51]
    v_mfma_f32_16x16x32_bf16 v[52:55], v[168:171], v[192:195], v[52:55]
    v_mfma_f32_16x16x32_bf16 v[56:59], v[168:171], v[196:199], v[56:59]
    v_mfma_f32_16x16x32_bf16 v[60:63], v[172:175], v[184:187], v[60:63]
    v_mfma_f32_16x16x32_bf16 v[64:67], v[172:175], v[188:191], v[64:67]
    v_mfma_f32_16x16x32_bf16 v[68:71], v[172:175], v[192:195], v[68:71]
    v_mfma_f32_16x16x32_bf16 v[72:75], v[172:175], v[196:199], v[72:75]
    v_mfma_f32_16x16x32_bf16 v[76:79], v[184:187], v[176:179], v[76:79]
    v_mfma_f32_16x16x32_bf16 v[80:83], v[188:191], v[176:179], v[80:83]
    v_mfma_f32_16x16x32_bf16 v[84:87], v[192:195], v[176:179], v[84:87]
    v_mfma_f32_16x16x32_bf16 v[88:91], v[196:199], v[176:179], v[88:91]
    v_mfma_f32_16x16x32_bf16 v[92:95], v[184:187], v[180:183], v[92:95]
    v_mfma_f32_16x16x32_bf16 v[96:99], v[188:191], v[180:183], v[96:99]
    v_mfma_f32_16x16x32_bf16 v[100:103], v[192:195], v[180:183], v[100:103]
    v_mfma_f32_16x16x32_bf16 v[104:107], v[196:199], v[180:183], v[104:107]
    s_barrier
    ds_read_b64_tr_b16 v[116:117], v2 offset:0
    ds_read_b64_tr_b16 v[118:119], v2 offset:512
    ds_read_b128 v[140:143], v1 offset:0
    ds_read_b128 v[144:147], v1 offset:2048
    ds_read_b128 v[148:151], v1 offset:4096
    ds_read_b128 v[152:155], v1 offset:6144
    ds_read_b64_tr_b16 v[120:121], v3 offset:0
    ds_read_b64_tr_b16 v[122:123], v3 offset:512
    ds_read_b64_tr_b16 v[124:125], v2 offset:8192
    ds_read_b64_tr_b16 v[126:127], v2 offset:8704
    ds_read_b64_tr_b16 v[128:129], v3 offset:8192
    ds_read_b64_tr_b16 v[130:131], v3 offset:8704
    ds_read_b64_tr_b16 v[132:133], v2 offset:16384
    ds_read_b64_tr_b16 v[134:135], v2 offset:16896
    ds_read_b64_tr_b16 v[136:137], v3 offset:16384
    ds_read_b64_tr_b16 v[138:139], v3 offset:16896
    s_waitcnt lgkmcnt(0)
    s_mov_b32 s60, 1
    s_branch ac_loop_p0
a_first_p0:
    s_barrier
    ds_read_b64_tr_b16 v[116:117], v2 offset:0
    ds_read_b64_tr_b16 v[118:119], v2 offset:512
    ds_read_b128 v[140:143], v1 offset:0
    ds_read_b128 v[144:147], v1 offset:2048
    ds_read_b128 v[148:151], v1 offset:4096
    ds_read_b128 v[152:155], v1 offset:6144
    ds_read_b64_tr_b16 v[120:121], v3 offset:0
    ds_read_b64_tr_b16 v[122:123], v3 offset:512
    ds_read_b64_tr_b16 v[124:125], v2 offset:8192
    ds_read_b64_tr_b16 v[126:127], v2 offset:8704
    ds_read_b64_tr_b16 v[128:129], v3 offset:8192
    ds_read_b64_tr_b16 v[130:131], v3 offset:8704
    ds_read_b64_tr_b16 v[132:133], v2 offset:16384
    ds_read_b64_tr_b16 v[134:135], v2 offset:16896
    ds_read_b64_tr_b16 v[136:137], v3 offset:16384
    ds_read_b64_tr_b16 v[138:139], v3 offset:16896
    s_waitcnt lgkmcnt(0)
ac_loop_p0:
    v_mfma_f32_16x16x32_bf16 v[12:15], v[116:119], v[140:143], v[12:15]
    ds_read_b64_tr_b16 v[160:161], v2 offset:4096
    v_mfma_f32_16x16x32_bf16 v[16:19], v[116:119], v[144:147], v[16:19]
    ds_read_b64_tr_b16 v[162:163], v2 offset:4608
    v_mfma_f32_16x16x32_bf16 v[20:23], v[116:119], v[148:151], v[20:23]
    ds_read_b128 v[184:187], v254 offset:0
    v_mfma_f32_16x16x32_bf16 v[24:27], v[116:119], v[152:155], v[24:27]
    ds_read_b128 v[188:191], v254 offset:2048
    v_mfma_f32_16x16x32_bf16 v[28:31], v[120:123], v[140:143], v[28:31]
    ds_read_b128 v[192:195], v254 offset:4096
    v_mfma_f32_16x16x32_bf16 v[32:35], v[120:123], v[144:147], v[32:35]
    ds_read_b128 v[196:199], v254 offset:6144
    v_mfma_f32_16x16x32_bf16 v[36:39], v[120:123], v[148:151], v[36:39]
    ds_read_b64_tr_b16 v[164:165], v3 offset:4096
    v_mfma_f32_16x16x32_bf16 v[40:43], v[120:123], v[152:155], v[40:43]
    ds_read_b64_tr_b16 v[166:167], v3 offset:4608
    v_mfma_f32_16x16x32_bf16 v[44:47], v[124:127], v[140:143], v[44:47]
    ds_read_b64_tr_b16 v[168:169], v2 offset:12288
    v_mfma_f32_16x16x32_bf16 v[48:51], v[124:127], v[144:147], v[48:51]
    ds_read_b64_tr_b16 v[170:171], v2 offset:12800
    v_mfma_f32_16x16x32_bf16 v[52:55], v[124:127], v[148:151], v[52:55]
    ds_read_b64_tr_b16 v[172:173], v3 offset:12288
    v_mfma_f32_16x16x32_bf16 v[56:59], v[124:127], v[152:155], v[56:59]
    ds_read_b64_tr_b16 v[174:175], v3 offset:12800
    v_mfma_f32_16x16x32_bf16 v[60:63], v[128:131], v[140:143], v[60:63]
    ds_read_b64_tr_b16 v[176:177], v2 offset:20480
    v_mfma_f32_16x16x32_bf16 v[64:67], v[128:131], v[144:147], v[64:67]
    ds_read_b64_tr_b16 v[178:179], v2 offset:20992
    v_mfma_f32_16x16x32_bf16 v[68:71], v[128:131], v[148:151], v[68:71]
    ds_read_b64_tr_b16 v[180:181], v3 offset:20480
    v_mfma_f32_16x16x32_bf16 v[72:75], v[128:131], v[152:155], v[72:75]
    ds_read_b64_tr_b16 v[182:183], v3 offset:20992
    v_mfma_f32_16x16x32_bf16 v[76:79], v[140:143], v[132:135], v[76:79]
    s_add_u32 s58, s58, 18432
    v_mfma_f32_16x16x32_bf16 v[80:83], v[144:147], v[132:135], v[80:83]
    s_add_u32 s59, s59, 24576
    v_mfma_f32_16x16x32_bf16 v[84:87], v[148:151], v[132:135], v[84:87]
    s_cmp_eq_u32 s58, 55296
    v_mfma_f32_16x16x32_bf16 v[88:91], v[152:155], v[132:135], v[88:91]
    s_cselect_b32 s58, 0, s58
    v_mfma_f32_16x16x32_bf16 v[92:95], v[140:143], v[136:139], v[92:95]
    s_cmp_eq_u32 s59, 153600
    v_mfma_f32_16x16x32_bf16 v[96:99], v[144:147], v[136:139], v[96:99]
    s_cselect_b32 s59, 55296, s59
    v_mfma_f32_16x16x32_bf16 v[100:103], v[148:151], v[136:139], v[100:103]
    v_add_u32 v1, s58, v10
    v_mfma_f32_16x16x32_bf16 v[104:107], v[152:155], v[136:139], v[104:107]
    v_add_u32 v254, s58, v11
    v_add_u32 v2, s59, v5
    v_add_u32 v3, s59, v6
    s_waitcnt lgkmcnt(0)
    s_barrier
    v_mfma_f32_16x16x32_bf16 v[12:15], v[160:163], v[184:187], v[12:15]
    ds_read_b64_tr_b16 v[116:117], v2 offset:0
    v_mfma_f32_16x16x32_bf16 v[16:19], v[160:163], v[188:191], v[16:19]
    ds_read_b64_tr_b16 v[118:119], v2 offset:512
    v_mfma_f32_16x16x32_bf16 v[20:23], v[160:163], v[192:195], v[20:23]
    ds_read_b128 v[140:143], v1 offset:0
    v_mfma_f32_16x16x32_bf16 v[24:27], v[160:163], v[196:199], v[24:27]
    ds_read_b128 v[144:147], v1 offset:2048
    v_mfma_f32_16x16x32_bf16 v[28:31], v[164:167], v[184:187], v[28:31]
    ds_read_b128 v[148:151], v1 offset:4096
    v_mfma_f32_16x16x32_bf16 v[32:35], v[164:167], v[188:191], v[32:35]
    ds_read_b128 v[152:155], v1 offset:6144
    v_mfma_f32_16x16x32_bf16 v[36:39], v[164:167], v[192:195], v[36:39]
    ds_read_b64_tr_b16 v[120:121], v3 offset:0
    v_mfma_f32_16x16x32_bf16 v[40:43], v[164:167], v[196:199], v[40:43]
    ds_read_b64_tr_b16 v[122:123], v3 offset:512
    v_mfma_f32_16x16x32_bf16 v[44:47], v[168:171], v[184:187], v[44:47]
    ds_read_b64_tr_b16 v[124:125], v2 offset:8192
    v_mfma_f32_16x16x32_bf16 v[48:51], v[168:171], v[188:191], v[48:51]
    ds_read_b64_tr_b16 v[126:127], v2 offset:8704
    v_mfma_f32_16x16x32_bf16 v[52:55], v[168:171], v[192:195], v[52:55]
    ds_read_b64_tr_b16 v[128:129], v3 offset:8192
    v_mfma_f32_16x16x32_bf16 v[56:59], v[168:171], v[196:199], v[56:59]
    ds_read_b64_tr_b16 v[130:131], v3 offset:8704
    v_mfma_f32_16x16x32_bf16 v[60:63], v[172:175], v[184:187], v[60:63]
    ds_read_b64_tr_b16 v[132:133], v2 offset:16384
    v_mfma_f32_16x16x32_bf16 v[64:67], v[172:175], v[188:191], v[64:67]
    ds_read_b64_tr_b16 v[134:135], v2 offset:16896
    v_mfma_f32_16x16x32_bf16 v[68:71], v[172:175], v[192:195], v[68:71]
    ds_read_b64_tr_b16 v[136:137], v3 offset:16384
    v_mfma_f32_16x16x32_bf16 v[72:75], v[172:175], v[196:199], v[72:75]
    ds_read_b64_tr_b16 v[138:139], v3 offset:16896
    v_mfma_f32_16x16x32_bf16 v[76:79], v[184:187], v[176:179], v[76:79]
    s_cmp_eq_u32 s60, s55
    v_mfma_f32_16x16x32_bf16 v[80:83], v[188:191], v[176:179], v[80:83]
    s_cbranch_scc1 a_flag_p0
a_flag_back_p0:
    v_mfma_f32_16x16x32_bf16 v[84:87], v[192:195], v[176:179], v[84:87]
    s_add_u32 s60, s60, 1
    v_mfma_f32_16x16x32_bf16 v[88:91], v[196:199], v[176:179], v[88:91]
    s_cmp_lt_u32 s60, 15
    v_mfma_f32_16x16x32_bf16 v[92:95], v[184:187], v[180:183], v[92:95]
    v_mfma_f32_16x16x32_bf16 v[96:99], v[188:191], v[180:183], v[96:99]
    v_mfma_f32_16x16x32_bf16 v[100:103], v[192:195], v[180:183], v[100:103]
    v_mfma_f32_16x16x32_bf16 v[104:107], v[196:199], v[180:183], v[104:107]
    s_waitcnt lgkmcnt(0)
    s_cbranch_scc1 ac_loop_p0
    s_branch a_last_p0
a_flag_p0:
    s_waitcnt vmcnt(0)
    v_mov_b32 v7, s44
    s_mov_b64 exec, 1
    buffer_store_dword v7, off, s[4:7], s50 sc1
    s_mov_b64 exec, -1
    s_branch a_flag_back_p0
a_last_p0:
    v_mfma_f32_16x16x32_bf16 v[12:15], v[116:119], v[140:143], v[12:15]
    ds_read_b64_tr_b16 v[160:161], v2 offset:4096
    v_mfma_f32_16x16x32_bf16 v[16:19], v[116:119], v[144:147], v[16:19]
    ds_read_b64_tr_b16 v[162:163], v2 offset:4608
    v_mfma_f32_16x16x32_bf16 v[20:23], v[116:119], v[148:151], v[20:23]
    ds_read_b128 v[184:187], v254 offset:0
    v_mfma_f32_16x16x32_bf16 v[24:27], v[116:119], v[152:155], v[24:27]
    ds_read_b128 v[188:191], v254 offset:2048
    v_mfma_f32_16x16x32_bf16 v[28:31], v[120:123], v[140:143], v[28:31]
    ds_read_b128 v[192:195], v254 offset:4096
    v_mfma_f32_16x16x32_bf16 v[32:35], v[120:123], v[144:147], v[32:35]
    ds_read_b128 v[196:199], v254 offset:6144
    v_mfma_f32_16x16x32_bf16 v[36:39], v[120:123], v[148:151], v[36:39]
    ds_read_b64_tr_b16 v[164:165], v3 offset:4096
    v_mfma_f32_16x16x32_bf16 v[40:43], v[120:123], v[152:155], v[40:43]
    ds_read_b64_tr_b16 v[166:167], v3 offset:4608
    v_mfma_f32_16x16x32_bf16 v[44:47], v[124:127], v[140:143], v[44:47]
    ds_read_b64_tr_b16 v[168:169], v2 offset:12288
    v_mfma_f32_16x16x32_bf16 v[48:51], v[124:127], v[144:147], v[48:51]
    ds_read_b64_tr_b16 v[170:171], v2 offset:12800
    v_mfma_f32_16x16x32_bf16 v[52:55], v[124:127], v[148:151], v[52:55]
    ds_read_b64_tr_b16 v[172:173], v3 offset:12288
    v_mfma_f32_16x16x32_bf16 v[56:59], v[124:127], v[152:155], v[56:59]
    ds_read_b64_tr_b16 v[174:175], v3 offset:12800
    v_mfma_f32_16x16x32_bf16 v[60:63], v[128:131], v[140:143], v[60:63]
    ds_read_b64_tr_b16 v[176:177], v2 offset:20480
    v_mfma_f32_16x16x32_bf16 v[64:67], v[128:131], v[144:147], v[64:67]
    ds_read_b64_tr_b16 v[178:179], v2 offset:20992
    v_mfma_f32_16x16x32_bf16 v[68:71], v[128:131], v[148:151], v[68:71]
    ds_read_b64_tr_b16 v[180:181], v3 offset:20480
    v_mfma_f32_16x16x32_bf16 v[72:75], v[128:131], v[152:155], v[72:75]
    ds_read_b64_tr_b16 v[182:183], v3 offset:20992
    v_mfma_f32_16x16x32_bf16 v[76:79], v[140:143], v[132:135], v[76:79]
    v_mov_b32 v110, s44
    v_mfma_f32_16x16x32_bf16 v[80:83], v[144:147], v[132:135], v[80:83]
    v_mov_b32 v111, s44
    v_mfma_f32_16x16x32_bf16 v[84:87], v[148:151], v[132:135], v[84:87]
    v_mov_b32 v202, s44
    v_mfma_f32_16x16x32_bf16 v[88:91], v[152:155], v[132:135], v[88:91]
    v_mov_b32 v203, s44
    v_mfma_f32_16x16x32_bf16 v[92:95], v[140:143], v[136:139], v[92:95]
    v_mfma_f32_16x16x32_bf16 v[96:99], v[144:147], v[136:139], v[96:99]
    v_mfma_f32_16x16x32_bf16 v[100:103], v[148:151], v[136:139], v[100:103]
    v_mfma_f32_16x16x32_bf16 v[104:107], v[152:155], v[136:139], v[104:107]
    s_and_b32 s45, s42, 1
    s_lshl_b32 s45, s45, 10
    s_lshl_b32 s46, s41, 7
    s_add_u32 s45, s45, s46
    s_add_u32 s45, s45, 159744
    v_lshlrev_b32 v1, 2, v233
    v_and_b32 v2, 0x30, v9
    v_add_u32 v3, s45, v2
    v_add_u32 v7, s45, v1
    v_add_u32 v1, 157696, v1
    v_add_u32 v2, 157696, v2
    s_waitcnt lgkmcnt(0)
    s_barrier
    v_mfma_f32_16x16x32_bf16 v[56:59], v[168:171], v[196:199], v[56:59]
    ds_read_b128 v[136:139], v3 offset:256
    ds_read_b128 v[140:143], v3 offset:320
    s_lshl_b32 s45, s42, 21
    s_lshl_b32 s49, s37, 13
    v_mfma_f32_16x16x32_bf16 v[72:75], v[172:175], v[196:199], v[72:75]
    ds_read_b32 v122, v1 offset:192
    ds_read_b32 v123, v1 offset:1216
    s_add_u32 s45, s45, s49
    v_mfma_f32_16x16x32_bf16 v[88:91], v[196:199], v[176:179], v[88:91]
    ds_read_b32 v126, v7 offset:512
    ds_read_b32 v127, v7 offset:576
    s_lshl_b32 s49, s40, 11
    s_add_u32 s45, s45, s49
    v_mfma_f32_16x16x32_bf16 v[104:107], v[196:199], v[180:183], v[104:107]
    ds_read_b128 v[144:147], v2 offset:192
    ds_read_b128 v[148:151], v2 offset:1216
    s_add_u32 s45, s45, 58720256
    v_mfma_f32_16x16x32_bf16 v[12:15], v[160:163], v[184:187], v[12:15]
    ds_read_b32 v116, v1 offset:0
    ds_read_b32 v117, v1 offset:1024
    s_lshl_b32 s49, s36, 17
    v_mfma_f32_16x16x32_bf16 v[16:19], v[160:163], v[188:191], v[16:19]
    ds_read_b32 v118, v1 offset:64
    ds_read_b32 v119, v1 offset:1088
    s_add_u32 s16, s45, s49
    s_max_u32 s49, s49, 131072
    v_mfma_f32_16x16x32_bf16 v[20:23], v[160:163], v[192:195], v[20:23]
    ds_read_b32 v120, v1 offset:128
    ds_read_b32 v121, v1 offset:1152
    s_sub_u32 s49, s49, 131072
    v_mfma_f32_16x16x32_bf16 v[24:27], v[160:163], v[196:199], v[24:27]
    ds_read_b128 v[152:155], v2 offset:0
    ds_read_b128 v[156:159], v2 offset:1024
    s_add_u32 s17, s45, s49
    v_mfma_f32_16x16x32_bf16 v[28:31], v[164:167], v[184:187], v[28:31]
    ds_read_b128 v[128:131], v3 offset:0
    ds_read_b128 v[132:135], v3 offset:64
    v_mfma_f32_16x16x32_bf16 v[32:35], v[164:167], v[188:191], v[32:35]
    s_waitcnt lgkmcnt(10)
    v_pk_fma_f32 v[56:57], v[136:137], v[122:123], v[56:57] op_sel_hi:[1,0,1]
    v_pk_fma_f32 v[88:89], v[144:145], v[126:127], v[88:89] op_sel_hi:[1,0,1]
    v_pk_fma_f32 v[72:73], v[140:141], v[122:123], v[72:73] op_sel_hi:[1,0,1]
    v_mfma_f32_16x16x32_bf16 v[36:39], v[164:167], v[192:195], v[36:39]
    v_pk_fma_f32 v[104:105], v[126:127], v[144:145], v[104:105] op_sel:[1,0,0] op_sel_hi:[1,1,1]
    v_pk_fma_f32 v[58:59], v[138:139], v[122:123], v[58:59] op_sel_hi:[1,0,1]
    v_mfma_f32_16x16x32_bf16 v[40:43], v[164:167], v[196:199], v[40:43]
    v_pk_fma_f32 v[90:91], v[146:147], v[126:127], v[90:91] op_sel_hi:[1,0,1]
    v_pk_fma_f32 v[74:75], v[142:143], v[122:123], v[74:75] op_sel_hi:[1,0,1]
    v_pk_fma_f32 v[106:107], v[126:127], v[146:147], v[106:107] op_sel:[1,0,0] op_sel_hi:[1,1,1]
    v_mfma_f32_16x16x32_bf16 v[44:47], v[168:171], v[184:187], v[44:47]
    v_pk_mul_f32 v[56:57], v[122:123], v[56:57] op_sel:[1,0] op_sel_hi:[1,1]
    v_pk_mul_f32 v[88:89], v[88:89], v[148:149]
    v_mfma_f32_16x16x32_bf16 v[48:51], v[168:171], v[188:191], v[48:51]
    v_pk_mul_f32 v[72:73], v[122:123], v[72:73] op_sel:[1,0] op_sel_hi:[1,1]
    v_pk_mul_f32 v[104:105], v[104:105], v[148:149]
    v_mfma_f32_16x16x32_bf16 v[52:55], v[168:171], v[192:195], v[52:55]
    v_pk_mul_f32 v[58:59], v[122:123], v[58:59] op_sel:[1,0] op_sel_hi:[1,1]
    v_pk_mul_f32 v[90:91], v[90:91], v[150:151]
    v_pk_mul_f32 v[74:75], v[122:123], v[74:75] op_sel:[1,0] op_sel_hi:[1,1]
    v_mfma_f32_16x16x32_bf16 v[60:63], v[172:175], v[184:187], v[60:63]
    v_pk_mul_f32 v[106:107], v[106:107], v[150:151]
    v_cvt_pk_bf16_f32 v56, v56, v57
    v_mfma_f32_16x16x32_bf16 v[64:67], v[172:175], v[188:191], v[64:67]
    v_cvt_pk_bf16_f32 v242, v88, v89
    v_cvt_pk_bf16_f32 v57, v58, v59
    v_cvt_pk_bf16_f32 v252, v104, v105
    v_mfma_f32_16x16x32_bf16 v[68:71], v[172:175], v[192:195], v[68:71]
    v_cvt_pk_bf16_f32 v58, v72, v73
    v_cvt_pk_bf16_f32 v243, v90, v91
    v_mfma_f32_16x16x32_bf16 v[76:79], v[184:187], v[176:179], v[76:79]
    v_cvt_pk_bf16_f32 v59, v74, v75
    v_cvt_pk_bf16_f32 v253, v106, v107
    v_mfma_f32_16x16x32_bf16 v[80:83], v[188:191], v[176:179], v[80:83]
    v_mov_b32 v108, v56
    v_mov_b32 v124, v252
    v_mov_b32 v109, v57
    v_mfma_f32_16x16x32_bf16 v[84:87], v[192:195], v[176:179], v[84:87]
    v_mov_b32 v200, v242
    v_mov_b32 v125, v253
    v_mfma_f32_16x16x32_bf16 v[92:95], v[184:187], v[180:183], v[92:95]
    v_mov_b32_dpp v108, v58 row_ror:8 row_mask:0xf bank_mask:0x3
    v_mov_b32 v201, v243
    v_mov_b32_dpp v109, v59 row_ror:8 row_mask:0xf bank_mask:0x3
    v_mfma_f32_16x16x32_bf16 v[96:99], v[188:191], v[180:183], v[96:99]
    buffer_store_dwordx4 v[108:111], v4, s[4:7], s16 offen sc1
    v_permlane32_swap_b32 v124, v200
    v_mfma_f32_16x16x32_bf16 v[100:103], v[192:195], v[180:183], v[100:103]
    v_permlane32_swap_b32 v125, v201
    buffer_store_dwordx4 v[200:203], v4, s[4:7], s16 offen offset:1024 sc1
    ds_read_b128 v[160:163], v2 offset:64
    ds_read_b128 v[164:167], v2 offset:1088
    ds_read_b128 v[168:171], v2 offset:128
    ds_read_b128 v[172:175], v2 offset:1152
    s_waitcnt lgkmcnt(4)
    v_pk_fma_f32 v[44:45], v[136:137], v[116:117], v[44:45] op_sel_hi:[1,0,1]
    v_pk_fma_f32 v[48:49], v[136:137], v[118:119], v[48:49] op_sel_hi:[1,0,1]
    v_pk_fma_f32 v[52:53], v[136:137], v[120:121], v[52:53] op_sel_hi:[1,0,1]
    v_pk_fma_f32 v[24:25], v[128:129], v[122:123], v[24:25] op_sel_hi:[1,0,1]
    v_pk_fma_f32 v[46:47], v[138:139], v[116:117], v[46:47] op_sel_hi:[1,0,1]
    v_pk_fma_f32 v[50:51], v[138:139], v[118:119], v[50:51] op_sel_hi:[1,0,1]
    v_pk_fma_f32 v[54:55], v[138:139], v[120:121], v[54:55] op_sel_hi:[1,0,1]
    v_pk_fma_f32 v[26:27], v[130:131], v[122:123], v[26:27] op_sel_hi:[1,0,1]
    v_pk_mul_f32 v[44:45], v[116:117], v[44:45] op_sel:[1,0] op_sel_hi:[1,1]
    v_pk_mul_f32 v[48:49], v[118:119], v[48:49] op_sel:[1,0] op_sel_hi:[1,1]
    v_pk_mul_f32 v[52:53], v[120:121], v[52:53] op_sel:[1,0] op_sel_hi:[1,1]
    v_pk_fma_f32 v[40:41], v[132:133], v[122:123], v[40:41] op_sel_hi:[1,0,1]
    v_pk_mul_f32 v[46:47], v[116:117], v[46:47] op_sel:[1,0] op_sel_hi:[1,1]
    v_pk_mul_f32 v[50:51], v[118:119], v[50:51] op_sel:[1,0] op_sel_hi:[1,1]
    v_pk_mul_f32 v[54:55], v[120:121], v[54:55] op_sel:[1,0] op_sel_hi:[1,1]
    v_pk_fma_f32 v[42:43], v[134:135], v[122:123], v[42:43] op_sel_hi:[1,0,1]
    v_pk_fma_f32 v[60:61], v[140:141], v[116:117], v[60:61] op_sel_hi:[1,0,1]
    v_pk_fma_f32 v[64:65], v[140:141], v[118:119], v[64:65] op_sel_hi:[1,0,1]
    v_pk_fma_f32 v[68:69], v[140:141], v[120:121], v[68:69] op_sel_hi:[1,0,1]
    v_cvt_pk_bf16_f32 v24, v24, v25
    v_pk_fma_f32 v[62:63], v[142:143], v[116:117], v[62:63] op_sel_hi:[1,0,1]
    v_pk_fma_f32 v[66:67], v[142:143], v[118:119], v[66:67] op_sel_hi:[1,0,1]
    v_pk_fma_f32 v[70:71], v[142:143], v[120:121], v[70:71] op_sel_hi:[1,0,1]
    v_cvt_pk_bf16_f32 v25, v26, v27
    v_pk_mul_f32 v[60:61], v[116:117], v[60:61] op_sel:[1,0] op_sel_hi:[1,1]
    v_pk_mul_f32 v[64:65], v[118:119], v[64:65] op_sel:[1,0] op_sel_hi:[1,1]
    v_pk_mul_f32 v[68:69], v[120:121], v[68:69] op_sel:[1,0] op_sel_hi:[1,1]
    v_cvt_pk_bf16_f32 v26, v40, v41
    v_pk_mul_f32 v[62:63], v[116:117], v[62:63] op_sel:[1,0] op_sel_hi:[1,1]
    v_pk_mul_f32 v[66:67], v[118:119], v[66:67] op_sel:[1,0] op_sel_hi:[1,1]
    v_pk_mul_f32 v[70:71], v[120:121], v[70:71] op_sel:[1,0] op_sel_hi:[1,1]
    v_cvt_pk_bf16_f32 v27, v42, v43
    v_cvt_pk_bf16_f32 v44, v44, v45
    v_cvt_pk_bf16_f32 v48, v48, v49
    v_cvt_pk_bf16_f32 v52, v52, v53
    v_mul_f32 v123, s54, v123
    v_cvt_pk_bf16_f32 v45, v46, v47
    v_cvt_pk_bf16_f32 v49, v50, v51
    v_cvt_pk_bf16_f32 v53, v54, v55
    v_cvt_pk_bf16_f32 v46, v60, v61
    v_cvt_pk_bf16_f32 v50, v64, v65
    v_cvt_pk_bf16_f32 v54, v68, v69
    v_cvt_pk_bf16_f32 v47, v62, v63
    v_cvt_pk_bf16_f32 v51, v66, v67
    v_cvt_pk_bf16_f32 v55, v70, v71
    v_pk_fma_f32 v[12:13], v[128:129], v[116:117], v[12:13] op_sel_hi:[1,0,1]
    v_pk_fma_f32 v[16:17], v[128:129], v[118:119], v[16:17] op_sel_hi:[1,0,1]
    v_pk_fma_f32 v[20:21], v[128:129], v[120:121], v[20:21] op_sel_hi:[1,0,1]
    v_pk_fma_f32 v[14:15], v[130:131], v[116:117], v[14:15] op_sel_hi:[1,0,1]
    v_pk_fma_f32 v[18:19], v[130:131], v[118:119], v[18:19] op_sel_hi:[1,0,1]
    v_pk_fma_f32 v[22:23], v[130:131], v[120:121], v[22:23] op_sel_hi:[1,0,1]
    v_pk_fma_f32 v[28:29], v[132:133], v[116:117], v[28:29] op_sel_hi:[1,0,1]
    v_pk_fma_f32 v[32:33], v[132:133], v[118:119], v[32:33] op_sel_hi:[1,0,1]
    v_pk_fma_f32 v[36:37], v[132:133], v[120:121], v[36:37] op_sel_hi:[1,0,1]
    v_pk_fma_f32 v[30:31], v[134:135], v[116:117], v[30:31] op_sel_hi:[1,0,1]
    v_pk_fma_f32 v[34:35], v[134:135], v[118:119], v[34:35] op_sel_hi:[1,0,1]
    v_pk_fma_f32 v[38:39], v[134:135], v[120:121], v[38:39] op_sel_hi:[1,0,1]
    v_cvt_pk_bf16_f32 v12, v12, v13
    v_cvt_pk_bf16_f32 v16, v16, v17
    v_cvt_pk_bf16_f32 v20, v20, v21
    v_cvt_pk_bf16_f32 v13, v14, v15
    v_cvt_pk_bf16_f32 v17, v18, v19
    v_cvt_pk_bf16_f32 v21, v22, v23
    v_cvt_pk_bf16_f32 v14, v28, v29
    v_cvt_pk_bf16_f32 v18, v32, v33
    v_cvt_pk_bf16_f32 v22, v36, v37
    v_cvt_pk_bf16_f32 v15, v30, v31
    v_cvt_pk_bf16_f32 v19, v34, v35
    v_cvt_pk_bf16_f32 v23, v38, v39
    v_mul_f32 v117, s54, v117
    v_mul_f32 v119, s54, v119
    v_mul_f32 v121, s54, v121
    buffer_load_dwordx4 v[112:115], v4, s[4:7], s17 offen sc1
    buffer_load_dwordx4 v[200:203], v4, s[4:7], s17 offen offset:1024 sc1
    s_waitcnt lgkmcnt(0)
    v_mfma_f32_16x16x32_bf16 v[60:63], v[44:47], v[12:15], 0
    v_pk_fma_f32 v[76:77], v[152:153], v[126:127], v[76:77] op_sel_hi:[1,0,1]
    v_pk_fma_f32 v[92:93], v[126:127], v[152:153], v[92:93] op_sel:[1,0,0] op_sel_hi:[1,1,1]
    v_mfma_f32_16x16x32_bf16 v[64:67], v[48:51], v[16:19], 0
    v_pk_fma_f32 v[80:81], v[160:161], v[126:127], v[80:81] op_sel_hi:[1,0,1]
    v_pk_fma_f32 v[96:97], v[126:127], v[160:161], v[96:97] op_sel:[1,0,0] op_sel_hi:[1,1,1]
    v_mfma_f32_16x16x32_bf16 v[68:71], v[52:55], v[20:23], 0
    v_pk_fma_f32 v[78:79], v[154:155], v[126:127], v[78:79] op_sel_hi:[1,0,1]
    v_pk_fma_f32 v[94:95], v[126:127], v[154:155], v[94:95] op_sel:[1,0,0] op_sel_hi:[1,1,1]
    v_mfma_f32_16x16x32_bf16 v[72:75], v[56:59], v[24:27], 0
    v_pk_fma_f32 v[82:83], v[162:163], v[126:127], v[82:83] op_sel_hi:[1,0,1]
    v_pk_fma_f32 v[98:99], v[126:127], v[162:163], v[98:99] op_sel:[1,0,0] op_sel_hi:[1,1,1]
    v_mfma_f32_16x16x32_bf16 v[32:35], v[44:47], v[16:19], 0
    v_pk_mul_f32 v[76:77], v[76:77], v[156:157]
    v_pk_mul_f32 v[92:93], v[92:93], v[156:157]
    v_mfma_f32_16x16x32_bf16 v[36:39], v[48:51], v[20:23], 0
    v_pk_mul_f32 v[80:81], v[80:81], v[164:165]
    v_pk_mul_f32 v[96:97], v[96:97], v[164:165]
    v_mfma_f32_16x16x32_bf16 v[40:43], v[52:55], v[24:27], 0
    v_pk_mul_f32 v[78:79], v[78:79], v[158:159]
    v_pk_mul_f32 v[94:95], v[94:95], v[158:159]
    v_pk_mul_f32 v[82:83], v[82:83], v[166:167]
    v_pk_mul_f32 v[98:99], v[98:99], v[166:167]
    v_cvt_pk_bf16_f32 v236, v76, v77
    v_cvt_pk_bf16_f32 v246, v92, v93
    v_cvt_pk_bf16_f32 v238, v80, v81
    v_cvt_pk_bf16_f32 v248, v96, v97
    v_cvt_pk_bf16_f32 v237, v78, v79
    v_cvt_pk_bf16_f32 v247, v94, v95
    v_cvt_pk_bf16_f32 v239, v82, v83
    v_cvt_pk_bf16_f32 v249, v98, v99
    v_pk_fma_f32 v[84:85], v[168:169], v[126:127], v[84:85] op_sel_hi:[1,0,1]
    v_pk_fma_f32 v[100:101], v[126:127], v[168:169], v[100:101] op_sel:[1,0,0] op_sel_hi:[1,1,1]
    v_pk_fma_f32 v[86:87], v[170:171], v[126:127], v[86:87] op_sel_hi:[1,0,1]
    v_pk_fma_f32 v[102:103], v[126:127], v[170:171], v[102:103] op_sel:[1,0,0] op_sel_hi:[1,1,1]
    v_pk_mul_f32 v[84:85], v[84:85], v[172:173]
    v_pk_mul_f32 v[100:101], v[100:101], v[172:173]
    v_pk_mul_f32 v[86:87], v[86:87], v[174:175]
    v_pk_mul_f32 v[102:103], v[102:103], v[174:175]
    v_cvt_pk_bf16_f32 v240, v84, v85
    v_cvt_pk_bf16_f32 v250, v100, v101
    v_cvt_pk_bf16_f32 v241, v86, v87
    v_cvt_pk_bf16_f32 v251, v102, v103
    v_mov_b32 v7, 0xf149f2ca
    s_lshl_b32 s45, s42, 22
    s_lshl_b32 s49, s36, 18
    s_add_u32 s45, s45, s49
    s_lshl_b32 s49, s37, 11
    s_add_u32 s45, s45, s49
    s_lshl_b32 s49, s41, 10
    s_add_u32 s45, s45, s49
    s_add_u32 s45, s45, 16777216
    s_add_u32 s46, s45, 32768
    s_add_u32 s47, s45, 65536
    s_add_u32 s48, s45, 98304
    v_cndmask_b32 v32, v32, v64, s[64:65]
    v_cndmask_b32 v36, v36, v68, s[64:65]
    v_cndmask_b32 v40, v40, v72, s[64:65]
    v_cndmask_b32 v33, v33, v65, s[66:67]
    v_cndmask_b32 v37, v37, v69, s[66:67]
    v_cndmask_b32 v41, v41, v73, s[66:67]
    v_cndmask_b32 v34, v34, v66, s[68:69]
    v_cndmask_b32 v38, v38, v70, s[68:69]
    v_cndmask_b32 v42, v42, v74, s[68:69]
    v_cndmask_b32 v35, v35, v67, s[70:71]
    v_cndmask_b32 v39, v39, v71, s[70:71]
    v_cndmask_b32 v43, v43, v75, s[70:71]
    v_cndmask_b32 v32, v7, v32, s[72:73]
    v_cndmask_b32 v36, v7, v36, s[72:73]
    v_cndmask_b32 v40, v7, v40, s[72:73]
    v_cndmask_b32 v33, v7, v33, s[74:75]
    v_cndmask_b32 v37, v7, v37, s[74:75]
    v_cndmask_b32 v41, v7, v41, s[74:75]
    v_cndmask_b32 v34, v7, v34, s[76:77]
    v_cndmask_b32 v38, v7, v38, s[76:77]
    v_cndmask_b32 v42, v7, v42, s[76:77]
    v_cndmask_b32 v35, v7, v35, s[78:79]
    v_cndmask_b32 v39, v7, v39, s[78:79]
    v_cndmask_b32 v43, v7, v43, s[78:79]
    v_max3_f32 v48, v32, v33, v34
    v_max3_f32 v52, v36, v37, v38
    v_max3_f32 v56, v40, v41, v42
    v_max_f32 v48, v48, v35
    v_max_f32 v52, v52, v39
    v_max_f32 v56, v56, v43
    v_mov_b32 v49, v48
    v_mov_b32 v53, v52
    v_mov_b32 v57, v56
    v_permlane16_swap_b32 v48, v49
    v_permlane16_swap_b32 v52, v53
    v_permlane16_swap_b32 v56, v57
    v_max_f32 v48, v48, v49
    v_max_f32 v52, v52, v53
    v_max_f32 v56, v56, v57
    v_mov_b32 v49, v48
    v_mov_b32 v53, v52
    v_mov_b32 v57, v56
    v_permlane32_swap_b32 v48, v49
    v_permlane32_swap_b32 v52, v53
    v_permlane32_swap_b32 v56, v57
    v_max_f32 v48, v48, v49
    v_max_f32 v52, v52, v53
    v_max_f32 v56, v56, v57
    v_mul_f32 v48, v48, v119
    v_mul_f32 v52, v52, v121
    v_mul_f32 v56, v56, v123
    v_fma_f32 v32, v32, v119, -v48
    v_fma_f32 v36, v36, v121, -v52
    v_fma_f32 v40, v40, v123, -v56
    v_fma_f32 v33, v33, v119, -v48
    v_fma_f32 v37, v37, v121, -v52
    v_fma_f32 v41, v41, v123, -v56
    v_fma_f32 v34, v34, v119, -v48
    v_fma_f32 v38, v38, v121, -v52
    v_fma_f32 v42, v42, v123, -v56
    v_fma_f32 v35, v35, v119, -v48
    v_fma_f32 v39, v39, v121, -v52
    v_fma_f32 v43, v43, v123, -v56
    v_exp_f32 v32, v32
    v_exp_f32 v36, v36
    v_exp_f32 v40, v40
    v_exp_f32 v33, v33
    v_exp_f32 v37, v37
    v_exp_f32 v41, v41
    v_exp_f32 v34, v34
    buffer_load_dwordx4 v[176:179], v4, s[4:7], s17 offen sc1
    buffer_load_dwordx4 v[180:183], v4, s[4:7], s17 offen offset:1024 sc1
    v_exp_f32 v38, v38
    v_exp_f32 v42, v42
    v_exp_f32 v35, v35
    v_exp_f32 v39, v39
    v_exp_f32 v43, v43
    v_add_f32 v48, v32, v33
    v_add_f32 v52, v36, v37
    v_add_f32 v56, v40, v41
    v_add_f32 v49, v34, v35
    v_add_f32 v53, v38, v39
    v_add_f32 v57, v42, v43
    v_add_f32 v48, v48, v49
    v_add_f32 v52, v52, v53
    v_add_f32 v56, v56, v57
    v_mov_b32 v49, v48
    v_mov_b32 v53, v52
    v_mov_b32 v57, v56
    v_permlane16_swap_b32 v48, v49
    v_permlane16_swap_b32 v52, v53
    v_permlane16_swap_b32 v56, v57
    v_add_f32 v48, v48, v49
    v_add_f32 v52, v52, v53
    v_add_f32 v56, v56, v57
    v_mov_b32 v49, v48
    v_mov_b32 v53, v52
    v_mov_b32 v57, v56
    v_permlane32_swap_b32 v48, v49
    v_permlane32_swap_b32 v52, v53
    v_permlane32_swap_b32 v56, v57
    v_add_f32 v48, v48, v49
    v_add_f32 v52, v52, v53
    v_add_f32 v56, v56, v57
    v_rcp_f32 v48, v48
    v_rcp_f32 v52, v52
    v_rcp_f32 v56, v56
    v_mul_f32 v32, v32, v48
    v_mul_f32 v36, v36, v52
    v_mul_f32 v40, v40, v56
    v_mul_f32 v33, v33, v48
    v_mul_f32 v37, v37, v52
    v_mul_f32 v41, v41, v56
    v_mul_f32 v34, v34, v48
    v_mul_f32 v38, v38, v52
    v_mul_f32 v42, v42, v56
    v_mul_f32 v35, v35, v48
    v_mul_f32 v39, v39, v52
    v_mul_f32 v43, v43, v56
    v_cvt_pk_bf16_f32 v50, v32, v33
    v_cvt_pk_bf16_f32 v54, v36, v37
    v_cvt_pk_bf16_f32 v58, v40, v41
    v_cvt_pk_bf16_f32 v51, v34, v35
    v_cvt_pk_bf16_f32 v55, v38, v39
    v_cvt_pk_bf16_f32 v59, v42, v43
    v_bfi_b32 v80, v220, 0, v50
    v_bfi_b32 v84, v220, 0, v54
    v_bfi_b32 v88, v220, 0, v58
    v_and_b32 v82, v220, v50
    v_and_b32 v86, v220, v54
    v_and_b32 v90, v220, v58
    v_bfi_b32 v81, v221, 0, v51
    v_bfi_b32 v85, v221, 0, v55
    v_bfi_b32 v89, v221, 0, v59
    v_and_b32 v83, v221, v51
    v_and_b32 v87, v221, v55
    v_and_b32 v91, v221, v59
    v_mfma_f32_16x16x32_bf16 v[16:19], v[236:239], v[80:83], 0
    v_mfma_f32_16x16x32_bf16 v[20:23], v[238:241], v[84:87], 0
    v_mfma_f32_16x16x32_bf16 v[24:27], v[240:243], v[88:91], 0
    v_mfma_f32_16x16x32_bf16 v[64:67], v[246:249], v[80:83], 0
    v_mfma_f32_16x16x32_bf16 v[68:71], v[248:251], v[84:87], 0
    v_mfma_f32_16x16x32_bf16 v[72:75], v[250:253], v[88:91], 0
    s_nop 2
    v_cvt_pk_bf16_f32 v48, v16, v17
    v_cvt_pk_bf16_f32 v52, v20, v21
    v_cvt_pk_bf16_f32 v56, v24, v25
    v_cvt_pk_bf16_f32 v49, v18, v19
    v_cvt_pk_bf16_f32 v53, v22, v23
    v_cvt_pk_bf16_f32 v57, v26, v27
    v_cvt_pk_bf16_f32 v50, v64, v65
    v_cvt_pk_bf16_f32 v54, v68, v69
    v_cvt_pk_bf16_f32 v58, v72, v73
    v_cvt_pk_bf16_f32 v51, v66, v67
    v_cvt_pk_bf16_f32 v55, v70, v71
    v_cvt_pk_bf16_f32 v59, v74, v75
    v_permlane16_swap_b32 v48, v50
    v_permlane16_swap_b32 v52, v54
    v_permlane16_swap_b32 v56, v58
    v_permlane16_swap_b32 v49, v51
    v_permlane16_swap_b32 v53, v55
    v_permlane16_swap_b32 v57, v59
    buffer_store_dwordx4 v[48:51], v223, s[4:7], s46 offen sc1
    buffer_store_dwordx4 v[52:55], v223, s[4:7], s47 offen sc1
    buffer_store_dwordx4 v[56:59], v223, s[4:7], s48 offen sc1
    s_cmp_eq_u32 s36, 0
    s_cbranch_scc1 hx_zero_1
    s_waitcnt vmcnt(5)
    v_cmp_ne_u32 vcc, s44, v114
    v_cmp_ne_u32 s[98:99], s44, v202
    s_nop 0
    s_or_b64 vcc, vcc, s[98:99]
    s_cbranch_vccnz hx_late_2
hx_ok_4:
    v_mov_b32 v244, v200
    v_mov_b32 v245, v201
    v_mov_b32_dpp v114, v112 row_ror:8 row_mask:0xf bank_mask:0xf
    v_mov_b32_dpp v115, v113 row_ror:8 row_mask:0xf bank_mask:0xf
    v_permlane32_swap_b32 v244, v200
    v_permlane32_swap_b32 v245, v201
    v_mov_b32 v234, v200
    v_mov_b32 v235, v201
hx_go_5:
    v_mfma_f32_16x16x32_bf16 v[28:31], v[112:115], v[12:15], 0
    s_nop 7
    v_cndmask_b32 v28, v28, v60, s[64:65]
    v_cndmask_b32 v29, v29, v61, s[66:67]
    v_cndmask_b32 v30, v30, v62, s[68:69]
    v_cndmask_b32 v31, v31, v63, s[70:71]
    v_cndmask_b32 v28, v7, v28, s[80:81]
    v_cndmask_b32 v29, v7, v29, s[82:83]
    v_cndmask_b32 v30, v7, v30, s[84:85]
    v_cndmask_b32 v31, v7, v31, s[86:87]
    v_max3_f32 v44, v28, v29, v30
    v_max_f32 v44, v44, v31
    v_mov_b32 v45, v44
    s_nop 1
    v_permlane16_swap_b32 v44, v45
    v_max_f32 v44, v44, v45
    v_mov_b32 v45, v44
    s_nop 1
    v_permlane32_swap_b32 v44, v45
    v_max_f32 v44, v44, v45
    v_mul_f32 v44, v44, v117
    v_fma_f32 v28, v28, v117, -v44
    v_fma_f32 v29, v29, v117, -v44
    v_fma_f32 v30, v30, v117, -v44
    v_fma_f32 v31, v31, v117, -v44
    v_exp_f32 v28, v28
    v_exp_f32 v29, v29
    v_exp_f32 v30, v30
    v_exp_f32 v31, v31
    v_add_f32 v44, v28, v29
    v_add_f32 v45, v30, v31
    v_add_f32 v44, v44, v45
    v_mov_b32 v45, v44
    s_nop 1
    v_permlane16_swap_b32 v44, v45
    v_add_f32 v44, v44, v45
    v_mov_b32 v45, v44
    s_nop 1
    v_permlane32_swap_b32 v44, v45
    v_add_f32 v44, v44, v45
    v_rcp_f32 v44, v44
    s_nop 0
    v_mul_f32 v28, v28, v44
    v_mul_f32 v29, v29, v44
    v_mul_f32 v30, v30, v44
    v_mul_f32 v31, v31, v44
    v_cvt_pk_bf16_f32 v46, v28, v29
    v_cvt_pk_bf16_f32 v47, v30, v31
    v_bfi_b32 v76, v220, 0, v46
    v_and_b32 v78, v220, v46
    v_bfi_b32 v77, v221, 0, v47
    v_and_b32 v79, v221, v47
    s_nop 1
    v_mfma_f32_16x16x32_bf16 v[12:15], v[234:237], v[76:79], 0
    v_mfma_f32_16x16x32_bf16 v[60:63], v[244:247], v[76:79], 0
    s_nop 6
    v_cvt_pk_bf16_f32 v44, v12, v13
    v_cvt_pk_bf16_f32 v45, v14, v15
    v_cvt_pk_bf16_f32 v46, v60, v61
    v_cvt_pk_bf16_f32 v47, v62, v63
    s_nop 0
    v_permlane16_swap_b32 v44, v46
    v_permlane16_swap_b32 v45, v47
    buffer_store_dwordx4 v[44:47], v223, s[4:7], s45 offen sc1
    s_branch b_cons
hx_late_2:
    s_waitcnt vmcnt(3)
    v_cmp_ne_u32 vcc, s44, v178
    v_cmp_ne_u32 s[98:99], s44, v182
    s_nop 0
    s_or_b64 vcc, vcc, s[98:99]
    s_cbranch_vccnz hx_spin_6
    v_mov_b32 v112, v176
    v_mov_b32 v113, v177
    v_mov_b32 v200, v180
    v_mov_b32 v201, v181
    s_branch hx_ok_4
hx_spin_6:
    s_mov_b32 s63, 0
hx_loop_3:
    buffer_load_dwordx4 v[112:115], v4, s[4:7], s17 offen sc1
    buffer_load_dwordx4 v[200:203], v4, s[4:7], s17 offen offset:1024 sc1
    s_waitcnt vmcnt(0)
    v_cmp_ne_u32 vcc, s44, v114
    v_cmp_ne_u32 s[98:99], s44, v202
    s_nop 0
    s_or_b64 vcc, vcc, s[98:99]
    s_cbranch_vccz hx_ok_4
    s_add_u32 s63, s63, 1
    s_cmp_lt_u32 s63, 20000
    s_cbranch_scc1 hx_loop_3
    v_mov_b32 v114, 0x120
    s_mov_b32 s63, 16
    buffer_store_dword v114, off, s[24:27], s63
    s_waitcnt vmcnt(0)
    s_branch hx_ok_4
hx_zero_1:
    s_waitcnt vmcnt(3)
    v_mov_b32 v112, 0
    v_mov_b32 v113, 0
    v_mov_b32 v114, 0
    v_mov_b32 v115, 0
    v_mov_b32 v234, 0
    v_mov_b32 v235, 0
    v_mov_b32 v244, 0
    v_mov_b32 v245, 0
    s_branch hx_go_5
a_cons_p1:
    s_cmp_lg_u32 s42, 0
    s_cbranch_scc1 a_nozero_p1
    v_mov_b32 v12, 0
    v_mov_b32 v13, 0
    v_mov_b32 v14, 0
    v_mov_b32 v15, 0
    v_mov_b32 v16, 0
    v_mov_b32 v17, 0
    v_mov_b32 v18, 0
    v_mov_b32 v19, 0
    v_mov_b32 v20, 0
    v_mov_b32 v21, 0
    v_mov_b32 v22, 0
    v_mov_b32 v23, 0
    v_mov_b32 v24, 0
    v_mov_b32 v25, 0
    v_mov_b32 v26, 0
    v_mov_b32 v27, 0
    v_mov_b32 v28, 0
    v_mov_b32 v29, 0
    v_mov_b32 v30, 0
    v_mov_b32 v31, 0
    v_mov_b32 v32, 0
    v_mov_b32 v33, 0
    v_mov_b32 v34, 0
    v_mov_b32 v35, 0
    v_mov_b32 v36, 0
    v_mov_b32 v37, 0
    v_mov_b32 v38, 0
    v_mov_b32 v39, 0
    v_mov_b32 v40, 0
    v_mov_b32 v41, 0
    v_mov_b32 v42, 0
    v_mov_b32 v43, 0
    v_mov_b32 v44, 0
    v_mov_b32 v45, 0
    v_mov_b32 v46, 0
    v_mov_b32 v47, 0
    v_mov_b32 v48, 0
    v_mov_b32 v49, 0
    v_mov_b32 v50, 0
    v_mov_b32 v51, 0
    v_mov_b32 v52, 0
    v_mov_b32 v53, 0
    v_mov_b32 v54, 0
    v_mov_b32 v55, 0
    v_mov_b32 v56, 0
    v_mov_b32 v57, 0
    v_mov_b32 v58, 0
    v_mov_b32 v59, 0
    v_mov_b32 v60, 0
    v_mov_b32 v61, 0
    v_mov_b32 v62, 0
    v_mov_b32 v63, 0
    v_mov_b32 v64, 0
    v_mov_b32 v65, 0
    v_mov_b32 v66, 0
    v_mov_b32 v67, 0
    v_mov_b32 v68, 0
    v_mov_b32 v69, 0
    v_mov_b32 v70, 0
    v_mov_b32 v71, 0
    v_mov_b32 v72, 0
    v_mov_b32 v73, 0
    v_mov_b32 v74, 0
    v_mov_b32 v75, 0
    v_mov_b32 v76, 0
    v_mov_b32 v77, 0
    v_mov_b32 v78, 0
    v_mov_b32 v79, 0
    v_mov_b32 v80, 0
    v_mov_b32 v81, 0
    v_mov_b32 v82, 0
    v_mov_b32 v83, 0
    v_mov_b32 v84, 0
    v_mov_b32 v85, 0
    v_mov_b32 v86, 0
    v_mov_b32 v87, 0
    v_mov_b32 v88, 0
    v_mov_b32 v89, 0
    v_mov_b32 v90, 0
    v_mov_b32 v91, 0
    v_mov_b32 v92, 0
    v_mov_b32 v93, 0
    v_mov_b32 v94, 0
    v_mov_b32 v95, 0
    v_mov_b32 v96, 0
    v_mov_b32 v97, 0
    v_mov_b32 v98, 0
    v_mov_b32 v99, 0
    v_mov_b32 v100, 0
    v_mov_b32 v101, 0
    v_mov_b32 v102, 0
    v_mov_b32 v103, 0
    v_mov_b32 v104, 0
    v_mov_b32 v105, 0
    v_mov_b32 v106, 0
    v_mov_b32 v107, 0
a_nozero_p1:
    s_mov_b32 s58, 0
    s_mov_b32 s59, 55296
    v_mov_b32 v1, v10
    v_mov_b32 v254, v11
    v_add_u32 v2, s59, v5
    v_add_u32 v3, s59, v6
    s_mov_b32 s60, 0
    s_cmp_eq_u32 s42, 0
    s_cbranch_scc1 a_first_p1
    s_waitcnt lgkmcnt(0)
    s_barrier
    ds_read_b64_tr_b16 v[116:117], v2 offset:0
    ds_read_b64_tr_b16 v[118:119], v2 offset:512
    ds_read_b128 v[140:143], v1 offset:8192
    ds_read_b128 v[144:147], v1 offset:10240
    ds_read_b128 v[148:151], v1 offset:12288
    ds_read_b128 v[152:155], v1 offset:14336
    ds_read_b64_tr_b16 v[120:121], v3 offset:0
    ds_read_b64_tr_b16 v[122:123], v3 offset:512
    ds_read_b64_tr_b16 v[124:125], v2 offset:8192
    ds_read_b64_tr_b16 v[126:127], v2 offset:8704
    ds_read_b64_tr_b16 v[128:129], v3 offset:8192
    ds_read_b64_tr_b16 v[130:131], v3 offset:8704
    ds_read_b64_tr_b16 v[132:133], v2 offset:16384
    ds_read_b64_tr_b16 v[134:135], v2 offset:16896
    ds_read_b64_tr_b16 v[136:137], v3 offset:16384
    ds_read_b64_tr_b16 v[138:139], v3 offset:16896
    s_waitcnt lgkmcnt(0)
    v_mfma_f32_16x16x32_bf16 v[12:15], v[116:119], v[140:143], 0
    ds_read_b64_tr_b16 v[160:161], v2 offset:4096
    v_mfma_f32_16x16x32_bf16 v[16:19], v[116:119], v[144:147], 0
    ds_read_b64_tr_b16 v[162:163], v2 offset:4608
    v_mfma_f32_16x16x32_bf16 v[20:23], v[116:119], v[148:151], 0
    ds_read_b128 v[184:187], v254 offset:8192
    v_mfma_f32_16x16x32_bf16 v[24:27], v[116:119], v[152:155], 0
    ds_read_b128 v[188:191], v254 offset:10240
    v_mfma_f32_16x16x32_bf16 v[28:31], v[120:123], v[140:143], 0
    ds_read_b128 v[192:195], v254 offset:12288
    v_mfma_f32_16x16x32_bf16 v[32:35], v[120:123], v[144:147], 0
    ds_read_b128 v[196:199], v254 offset:14336
    v_mfma_f32_16x16x32_bf16 v[36:39], v[120:123], v[148:151], 0
    ds_read_b64_tr_b16 v[164:165], v3 offset:4096
    v_mfma_f32_16x16x32_bf16 v[40:43], v[120:123], v[152:155], 0
    ds_read_b64_tr_b16 v[166:167], v3 offset:4608
    v_mfma_f32_16x16x32_bf16 v[44:47], v[124:127], v[140:143], 0
    ds_read_b64_tr_b16 v[168:169], v2 offset:12288
    v_mfma_f32_16x16x32_bf16 v[48:51], v[124:127], v[144:147], 0
    ds_read_b64_tr_b16 v[170:171], v2 offset:12800
    v_mfma_f32_16x16x32_bf16 v[52:55], v[124:127], v[148:151], 0
    ds_read_b64_tr_b16 v[172:173], v3 offset:12288
    v_mfma_f32_16x16x32_bf16 v[56:59], v[124:127], v[152:155], 0
    ds_read_b64_tr_b16 v[174:175], v3 offset:12800
    v_mfma_f32_16x16x32_bf16 v[60:63], v[128:131], v[140:143], 0
    ds_read_b64_tr_b16 v[176:177], v2 offset:20480
    v_mfma_f32_16x16x32_bf16 v[64:67], v[128:131], v[144:147], 0
    ds_read_b64_tr_b16 v[178:179], v2 offset:20992
    v_mfma_f32_16x16x32_bf16 v[68:71], v[128:131], v[148:151], 0
    ds_read_b64_tr_b16 v[180:181], v3 offset:20480
    v_mfma_f32_16x16x32_bf16 v[72:75], v[128:131], v[152:155], 0
    ds_read_b64_tr_b16 v[182:183], v3 offset:20992
    v_mfma_f32_16x16x32_bf16 v[76:79], v[140:143], v[132:135], 0
    s_add_u32 s58, s58, 18432
    v_mfma_f32_16x16x32_bf16 v[80:83], v[144:147], v[132:135], 0
    s_add_u32 s59, s59, 24576
    v_mfma_f32_16x16x32_bf16 v[84:87], v[148:151], v[132:135], 0
    s_cmp_eq_u32 s58, 55296
    v_mfma_f32_16x16x32_bf16 v[88:91], v[152:155], v[132:135], 0
    s_cselect_b32 s58, 0, s58
    v_mfma_f32_16x16x32_bf16 v[92:95], v[140:143], v[136:139], 0
    s_cmp_eq_u32 s59, 153600
    v_mfma_f32_16x16x32_bf16 v[96:99], v[144:147], v[136:139], 0
    s_cselect_b32 s59, 55296, s59
    v_mfma_f32_16x16x32_bf16 v[100:103], v[148:151], v[136:139], 0
    v_add_u32 v1, s58, v10
    v_mfma_f32_16x16x32_bf16 v[104:107], v[152:155], v[136:139], 0
    v_add_u32 v254, s58, v11
    v_add_u32 v2, s59, v5
    v_add_u32 v3, s59, v6
    s_waitcnt lgkmcnt(0)
    v_mfma_f32_16x16x32_bf16 v[12:15], v[160:163], v[184:187], v[12:15]
    v_mfma_f32_16x16x32_bf16 v[16:19], v[160:163], v[188:191], v[16:19]
    v_mfma_f32_16x16x32_bf16 v[20:23], v[160:163], v[192:195], v[20:23]
    v_mfma_f32_16x16x32_bf16 v[24:27], v[160:163], v[196:199], v[24:27]
    v_mfma_f32_16x16x32_bf16 v[28:31], v[164:167], v[184:187], v[28:31]
    v_mfma_f32_16x16x32_bf16 v[32:35], v[164:167], v[188:191], v[32:35]
    v_mfma_f32_16x16x32_bf16 v[36:39], v[164:167], v[192:195], v[36:39]
    v_mfma_f32_16x16x32_bf16 v[40:43], v[164:167], v[196:199], v[40:43]
    v_mfma_f32_16x16x32_bf16 v[44:47], v[168:171], v[184:187], v[44:47]
    v_mfma_f32_16x16x32_bf16 v[48:51], v[168:171], v[188:191], v[48:51]
    v_mfma_f32_16x16x32_bf16 v[52:55], v[168:171], v[192:195], v[52:55]
    v_mfma_f32_16x16x32_bf16 v[56:59], v[168:171], v[196:199], v[56:59]
    v_mfma_f32_16x16x32_bf16 v[60:63], v[172:175], v[184:187], v[60:63]
    v_mfma_f32_16x16x32_bf16 v[64:67], v[172:175], v[188:191], v[64:67]
    v_mfma_f32_16x16x32_bf16 v[68:71], v[172:175], v[192:195], v[68:71]
    v_mfma_f32_16x16x32_bf16 v[72:75], v[172:175], v[196:199], v[72:75]
    v_mfma_f32_16x16x32_bf16 v[76:79], v[184:187], v[176:179], v[76:79]
    v_mfma_f32_16x16x32_bf16 v[80:83], v[188:191], v[176:179], v[80:83]
    v_mfma_f32_16x16x32_bf16 v[84:87], v[192:195], v[176:179], v[84:87]
    v_mfma_f32_16x16x32_bf16 v[88:91], v[196:199], v[176:179], v[88:91]
    v_mfma_f32_16x16x32_bf16 v[92:95], v[184:187], v[180:183], v[92:95]
    v_mfma_f32_16x16x32_bf16 v[96:99], v[188:191], v[180:183], v[96:99]
    v_mfma_f32_16x16x32_bf16 v[100:103], v[192:195], v[180:183], v[100:103]
    v_mfma_f32_16x16x32_bf16 v[104:107], v[196:199], v[180:183], v[104:107]
    s_barrier
    ds_read_b64_tr_b16 v[116:117], v2 offset:0
    ds_read_b64_tr_b16 v[118:119], v2 offset:512
    ds_read_b128 v[140:143], v1 offset:8192
    ds_read_b128 v[144:147], v1 offset:10240
    ds_read_b128 v[148:151], v1 offset:12288
    ds_read_b128 v[152:155], v1 offset:14336
    ds_read_b64_tr_b16 v[120:121], v3 offset:0
    ds_read_b64_tr_b16 v[122:123], v3 offset:512
    ds_read_b64_tr_b16 v[124:125], v2 offset:8192
    ds_read_b64_tr_b16 v[126:127], v2 offset:8704
    ds_read_b64_tr_b16 v[128:129], v3 offset:8192
    ds_read_b64_tr_b16 v[130:131], v3 offset:8704
    ds_read_b64_tr_b16 v[132:133], v2 offset:16384
    ds_read_b64_tr_b16 v[134:135], v2 offset:16896
    ds_read_b64_tr_b16 v[136:137], v3 offset:16384
    ds_read_b64_tr_b16 v[138:139], v3 offset:16896
    s_waitcnt lgkmcnt(0)
    s_mov_b32 s60, 1
    s_branch ac_loop_p1
a_first_p1:
    s_barrier
    ds_read_b64_tr_b16 v[116:117], v2 offset:0
    ds_read_b64_tr_b16 v[118:119], v2 offset:512
    ds_read_b128 v[140:143], v1 offset:8192
    ds_read_b128 v[144:147], v1 offset:10240
    ds_read_b128 v[148:151], v1 offset:12288
    ds_read_b128 v[152:155], v1 offset:14336
    ds_read_b64_tr_b16 v[120:121], v3 offset:0
    ds_read_b64_tr_b16 v[122:123], v3 offset:512
    ds_read_b64_tr_b16 v[124:125], v2 offset:8192
    ds_read_b64_tr_b16 v[126:127], v2 offset:8704
    ds_read_b64_tr_b16 v[128:129], v3 offset:8192
    ds_read_b64_tr_b16 v[130:131], v3 offset:8704
    ds_read_b64_tr_b16 v[132:133], v2 offset:16384
    ds_read_b64_tr_b16 v[134:135], v2 offset:16896
    ds_read_b64_tr_b16 v[136:137], v3 offset:16384
    ds_read_b64_tr_b16 v[138:139], v3 offset:16896
    s_waitcnt lgkmcnt(0)
ac_loop_p1:
    v_mfma_f32_16x16x32_bf16 v[12:15], v[116:119], v[140:143], v[12:15]
    ds_read_b64_tr_b16 v[160:161], v2 offset:4096
    v_mfma_f32_16x16x32_bf16 v[16:19], v[116:119], v[144:147], v[16:19]
    ds_read_b64_tr_b16 v[162:163], v2 offset:4608
    v_mfma_f32_16x16x32_bf16 v[20:23], v[116:119], v[148:151], v[20:23]
    ds_read_b128 v[184:187], v254 offset:8192
    v_mfma_f32_16x16x32_bf16 v[24:27], v[116:119], v[152:155], v[24:27]
    ds_read_b128 v[188:191], v254 offset:10240
    v_mfma_f32_16x16x32_bf16 v[28:31], v[120:123], v[140:143], v[28:31]
    ds_read_b128 v[192:195], v254 offset:12288
    v_mfma_f32_16x16x32_bf16 v[32:35], v[120:123], v[144:147], v[32:35]
    ds_read_b128 v[196:199], v254 offset:14336
    v_mfma_f32_16x16x32_bf16 v[36:39], v[120:123], v[148:151], v[36:39]
    ds_read_b64_tr_b16 v[164:165], v3 offset:4096
    v_mfma_f32_16x16x32_bf16 v[40:43], v[120:123], v[152:155], v[40:43]
    ds_read_b64_tr_b16 v[166:167], v3 offset:4608
    v_mfma_f32_16x16x32_bf16 v[44:47], v[124:127], v[140:143], v[44:47]
    ds_read_b64_tr_b16 v[168:169], v2 offset:12288
    v_mfma_f32_16x16x32_bf16 v[48:51], v[124:127], v[144:147], v[48:51]
    ds_read_b64_tr_b16 v[170:171], v2 offset:12800
    v_mfma_f32_16x16x32_bf16 v[52:55], v[124:127], v[148:151], v[52:55]
    ds_read_b64_tr_b16 v[172:173], v3 offset:12288
    v_mfma_f32_16x16x32_bf16 v[56:59], v[124:127], v[152:155], v[56:59]
    ds_read_b64_tr_b16 v[174:175], v3 offset:12800
    v_mfma_f32_16x16x32_bf16 v[60:63], v[128:131], v[140:143], v[60:63]
    ds_read_b64_tr_b16 v[176:177], v2 offset:20480
    v_mfma_f32_16x16x32_bf16 v[64:67], v[128:131], v[144:147], v[64:67]
    ds_read_b64_tr_b16 v[178:179], v2 offset:20992
    v_mfma_f32_16x16x32_bf16 v[68:71], v[128:131], v[148:151], v[68:71]
    ds_read_b64_tr_b16 v[180:181], v3 offset:20480
    v_mfma_f32_16x16x32_bf16 v[72:75], v[128:131], v[152:155], v[72:75]
    ds_read_b64_tr_b16 v[182:183], v3 offset:20992
    v_mfma_f32_16x16x32_bf16 v[76:79], v[140:143], v[132:135], v[76:79]
    s_add_u32 s58, s58, 18432
    v_mfma_f32_16x16x32_bf16 v[80:83], v[144:147], v[132:135], v[80:83]
    s_add_u32 s59, s59, 24576
    v_mfma_f32_16x16x32_bf16 v[84:87], v[148:151], v[132:135], v[84:87]
    s_cmp_eq_u32 s58, 55296
    v_mfma_f32_16x16x32_bf16 v[88:91], v[152:155], v[132:135], v[88:91]
    s_cselect_b32 s58, 0, s58
    v_mfma_f32_16x16x32_bf16 v[92:95], v[140:143], v[136:139], v[92:95]
    s_cmp_eq_u32 s59, 153600
    v_mfma_f32_16x16x32_bf16 v[96:99], v[144:147], v[136:139], v[96:99]
    s_cselect_b32 s59, 55296, s59
    v_mfma_f32_16x16x32_bf16 v[100:103], v[148:151], v[136:139], v[100:103]
    v_add_u32 v1, s58, v10
    v_mfma_f32_16x16x32_bf16 v[104:107], v[152:155], v[136:139], v[104:107]
    v_add_u32 v254, s58, v11
    v_add_u32 v2, s59, v5
    v_add_u32 v3, s59, v6
    s_waitcnt lgkmcnt(0)
    s_barrier
    v_mfma_f32_16x16x32_bf16 v[12:15], v[160:163], v[184:187], v[12:15]
    ds_read_b64_tr_b16 v[116:117], v2 offset:0
    v_mfma_f32_16x16x32_bf16 v[16:19], v[160:163], v[188:191], v[16:19]
    ds_read_b64_tr_b16 v[118:119], v2 offset:512
    v_mfma_f32_16x16x32_bf16 v[20:23], v[160:163], v[192:195], v[20:23]
    ds_read_b128 v[140:143], v1 offset:8192
    v_mfma_f32_16x16x32_bf16 v[24:27], v[160:163], v[196:199], v[24:27]
    ds_read_b128 v[144:147], v1 offset:10240
    v_mfma_f32_16x16x32_bf16 v[28:31], v[164:167], v[184:187], v[28:31]
    ds_read_b128 v[148:151], v1 offset:12288
    v_mfma_f32_16x16x32_bf16 v[32:35], v[164:167], v[188:191], v[32:35]
    ds_read_b128 v[152:155], v1 offset:14336
    v_mfma_f32_16x16x32_bf16 v[36:39], v[164:167], v[192:195], v[36:39]
    ds_read_b64_tr_b16 v[120:121], v3 offset:0
    v_mfma_f32_16x16x32_bf16 v[40:43], v[164:167], v[196:199], v[40:43]
    ds_read_b64_tr_b16 v[122:123], v3 offset:512
    v_mfma_f32_16x16x32_bf16 v[44:47], v[168:171], v[184:187], v[44:47]
    ds_read_b64_tr_b16 v[124:125], v2 offset:8192
    v_mfma_f32_16x16x32_bf16 v[48:51], v[168:171], v[188:191], v[48:51]
    ds_read_b64_tr_b16 v[126:127], v2 offset:8704
    v_mfma_f32_16x16x32_bf16 v[52:55], v[168:171], v[192:195], v[52:55]
    ds_read_b64_tr_b16 v[128:129], v3 offset:8192
    v_mfma_f32_16x16x32_bf16 v[56:59], v[168:171], v[196:199], v[56:59]
    ds_read_b64_tr_b16 v[130:131], v3 offset:8704
    v_mfma_f32_16x16x32_bf16 v[60:63], v[172:175], v[184:187], v[60:63]
    ds_read_b64_tr_b16 v[132:133], v2 offset:16384
    v_mfma_f32_16x16x32_bf16 v[64:67], v[172:175], v[188:191], v[64:67]
    ds_read_b64_tr_b16 v[134:135], v2 offset:16896
    v_mfma_f32_16x16x32_bf16 v[68:71], v[172:175], v[192:195], v[68:71]
    ds_read_b64_tr_b16 v[136:137], v3 offset:16384
    v_mfma_f32_16x16x32_bf16 v[72:75], v[172:175], v[196:199], v[72:75]
    ds_read_b64_tr_b16 v[138:139], v3 offset:16896
    v_mfma_f32_16x16x32_bf16 v[76:79], v[184:187], v[176:179], v[76:79]
    s_cmp_eq_u32 s60, s55
    v_mfma_f32_16x16x32_bf16 v[80:83], v[188:191], v[176:179], v[80:83]
    s_cbranch_scc1 a_flag_p1
a_flag_back_p1:
    v_mfma_f32_16x16x32_bf16 v[84:87], v[192:195], v[176:179], v[84:87]
    s_add_u32 s60, s60, 1
    v_mfma_f32_16x16x32_bf16 v[88:91], v[196:199], v[176:179], v[88:91]
    s_cmp_lt_u32 s60, 15
    v_mfma_f32_16x16x32_bf16 v[92:95], v[184:187], v[180:183], v[92:95]
    v_mfma_f32_16x16x32_bf16 v[96:99], v[188:191], v[180:183], v[96:99]
    v_mfma_f32_16x16x32_bf16 v[100:103], v[192:195], v[180:183], v[100:103]
    v_mfma_f32_16x16x32_bf16 v[104:107], v[196:199], v[180:183], v[104:107]
    s_waitcnt lgkmcnt(0)
    s_cbranch_scc1 ac_loop_p1
    s_branch a_last_p1
a_flag_p1:
    s_waitcnt vmcnt(0)
    v_mov_b32 v7, s44
    s_mov_b64 exec, 1
    buffer_store_dword v7, off, s[4:7], s50 sc1
    s_mov_b64 exec, -1
    s_branch a_flag_back_p1
a_last_p1:
    v_mfma_f32_16x16x32_bf16 v[12:15], v[116:119], v[140:143], v[12:15]
    ds_read_b64_tr_b16 v[160:161], v2 offset:4096
    v_mfma_f32_16x16x32_bf16 v[16:19], v[116:119], v[144:147], v[16:19]
    ds_read_b64_tr_b16 v[162:163], v2 offset:4608
    v_mfma_f32_16x16x32_bf16 v[20:23], v[116:119], v[148:151], v[20:23]
    ds_read_b128 v[184:187], v254 offset:8192
    v_mfma_f32_16x16x32_bf16 v[24:27], v[116:119], v[152:155], v[24:27]
    ds_read_b128 v[188:191], v254 offset:10240
    v_mfma_f32_16x16x32_bf16 v[28:31], v[120:123], v[140:143], v[28:31]
    ds_read_b128 v[192:195], v254 offset:12288
    v_mfma_f32_16x16x32_bf16 v[32:35], v[120:123], v[144:147], v[32:35]
    ds_read_b128 v[196:199], v254 offset:14336
    v_mfma_f32_16x16x32_bf16 v[36:39], v[120:123], v[148:151], v[36:39]
    ds_read_b64_tr_b16 v[164:165], v3 offset:4096
    v_mfma_f32_16x16x32_bf16 v[40:43], v[120:123], v[152:155], v[40:43]
    ds_read_b64_tr_b16 v[166:167], v3 offset:4608
    v_mfma_f32_16x16x32_bf16 v[44:47], v[124:127], v[140:143], v[44:47]
    ds_read_b64_tr_b16 v[168:169], v2 offset:12288
    v_mfma_f32_16x16x32_bf16 v[48:51], v[124:127], v[144:147], v[48:51]
    ds_read_b64_tr_b16 v[170:171], v2 offset:12800
    v_mfma_f32_16x16x32_bf16 v[52:55], v[124:127], v[148:151], v[52:55]
    ds_read_b64_tr_b16 v[172:173], v3 offset:12288
    v_mfma_f32_16x16x32_bf16 v[56:59], v[124:127], v[152:155], v[56:59]
    ds_read_b64_tr_b16 v[174:175], v3 offset:12800
    v_mfma_f32_16x16x32_bf16 v[60:63], v[128:131], v[140:143], v[60:63]
    ds_read_b64_tr_b16 v[176:177], v2 offset:20480
    v_mfma_f32_16x16x32_bf16 v[64:67], v[128:131], v[144:147], v[64:67]
    ds_read_b64_tr_b16 v[178:179], v2 offset:20992
    v_mfma_f32_16x16x32_bf16 v[68:71], v[128:131], v[148:151], v[68:71]
    ds_read_b64_tr_b16 v[180:181], v3 offset:20480
    v_mfma_f32_16x16x32_bf16 v[72:75], v[128:131], v[152:155], v[72:75]
    ds_read_b64_tr_b16 v[182:183], v3 offset:20992
    v_mfma_f32_16x16x32_bf16 v[76:79], v[140:143], v[132:135], v[76:79]
    v_mov_b32 v110, s44
    v_mfma_f32_16x16x32_bf16 v[80:83], v[144:147], v[132:135], v[80:83]
    v_mov_b32 v111, s44
    v_mfma_f32_16x16x32_bf16 v[84:87], v[148:151], v[132:135], v[84:87]
    v_mov_b32 v202, s44
    v_mfma_f32_16x16x32_bf16 v[88:91], v[152:155], v[132:135], v[88:91]
    v_mov_b32 v203, s44
    v_mfma_f32_16x16x32_bf16 v[92:95], v[140:143], v[136:139], v[92:95]
    v_mfma_f32_16x16x32_bf16 v[96:99], v[144:147], v[136:139], v[96:99]
    v_mfma_f32_16x16x32_bf16 v[100:103], v[148:151], v[136:139], v[100:103]
    v_mfma_f32_16x16x32_bf16 v[104:107], v[152:155], v[136:139], v[104:107]
    s_and_b32 s45, s42, 1
    s_lshl_b32 s45, s45, 10
    s_lshl_b32 s46, s41, 7
    s_add_u32 s45, s45, s46
    s_add_u32 s45, s45, 159744
    v_lshlrev_b32 v1, 2, v233
    v_and_b32 v2, 0x30, v9
    v_add_u32 v3, s45, v2
    v_add_u32 v7, s45, v1
    v_add_u32 v1, 157696, v1
    v_add_u32 v2, 157696, v2
    s_waitcnt lgkmcnt(0)
    s_barrier
    v_mfma_f32_16x16x32_bf16 v[56:59], v[168:171], v[196:199], v[56:59]
    ds_read_b128 v[136:139], v3 offset:256
    ds_read_b128 v[140:143], v3 offset:320
    s_lshl_b32 s45, s42, 21
    s_lshl_b32 s49, s37, 13
    v_mfma_f32_16x16x32_bf16 v[72:75], v[172:175], v[196:199], v[72:75]
    ds_read_b32 v122, v1 offset:448
    ds_read_b32 v123, v1 offset:1472
    s_add_u32 s45, s45, s49
    v_mfma_f32_16x16x32_bf16 v[88:91], v[196:199], v[176:179], v[88:91]
    ds_read_b32 v126, v7 offset:512
    ds_read_b32 v127, v7 offset:576
    s_lshl_b32 s49, s40, 11
    s_add_u32 s45, s45, s49
    v_mfma_f32_16x16x32_bf16 v[104:107], v[196:199], v[180:183], v[104:107]
    ds_read_b128 v[144:147], v2 offset:448
    ds_read_b128 v[148:151], v2 offset:1472
    s_add_u32 s45, s45, 58720256
    v_mfma_f32_16x16x32_bf16 v[12:15], v[160:163], v[184:187], v[12:15]
    ds_read_b32 v116, v1 offset:256
    ds_read_b32 v117, v1 offset:1280
    s_lshl_b32 s49, s36, 17
    v_mfma_f32_16x16x32_bf16 v[16:19], v[160:163], v[188:191], v[16:19]
    ds_read_b32 v118, v1 offset:320
    ds_read_b32 v119, v1 offset:1344
    s_add_u32 s16, s45, s49
    s_max_u32 s49, s49, 131072
    v_mfma_f32_16x16x32_bf16 v[20:23], v[160:163], v[192:195], v[20:23]
    ds_read_b32 v120, v1 offset:384
    ds_read_b32 v121, v1 offset:1408
    s_sub_u32 s49, s49, 131072
    v_mfma_f32_16x16x32_bf16 v[24:27], v[160:163], v[196:199], v[24:27]
    ds_read_b128 v[152:155], v2 offset:256
    ds_read_b128 v[156:159], v2 offset:1280
    s_add_u32 s17, s45, s49
    v_mfma_f32_16x16x32_bf16 v[28:31], v[164:167], v[184:187], v[28:31]
    ds_read_b128 v[128:131], v3 offset:0
    ds_read_b128 v[132:135], v3 offset:64
    v_mfma_f32_16x16x32_bf16 v[32:35], v[164:167], v[188:191], v[32:35]
    s_waitcnt lgkmcnt(10)
    v_pk_fma_f32 v[56:57], v[136:137], v[122:123], v[56:57] op_sel_hi:[1,0,1]
    v_pk_fma_f32 v[88:89], v[144:145], v[126:127], v[88:89] op_sel_hi:[1,0,1]
    v_pk_fma_f32 v[72:73], v[140:141], v[122:123], v[72:73] op_sel_hi:[1,0,1]
    v_mfma_f32_16x16x32_bf16 v[36:39], v[164:167], v[192:195], v[36:39]
    v_pk_fma_f32 v[104:105], v[126:127], v[144:145], v[104:105] op_sel:[1,0,0] op_sel_hi:[1,1,1]
    v_pk_fma_f32 v[58:59], v[138:139], v[122:123], v[58:59] op_sel_hi:[1,0,1]
    v_mfma_f32_16x16x32_bf16 v[40:43], v[164:167], v[196:199], v[40:43]
    v_pk_fma_f32 v[90:91], v[146:147], v[126:127], v[90:91] op_sel_hi:[1,0,1]
    v_pk_fma_f32 v[74:75], v[142:143], v[122:123], v[74:75] op_sel_hi:[1,0,1]
    v_pk_fma_f32 v[106:107], v[126:127], v[146:147], v[106:107] op_sel:[1,0,0] op_sel_hi:[1,1,1]
    v_mfma_f32_16x16x32_bf16 v[44:47], v[168:171], v[184:187], v[44:47]
    v_pk_mul_f32 v[56:57], v[122:123], v[56:57] op_sel:[1,0] op_sel_hi:[1,1]
    v_pk_mul_f32 v[88:89], v[88:89], v[148:149]
    v_mfma_f32_16x16x32_bf16 v[48:51], v[168:171], v[188:191], v[48:51]
    v_pk_mul_f32 v[72:73], v[122:123], v[72:73] op_sel:[1,0] op_sel_hi:[1,1]
    v_pk_mul_f32 v[104:105], v[104:105], v[148:149]
    v_mfma_f32_16x16x32_bf16 v[52:55], v[168:171], v[192:195], v[52:55]
    v_pk_mul_f32 v[58:59], v[122:123], v[58:59] op_sel:[1,0] op_sel_hi:[1,1]
    v_pk_mul_f32 v[90:91], v[90:91], v[150:151]
    v_pk_mul_f32 v[74:75], v[122:123], v[74:75] op_sel:[1,0] op_sel_hi:[1,1]
    v_mfma_f32_16x16x32_bf16 v[60:63], v[172:175], v[184:187], v[60:63]
    v_pk_mul_f32 v[106:107], v[106:107], v[150:151]
    v_cvt_pk_bf16_f32 v56, v56, v57
    v_mfma_f32_16x16x32_bf16 v[64:67], v[172:175], v[188:191], v[64:67]
    v_cvt_pk_bf16_f32 v242, v88, v89
    v_cvt_pk_bf16_f32 v57, v58, v59
    v_cvt_pk_bf16_f32 v252, v104, v105
    v_mfma_f32_16x16x32_bf16 v[68:71], v[172:175], v[192:195], v[68:71]
    v_cvt_pk_bf16_f32 v58, v72, v73
    v_cvt_pk_bf16_f32 v243, v90, v91
    v_mfma_f32_16x16x32_bf16 v[76:79], v[184:187], v[176:179], v[76:79]
    v_cvt_pk_bf16_f32 v59, v74, v75
    v_cvt_pk_bf16_f32 v253, v106, v107
    v_mfma_f32_16x16x32_bf16 v[80:83], v[188:191], v[176:179], v[80:83]
    v_mov_b32 v108, v56
    v_mov_b32 v124, v252
    v_mov_b32 v109, v57
    v_mfma_f32_16x16x32_bf16 v[84:87], v[192:195], v[176:179], v[84:87]
    v_mov_b32 v200, v242
    v_mov_b32 v125, v253
    v_mfma_f32_16x16x32_bf16 v[92:95], v[184:187], v[180:183], v[92:95]
    v_mov_b32_dpp v108, v58 row_ror:8 row_mask:0xf bank_mask:0x3
    v_mov_b32 v201, v243
    v_mov_b32_dpp v109, v59 row_ror:8 row_mask:0xf bank_mask:0x3
    v_mfma_f32_16x16x32_bf16 v[96:99], v[188:191], v[180:183], v[96:99]
    buffer_store_dwordx4 v[108:111], v4, s[4:7], s16 offen sc1
    v_permlane32_swap_b32 v124, v200
    v_mfma_f32_16x16x32_bf16 v[100:103], v[192:195], v[180:183], v[100:103]
    v_permlane32_swap_b32 v125, v201
    buffer_store_dwordx4 v[200:203], v4, s[4:7], s16 offen offset:1024 sc1
    ds_read_b128 v[160:163], v2 offset:320
    ds_read_b128 v[164:167], v2 offset:1344
    ds_read_b128 v[168:171], v2 offset:384
    ds_read_b128 v[172:175], v2 offset:1408
    s_waitcnt lgkmcnt(4)
    v_pk_fma_f32 v[44:45], v[136:137], v[116:117], v[44:45] op_sel_hi:[1,0,1]
    v_pk_fma_f32 v[48:49], v[136:137], v[118:119], v[48:49] op_sel_hi:[1,0,1]
    v_pk_fma_f32 v[52:53], v[136:137], v[120:121], v[52:53] op_sel_hi:[1,0,1]
    v_pk_fma_f32 v[24:25], v[128:129], v[122:123], v[24:25] op_sel_hi:[1,0,1]
    v_pk_fma_f32 v[46:47], v[138:139], v[116:117], v[46:47] op_sel_hi:[1,0,1]
    v_pk_fma_f32 v[50:51], v[138:139], v[118:119], v[50:51] op_sel_hi:[1,0,1]
    v_pk_fma_f32 v[54:55], v[138:139], v[120:121], v[54:55] op_sel_hi:[1,0,1]
    v_pk_fma_f32 v[26:27], v[130:131], v[122:123], v[26:27] op_sel_hi:[1,0,1]
    v_pk_mul_f32 v[44:45], v[116:117], v[44:45] op_sel:[1,0] op_sel_hi:[1,1]
    v_pk_mul_f32 v[48:49], v[118:119], v[48:49] op_sel:[1,0] op_sel_hi:[1,1]
    v_pk_mul_f32 v[52:53], v[120:121], v[52:53] op_sel:[1,0] op_sel_hi:[1,1]
    v_pk_fma_f32 v[40:41], v[132:133], v[122:123], v[40:41] op_sel_hi:[1,0,1]
    v_pk_mul_f32 v[46:47], v[116:117], v[46:47] op_sel:[1,0] op_sel_hi:[1,1]
    v_pk_mul_f32 v[50:51], v[118:119], v[50:51] op_sel:[1,0] op_sel_hi:[1,1]
    v_pk_mul_f32 v[54:55], v[120:121], v[54:55] op_sel:[1,0] op_sel_hi:[1,1]
    v_pk_fma_f32 v[42:43], v[134:135], v[122:123], v[42:43] op_sel_hi:[1,0,1]
    v_pk_fma_f32 v[60:61], v[140:141], v[116:117], v[60:61] op_sel_hi:[1,0,1]
    v_pk_fma_f32 v[64:65], v[140:141], v[118:119], v[64:65] op_sel_hi:[1,0,1]
    v_pk_fma_f32 v[68:69], v[140:141], v[120:121], v[68:69] op_sel_hi:[1,0,1]
    v_cvt_pk_bf16_f32 v24, v24, v25
    v_pk_fma_f32 v[62:63], v[142:143], v[116:117], v[62:63] op_sel_hi:[1,0,1]
    v_pk_fma_f32 v[66:67], v[142:143], v[118:119], v[66:67] op_sel_hi:[1,0,1]
    v_pk_fma_f32 v[70:71], v[142:143], v[120:121], v[70:71] op_sel_hi:[1,0,1]
    v_cvt_pk_bf16_f32 v25, v26, v27
    v_pk_mul_f32 v[60:61], v[116:117], v[60:61] op_sel:[1,0] op_sel_hi:[1,1]
    v_pk_mul_f32 v[64:65], v[118:119], v[64:65] op_sel:[1,0] op_sel_hi:[1,1]
    v_pk_mul_f32 v[68:69], v[120:121], v[68:69] op_sel:[1,0] op_sel_hi:[1,1]
    v_cvt_pk_bf16_f32 v26, v40, v41
    v_pk_mul_f32 v[62:63], v[116:117], v[62:63] op_sel:[1,0] op_sel_hi:[1,1]
    v_pk_mul_f32 v[66:67], v[118:119], v[66:67] op_sel:[1,0] op_sel_hi:[1,1]
    v_pk_mul_f32 v[70:71], v[120:121], v[70:71] op_sel:[1,0] op_sel_hi:[1,1]
    v_cvt_pk_bf16_f32 v27, v42, v43
    v_cvt_pk_bf16_f32 v44, v44, v45
    v_cvt_pk_bf16_f32 v48, v48, v49
    v_cvt_pk_bf16_f32 v52, v52, v53
    v_mul_f32 v123, s54, v123
    v_cvt_pk_bf16_f32 v45, v46, v47
    v_cvt_pk_bf16_f32 v49, v50, v51
    v_cvt_pk_bf16_f32 v53, v54, v55
    v_cvt_pk_bf16_f32 v46, v60, v61
    v_cvt_pk_bf16_f32 v50, v64, v65
    v_cvt_pk_bf16_f32 v54, v68, v69
    v_cvt_pk_bf16_f32 v47, v62, v63
    v_cvt_pk_bf16_f32 v51, v66, v67
    v_cvt_pk_bf16_f32 v55, v70, v71
    v_pk_fma_f32 v[12:13], v[128:129], v[116:117], v[12:13] op_sel_hi:[1,0,1]
    v_pk_fma_f32 v[16:17], v[128:129], v[118:119], v[16:17] op_sel_hi:[1,0,1]
    v_pk_fma_f32 v[20:21], v[128:129], v[120:121], v[20:21] op_sel_hi:[1,0,1]
    v_pk_fma_f32 v[14:15], v[130:131], v[116:117], v[14:15] op_sel_hi:[1,0,1]
    v_pk_fma_f32 v[18:19], v[130:131], v[118:119], v[18:19] op_sel_hi:[1,0,1]
    v_pk_fma_f32 v[22:23], v[130:131], v[120:121], v[22:23] op_sel_hi:[1,0,1]
    v_pk_fma_f32 v[28:29], v[132:133], v[116:117], v[28:29] op_sel_hi:[1,0,1]
    v_pk_fma_f32 v[32:33], v[132:133], v[118:119], v[32:33] op_sel_hi:[1,0,1]
    v_pk_fma_f32 v[36:37], v[132:133], v[120:121], v[36:37] op_sel_hi:[1,0,1]
    v_pk_fma_f32 v[30:31], v[134:135], v[116:117], v[30:31] op_sel_hi:[1,0,1]
    v_pk_fma_f32 v[34:35], v[134:135], v[118:119], v[34:35] op_sel_hi:[1,0,1]
    v_pk_fma_f32 v[38:39], v[134:135], v[120:121], v[38:39] op_sel_hi:[1,0,1]
    v_cvt_pk_bf16_f32 v12, v12, v13
    v_cvt_pk_bf16_f32 v16, v16, v17
    v_cvt_pk_bf16_f32 v20, v20, v21
    v_cvt_pk_bf16_f32 v13, v14, v15
    v_cvt_pk_bf16_f32 v17, v18, v19
    v_cvt_pk_bf16_f32 v21, v22, v23
    v_cvt_pk_bf16_f32 v14, v28, v29
    v_cvt_pk_bf16_f32 v18, v32, v33
    v_cvt_pk_bf16_f32 v22, v36, v37
    v_cvt_pk_bf16_f32 v15, v30, v31
    v_cvt_pk_bf16_f32 v19, v34, v35
    v_cvt_pk_bf16_f32 v23, v38, v39
    v_mul_f32 v117, s54, v117
    v_mul_f32 v119, s54, v119
    v_mul_f32 v121, s54, v121
    buffer_load_dwordx4 v[112:115], v4, s[4:7], s17 offen sc1
    buffer_load_dwordx4 v[200:203], v4, s[4:7], s17 offen offset:1024 sc1
    s_waitcnt lgkmcnt(0)
    v_mfma_f32_16x16x32_bf16 v[60:63], v[44:47], v[12:15], 0
    v_pk_fma_f32 v[76:77], v[152:153], v[126:127], v[76:77] op_sel_hi:[1,0,1]
    v_pk_fma_f32 v[92:93], v[126:127], v[152:153], v[92:93] op_sel:[1,0,0] op_sel_hi:[1,1,1]
    v_mfma_f32_16x16x32_bf16 v[64:67], v[48:51], v[16:19], 0
    v_pk_fma_f32 v[80:81], v[160:161], v[126:127], v[80:81] op_sel_hi:[1,0,1]
    v_pk_fma_f32 v[96:97], v[126:127], v[160:161], v[96:97] op_sel:[1,0,0] op_sel_hi:[1,1,1]
    v_mfma_f32_16x16x32_bf16 v[68:71], v[52:55], v[20:23], 0
    v_pk_fma_f32 v[78:79], v[154:155], v[126:127], v[78:79] op_sel_hi:[1,0,1]
    v_pk_fma_f32 v[94:95], v[126:127], v[154:155], v[94:95] op_sel:[1,0,0] op_sel_hi:[1,1,1]
    v_mfma_f32_16x16x32_bf16 v[72:75], v[56:59], v[24:27], 0
    v_pk_fma_f32 v[82:83], v[162:163], v[126:127], v[82:83] op_sel_hi:[1,0,1]
    v_pk_fma_f32 v[98:99], v[126:127], v[162:163], v[98:99] op_sel:[1,0,0] op_sel_hi:[1,1,1]
    v_mfma_f32_16x16x32_bf16 v[32:35], v[44:47], v[16:19], 0
    v_pk_mul_f32 v[76:77], v[76:77], v[156:157]
    v_pk_mul_f32 v[92:93], v[92:93], v[156:157]
    v_mfma_f32_16x16x32_bf16 v[36:39], v[48:51], v[20:23], 0
    v_pk_mul_f32 v[80:81], v[80:81], v[164:165]
    v_pk_mul_f32 v[96:97], v[96:97], v[164:165]
    v_mfma_f32_16x16x32_bf16 v[40:43], v[52:55], v[24:27], 0
    v_pk_mul_f32 v[78:79], v[78:79], v[158:159]
    v_pk_mul_f32 v[94:95], v[94:95], v[158:159]
    v_pk_mul_f32 v[82:83], v[82:83], v[166:167]
    v_pk_mul_f32 v[98:99], v[98:99], v[166:167]
    v_cvt_pk_bf16_f32 v236, v76, v77
    v_cvt_pk_bf16_f32 v246, v92, v93
    v_cvt_pk_bf16_f32 v238, v80, v81
    v_cvt_pk_bf16_f32 v248, v96, v97
    v_cvt_pk_bf16_f32 v237, v78, v79
    v_cvt_pk_bf16_f32 v247, v94, v95
    v_cvt_pk_bf16_f32 v239, v82, v83
    v_cvt_pk_bf16_f32 v249, v98, v99
    v_pk_fma_f32 v[84:85], v[168:169], v[126:127], v[84:85] op_sel_hi:[1,0,1]
    v_pk_fma_f32 v[100:101], v[126:127], v[168:169], v[100:101] op_sel:[1,0,0] op_sel_hi:[1,1,1]
    v_pk_fma_f32 v[86:87], v[170:171], v[126:127], v[86:87] op_sel_hi:[1,0,1]
    v_pk_fma_f32 v[102:103], v[126:127], v[170:171], v[102:103] op_sel:[1,0,0] op_sel_hi:[1,1,1]
    v_pk_mul_f32 v[84:85], v[84:85], v[172:173]
    v_pk_mul_f32 v[100:101], v[100:101], v[172:173]
    v_pk_mul_f32 v[86:87], v[86:87], v[174:175]
    v_pk_mul_f32 v[102:103], v[102:103], v[174:175]
    v_cvt_pk_bf16_f32 v240, v84, v85
    v_cvt_pk_bf16_f32 v250, v100, v101
    v_cvt_pk_bf16_f32 v241, v86, v87
    v_cvt_pk_bf16_f32 v251, v102, v103
    v_mov_b32 v7, 0xf149f2ca
    s_lshl_b32 s45, s42, 22
    s_lshl_b32 s49, s36, 18
    s_add_u32 s45, s45, s49
    s_lshl_b32 s49, s37, 11
    s_add_u32 s45, s45, s49
    s_lshl_b32 s49, s41, 10
    s_add_u32 s45, s45, s49
    s_add_u32 s45, s45, 16908288
    s_add_u32 s46, s45, 32768
    s_add_u32 s47, s45, 65536
    s_add_u32 s48, s45, 98304
    v_cndmask_b32 v32, v32, v64, s[64:65]
    v_cndmask_b32 v36, v36, v68, s[64:65]
    v_cndmask_b32 v40, v40, v72, s[64:65]
    v_cndmask_b32 v33, v33, v65, s[66:67]
    v_cndmask_b32 v37, v37, v69, s[66:67]
    v_cndmask_b32 v41, v41, v73, s[66:67]
    v_cndmask_b32 v34, v34, v66, s[68:69]
    v_cndmask_b32 v38, v38, v70, s[68:69]
    v_cndmask_b32 v42, v42, v74, s[68:69]
    v_cndmask_b32 v35, v35, v67, s[70:71]
    v_cndmask_b32 v39, v39, v71, s[70:71]
    v_cndmask_b32 v43, v43, v75, s[70:71]
    v_cndmask_b32 v32, v7, v32, s[72:73]
    v_cndmask_b32 v36, v7, v36, s[72:73]
    v_cndmask_b32 v40, v7, v40, s[72:73]
    v_cndmask_b32 v33, v7, v33, s[74:75]
    v_cndmask_b32 v37, v7, v37, s[74:75]
    v_cndmask_b32 v41, v7, v41, s[74:75]
    v_cndmask_b32 v34, v7, v34, s[76:77]
    v_cndmask_b32 v38, v7, v38, s[76:77]
    v_cndmask_b32 v42, v7, v42, s[76:77]
    v_cndmask_b32 v35, v7, v35, s[78:79]
    v_cndmask_b32 v39, v7, v39, s[78:79]
    v_cndmask_b32 v43, v7, v43, s[78:79]
    v_max3_f32 v48, v32, v33, v34
    v_max3_f32 v52, v36, v37, v38
    v_max3_f32 v56, v40, v41, v42
    v_max_f32 v48, v48, v35
    v_max_f32 v52, v52, v39
    v_max_f32 v56, v56, v43
    v_mov_b32 v49, v48
    v_mov_b32 v53, v52
    v_mov_b32 v57, v56
    v_permlane16_swap_b32 v48, v49
    v_permlane16_swap_b32 v52, v53
    v_permlane16_swap_b32 v56, v57
    v_max_f32 v48, v48, v49
    v_max_f32 v52, v52, v53
    v_max_f32 v56, v56, v57
    v_mov_b32 v49, v48
    v_mov_b32 v53, v52
    v_mov_b32 v57, v56
    v_permlane32_swap_b32 v48, v49
    v_permlane32_swap_b32 v52, v53
    v_permlane32_swap_b32 v56, v57
    v_max_f32 v48, v48, v49
    v_max_f32 v52, v52, v53
    v_max_f32 v56, v56, v57
    v_mul_f32 v48, v48, v119
    v_mul_f32 v52, v52, v121
    v_mul_f32 v56, v56, v123
    v_fma_f32 v32, v32, v119, -v48
    v_fma_f32 v36, v36, v121, -v52
    v_fma_f32 v40, v40, v123, -v56
    v_fma_f32 v33, v33, v119, -v48
    v_fma_f32 v37, v37, v121, -v52
    v_fma_f32 v41, v41, v123, -v56
    v_fma_f32 v34, v34, v119, -v48
    v_fma_f32 v38, v38, v121, -v52
    v_fma_f32 v42, v42, v123, -v56
    v_fma_f32 v35, v35, v119, -v48
    v_fma_f32 v39, v39, v121, -v52
    v_fma_f32 v43, v43, v123, -v56
    v_exp_f32 v32, v32
    v_exp_f32 v36, v36
    v_exp_f32 v40, v40
    v_exp_f32 v33, v33
    v_exp_f32 v37, v37
    v_exp_f32 v41, v41
    v_exp_f32 v34, v34
    buffer_load_dwordx4 v[176:179], v4, s[4:7], s17 offen sc1
    buffer_load_dwordx4 v[180:183], v4, s[4:7], s17 offen offset:1024 sc1
    v_exp_f32 v38, v38
    v_exp_f32 v42, v42
    v_exp_f32 v35, v35
    v_exp_f32 v39, v39
    v_exp_f32 v43, v43
    v_add_f32 v48, v32, v33
    v_add_f32 v52, v36, v37
    v_add_f32 v56, v40, v41
    v_add_f32 v49, v34, v35
    v_add_f32 v53, v38, v39
    v_add_f32 v57, v42, v43
    v_add_f32 v48, v48, v49
    v_add_f32 v52, v52, v53
    v_add_f32 v56, v56, v57
    v_mov_b32 v49, v48
    v_mov_b32 v53, v52
    v_mov_b32 v57, v56
    v_permlane16_swap_b32 v48, v49
    v_permlane16_swap_b32 v52, v53
    v_permlane16_swap_b32 v56, v57
    v_add_f32 v48, v48, v49
    v_add_f32 v52, v52, v53
    v_add_f32 v56, v56, v57
    v_mov_b32 v49, v48
    v_mov_b32 v53, v52
    v_mov_b32 v57, v56
    v_permlane32_swap_b32 v48, v49
    v_permlane32_swap_b32 v52, v53
    v_permlane32_swap_b32 v56, v57
    v_add_f32 v48, v48, v49
    v_add_f32 v52, v52, v53
    v_add_f32 v56, v56, v57
    v_rcp_f32 v48, v48
    v_rcp_f32 v52, v52
    v_rcp_f32 v56, v56
    v_mul_f32 v32, v32, v48
    v_mul_f32 v36, v36, v52
    v_mul_f32 v40, v40, v56
    v_mul_f32 v33, v33, v48
    v_mul_f32 v37, v37, v52
    v_mul_f32 v41, v41, v56
    v_mul_f32 v34, v34, v48
    v_mul_f32 v38, v38, v52
    v_mul_f32 v42, v42, v56
    v_mul_f32 v35, v35, v48
    v_mul_f32 v39, v39, v52
    v_mul_f32 v43, v43, v56
    v_cvt_pk_bf16_f32 v50, v32, v33
    v_cvt_pk_bf16_f32 v54, v36, v37
    v_cvt_pk_bf16_f32 v58, v40, v41
    v_cvt_pk_bf16_f32 v51, v34, v35
    v_cvt_pk_bf16_f32 v55, v38, v39
    v_cvt_pk_bf16_f32 v59, v42, v43
    v_bfi_b32 v80, v220, 0, v50
    v_bfi_b32 v84, v220, 0, v54
    v_bfi_b32 v88, v220, 0, v58
    v_and_b32 v82, v220, v50
    v_and_b32 v86, v220, v54
    v_and_b32 v90, v220, v58
    v_bfi_b32 v81, v221, 0, v51
    v_bfi_b32 v85, v221, 0, v55
    v_bfi_b32 v89, v221, 0, v59
    v_and_b32 v83, v221, v51
    v_and_b32 v87, v221, v55
    v_and_b32 v91, v221, v59
    v_mfma_f32_16x16x32_bf16 v[16:19], v[236:239], v[80:83], 0
    v_mfma_f32_16x16x32_bf16 v[20:23], v[238:241], v[84:87], 0
    v_mfma_f32_16x16x32_bf16 v[24:27], v[240:243], v[88:91], 0
    v_mfma_f32_16x16x32_bf16 v[64:67], v[246:249], v[80:83], 0
    v_mfma_f32_16x16x32_bf16 v[68:71], v[248:251], v[84:87], 0
    v_mfma_f32_16x16x32_bf16 v[72:75], v[250:253], v[88:91], 0
    s_nop 2
    v_cvt_pk_bf16_f32 v48, v16, v17
    v_cvt_pk_bf16_f32 v52, v20, v21
    v_cvt_pk_bf16_f32 v56, v24, v25
    v_cvt_pk_bf16_f32 v49, v18, v19
    v_cvt_pk_bf16_f32 v53, v22, v23
    v_cvt_pk_bf16_f32 v57, v26, v27
    v_cvt_pk_bf16_f32 v50, v64, v65
    v_cvt_pk_bf16_f32 v54, v68, v69
    v_cvt_pk_bf16_f32 v58, v72, v73
    v_cvt_pk_bf16_f32 v51, v66, v67
    v_cvt_pk_bf16_f32 v55, v70, v71
    v_cvt_pk_bf16_f32 v59, v74, v75
    v_permlane16_swap_b32 v48, v50
    v_permlane16_swap_b32 v52, v54
    v_permlane16_swap_b32 v56, v58
    v_permlane16_swap_b32 v49, v51
    v_permlane16_swap_b32 v53, v55
    v_permlane16_swap_b32 v57, v59
    buffer_store_dwordx4 v[48:51], v223, s[4:7], s46 offen sc1
    buffer_store_dwordx4 v[52:55], v223, s[4:7], s47 offen sc1
    buffer_store_dwordx4 v[56:59], v223, s[4:7], s48 offen sc1
    s_cmp_eq_u32 s36, 0
    s_cbranch_scc1 hx_zero_7
    s_waitcnt vmcnt(5)
    v_cmp_ne_u32 vcc, s44, v114
    v_cmp_ne_u32 s[98:99], s44, v202
    s_nop 0
    s_or_b64 vcc, vcc, s[98:99]
    s_cbranch_vccnz hx_late_8
hx_ok_10:
    v_mov_b32 v244, v200
    v_mov_b32 v245, v201
    v_mov_b32_dpp v114, v112 row_ror:8 row_mask:0xf bank_mask:0xf
    v_mov_b32_dpp v115, v113 row_ror:8 row_mask:0xf bank_mask:0xf
    v_permlane32_swap_b32 v244, v200
    v_permlane32_swap_b32 v245, v201
    v_mov_b32 v234, v200
    v_mov_b32 v235, v201
hx_go_11:
    v_mfma_f32_16x16x32_bf16 v[28:31], v[112:115], v[12:15], 0
    s_nop 7
    v_cndmask_b32 v28, v28, v60, s[64:65]
    v_cndmask_b32 v29, v29, v61, s[66:67]
    v_cndmask_b32 v30, v30, v62, s[68:69]
    v_cndmask_b32 v31, v31, v63, s[70:71]
    v_cndmask_b32 v28, v7, v28, s[80:81]
    v_cndmask_b32 v29, v7, v29, s[82:83]
    v_cndmask_b32 v30, v7, v30, s[84:85]
    v_cndmask_b32 v31, v7, v31, s[86:87]
    v_max3_f32 v44, v28, v29, v30
    v_max_f32 v44, v44, v31
    v_mov_b32 v45, v44
    s_nop 1
    v_permlane16_swap_b32 v44, v45
    v_max_f32 v44, v44, v45
    v_mov_b32 v45, v44
    s_nop 1
    v_permlane32_swap_b32 v44, v45
    v_max_f32 v44, v44, v45
    v_mul_f32 v44, v44, v117
    v_fma_f32 v28, v28, v117, -v44
    v_fma_f32 v29, v29, v117, -v44
    v_fma_f32 v30, v30, v117, -v44
    v_fma_f32 v31, v31, v117, -v44
    v_exp_f32 v28, v28
    v_exp_f32 v29, v29
    v_exp_f32 v30, v30
    v_exp_f32 v31, v31
    v_add_f32 v44, v28, v29
    v_add_f32 v45, v30, v31
    v_add_f32 v44, v44, v45
    v_mov_b32 v45, v44
    s_nop 1
    v_permlane16_swap_b32 v44, v45
    v_add_f32 v44, v44, v45
    v_mov_b32 v45, v44
    s_nop 1
    v_permlane32_swap_b32 v44, v45
    v_add_f32 v44, v44, v45
    v_rcp_f32 v44, v44
    s_nop 0
    v_mul_f32 v28, v28, v44
    v_mul_f32 v29, v29, v44
    v_mul_f32 v30, v30, v44
    v_mul_f32 v31, v31, v44
    v_cvt_pk_bf16_f32 v46, v28, v29
    v_cvt_pk_bf16_f32 v47, v30, v31
    v_bfi_b32 v76, v220, 0, v46
    v_and_b32 v78, v220, v46
    v_bfi_b32 v77, v221, 0, v47
    v_and_b32 v79, v221, v47
    s_nop 1
    v_mfma_f32_16x16x32_bf16 v[12:15], v[234:237], v[76:79], 0
    v_mfma_f32_16x16x32_bf16 v[60:63], v[244:247], v[76:79], 0
    s_nop 6
    v_cvt_pk_bf16_f32 v44, v12, v13
    v_cvt_pk_bf16_f32 v45, v14, v15
    v_cvt_pk_bf16_f32 v46, v60, v61
    v_cvt_pk_bf16_f32 v47, v62, v63
    s_nop 0
    v_permlane16_swap_b32 v44, v46
    v_permlane16_swap_b32 v45, v47
    buffer_store_dwordx4 v[44:47], v223, s[4:7], s45 offen sc1
    s_branch b_cons
hx_late_8:
    s_waitcnt vmcnt(3)
    v_cmp_ne_u32 vcc, s44, v178
    v_cmp_ne_u32 s[98:99], s44, v182
    s_nop 0
    s_or_b64 vcc, vcc, s[98:99]
    s_cbranch_vccnz hx_spin_12
    v_mov_b32 v112, v176
    v_mov_b32 v113, v177
    v_mov_b32 v200, v180
    v_mov_b32 v201, v181
    s_branch hx_ok_10
hx_spin_12:
    s_mov_b32 s63, 0
hx_loop_9:
    buffer_load_dwordx4 v[112:115], v4, s[4:7], s17 offen sc1
    buffer_load_dwordx4 v[200:203], v4, s[4:7], s17 offen offset:1024 sc1
    s_waitcnt vmcnt(0)
    v_cmp_ne_u32 vcc, s44, v114
    v_cmp_ne_u32 s[98:99], s44, v202
    s_nop 0
    s_or_b64 vcc, vcc, s[98:99]
    s_cbranch_vccz hx_ok_10
    s_add_u32 s63, s63, 1
    s_cmp_lt_u32 s63, 20000
    s_cbranch_scc1 hx_loop_9
    v_mov_b32 v114, 0x120
    s_mov_b32 s63, 16
    buffer_store_dword v114, off, s[24:27], s63
    s_waitcnt vmcnt(0)
    s_branch hx_ok_10
hx_zero_7:
    s_waitcnt vmcnt(3)
    v_mov_b32 v112, 0
    v_mov_b32 v113, 0
    v_mov_b32 v114, 0
    v_mov_b32 v115, 0
    v_mov_b32 v234, 0
    v_mov_b32 v235, 0
    v_mov_b32 v244, 0
    v_mov_b32 v245, 0
    s_branch hx_go_11
b_cons:
    v_lshlrev_b32 v12, 16, v204
    v_and_b32 v13, s53, v204
    v_lshlrev_b32 v14, 16, v205
    v_and_b32 v15, s53, v205
    v_lshlrev_b32 v20, 16, v206
    v_and_b32 v21, s53, v206
    v_lshlrev_b32 v22, 16, v207
    v_and_b32 v23, s53, v207
    v_lshlrev_b32 v28, 16, v208
    v_and_b32 v29, s53, v208
    v_lshlrev_b32 v30, 16, v209
    v_and_b32 v31, s53, v209
    v_lshlrev_b32 v36, 16, v210
    v_and_b32 v37, s53, v210
    v_lshlrev_b32 v38, 16, v211
    v_and_b32 v39, s53, v211
    v_lshlrev_b32 v16, 16, v212
    v_and_b32 v17, s53, v212
    v_lshlrev_b32 v18, 16, v213
    v_and_b32 v19, s53, v213
    v_lshlrev_b32 v24, 16, v214
    v_and_b32 v25, s53, v214
    v_lshlrev_b32 v26, 16, v215
    v_and_b32 v27, s53, v215
    v_lshlrev_b32 v32, 16, v216
    v_and_b32 v33, s53, v216
    v_lshlrev_b32 v34, 16, v217
    v_and_b32 v35, s53, v217
    v_lshlrev_b32 v40, 16, v218
    v_and_b32 v41, s53, v218
    v_lshlrev_b32 v42, 16, v219
    v_and_b32 v43, s53, v219
    s_lshl_b32 s61, s42, 22
    s_lshl_b32 s49, s38, 18
    s_add_u32 s61, s61, s49
    s_lshl_b32 s49, s40, 16
    s_add_u32 s61, s61, s49
    s_add_u32 s61, s61, 16777216
    s_add_u32 s62, s61, 32768
    v_add_u32 v148, 32768, v4
    s_waitcnt vmcnt(0)
    s_barrier
    s_add_u32 s28, s61, 8192
    buffer_load_dwordx4 v[76:79], v4, s[4:7], s28 offen sc1
    buffer_load_dwordx4 v[80:83], v148, s[4:7], s28 offen sc1
    s_add_u32 s29, s61, 9216
    buffer_load_dwordx4 v[84:87], v4, s[4:7], s29 offen sc1
    buffer_load_dwordx4 v[88:91], v148, s[4:7], s29 offen sc1
    s_add_u32 s30, s61, 10240
    buffer_load_dwordx4 v[92:95], v4, s[4:7], s30 offen sc1
    buffer_load_dwordx4 v[96:99], v148, s[4:7], s30 offen sc1
    s_add_u32 s31, s61, 11264
    buffer_load_dwordx4 v[100:103], v4, s[4:7], s31 offen sc1
    buffer_load_dwordx4 v[104:107], v148, s[4:7], s31 offen sc1
    s_add_u32 s32, s61, 12288
    buffer_load_dwordx4 v[108:111], v4, s[4:7], s32 offen sc1
    buffer_load_dwordx4 v[112:115], v148, s[4:7], s32 offen sc1
    s_add_u32 s33, s61, 13312
    buffer_load_dwordx4 v[116:119], v4, s[4:7], s33 offen sc1
    buffer_load_dwordx4 v[120:123], v148, s[4:7], s33 offen sc1
    s_add_u32 s34, s61, 14336
    buffer_load_dwordx4 v[124:127], v4, s[4:7], s34 offen sc1
    buffer_load_dwordx4 v[128:131], v148, s[4:7], s34 offen sc1
    s_add_u32 s35, s61, 15360
    buffer_load_dwordx4 v[132:135], v4, s[4:7], s35 offen sc1
    buffer_load_dwordx4 v[136:139], v148, s[4:7], s35 offen sc1
    s_add_u32 s8, s61, 16384
    ds_read_b64_tr_b16 v[44:45], v225 offset:32768
    ds_read_b64_tr_b16 v[46:47], v225 offset:33280
    ds_read_b64_tr_b16 v[48:49], v226 offset:32768
    ds_read_b64_tr_b16 v[50:51], v226 offset:33280
    ds_read_b64_tr_b16 v[52:53], v227 offset:32768
    ds_read_b64_tr_b16 v[54:55], v227 offset:33280
    ds_read_b64_tr_b16 v[56:57], v228 offset:32768
    ds_read_b64_tr_b16 v[58:59], v228 offset:33280
    s_waitcnt vmcnt(14)
    v_max3_u32 v149, v76, v77, v78
    v_max3_u32 v149, v149, v79, v80
    v_max3_u32 v149, v149, v81, v82
    v_max_u32 v149, v149, v83
    v_cmp_eq_u32 vcc, -1, v149
    s_cbranch_vccnz so_stub_0
so_back_0:
    s_waitcnt lgkmcnt(0)
    v_mfma_f32_16x16x32_bf16 v[12:15], v[44:47], v[76:79], v[12:15]
    ds_read_b64_tr_b16 v[60:61], v225 offset:36864
    ds_read_b64_tr_b16 v[62:63], v225 offset:37376
    v_mfma_f32_16x16x32_bf16 v[16:19], v[44:47], v[80:83], v[16:19]
    ds_read_b64_tr_b16 v[64:65], v226 offset:36864
    ds_read_b64_tr_b16 v[66:67], v226 offset:37376
    v_mfma_f32_16x16x32_bf16 v[20:23], v[48:51], v[76:79], v[20:23]
    ds_read_b64_tr_b16 v[68:69], v227 offset:36864
    ds_read_b64_tr_b16 v[70:71], v227 offset:37376
    v_mfma_f32_16x16x32_bf16 v[24:27], v[48:51], v[80:83], v[24:27]
    ds_read_b64_tr_b16 v[72:73], v228 offset:36864
    ds_read_b64_tr_b16 v[74:75], v228 offset:37376
    s_add_u32 s8, s61, 16384
    buffer_load_dwordx4 v[140:143], v4, s[4:7], s8 offen sc1
    v_mfma_f32_16x16x32_bf16 v[28:31], v[52:55], v[76:79], v[28:31]
    buffer_load_dwordx4 v[144:147], v148, s[4:7], s8 offen sc1
    v_mfma_f32_16x16x32_bf16 v[32:35], v[52:55], v[80:83], v[32:35]
    s_waitcnt vmcnt(14)
    v_max3_u32 v149, v84, v85, v86
    v_max3_u32 v149, v149, v87, v88
    v_mfma_f32_16x16x32_bf16 v[36:39], v[56:59], v[76:79], v[36:39]
    v_max3_u32 v149, v149, v89, v90
    v_max_u32 v149, v149, v91
    v_cmp_eq_u32 vcc, -1, v149
    v_mfma_f32_16x16x32_bf16 v[40:43], v[56:59], v[80:83], v[40:43]
    s_cbranch_vccnz so_stub_1
so_back_1:
    s_waitcnt lgkmcnt(0)
    v_mfma_f32_16x16x32_bf16 v[12:15], v[60:63], v[84:87], v[12:15]
    ds_read_b64_tr_b16 v[44:45], v225 offset:40960
    ds_read_b64_tr_b16 v[46:47], v225 offset:41472
    v_mfma_f32_16x16x32_bf16 v[16:19], v[60:63], v[88:91], v[16:19]
    ds_read_b64_tr_b16 v[48:49], v226 offset:40960
    ds_read_b64_tr_b16 v[50:51], v226 offset:41472
    v_mfma_f32_16x16x32_bf16 v[20:23], v[64:67], v[84:87], v[20:23]
    ds_read_b64_tr_b16 v[52:53], v227 offset:40960
    ds_read_b64_tr_b16 v[54:55], v227 offset:41472
    v_mfma_f32_16x16x32_bf16 v[24:27], v[64:67], v[88:91], v[24:27]
    ds_read_b64_tr_b16 v[56:57], v228 offset:40960
    ds_read_b64_tr_b16 v[58:59], v228 offset:41472
    s_add_u32 s28, s61, 17408
    buffer_load_dwordx4 v[76:79], v4, s[4:7], s28 offen sc1
    v_mfma_f32_16x16x32_bf16 v[28:31], v[68:71], v[84:87], v[28:31]
    buffer_load_dwordx4 v[80:83], v148, s[4:7], s28 offen sc1
    v_mfma_f32_16x16x32_bf16 v[32:35], v[68:71], v[88:91], v[32:35]
    s_waitcnt vmcnt(14)
    v_max3_u32 v149, v92, v93, v94
    v_max3_u32 v149, v149, v95, v96
    v_mfma_f32_16x16x32_bf16 v[36:39], v[72:75], v[84:87], v[36:39]
    v_max3_u32 v149, v149, v97, v98
    v_max_u32 v149, v149, v99
    v_cmp_eq_u32 vcc, -1, v149
    v_mfma_f32_16x16x32_bf16 v[40:43], v[72:75], v[88:91], v[40:43]
    s_cbranch_vccnz so_stub_2
so_back_2:
    s_waitcnt lgkmcnt(0)
    v_mfma_f32_16x16x32_bf16 v[12:15], v[44:47], v[92:95], v[12:15]
    ds_read_b64_tr_b16 v[60:61], v225 offset:45056
    ds_read_b64_tr_b16 v[62:63], v225 offset:45568
    v_mfma_f32_16x16x32_bf16 v[16:19], v[44:47], v[96:99], v[16:19]
    ds_read_b64_tr_b16 v[64:65], v226 offset:45056
    ds_read_b64_tr_b16 v[66:67], v226 offset:45568
    v_mfma_f32_16x16x32_bf16 v[20:23], v[48:51], v[92:95], v[20:23]
    ds_read_b64_tr_b16 v[68:69], v227 offset:45056
    ds_read_b64_tr_b16 v[70:71], v227 offset:45568
    v_mfma_f32_16x16x32_bf16 v[24:27], v[48:51], v[96:99], v[24:27]
    ds_read_b64_tr_b16 v[72:73], v228 offset:45056
    ds_read_b64_tr_b16 v[74:75], v228 offset:45568
    s_add_u32 s29, s61, 18432
    buffer_load_dwordx4 v[84:87], v4, s[4:7], s29 offen sc1
    v_mfma_f32_16x16x32_bf16 v[28:31], v[52:55], v[92:95], v[28:31]
    buffer_load_dwordx4 v[88:91], v148, s[4:7], s29 offen sc1
    v_mfma_f32_16x16x32_bf16 v[32:35], v[52:55], v[96:99], v[32:35]
    s_waitcnt vmcnt(14)
    v_max3_u32 v149, v100, v101, v102
    v_max3_u32 v149, v149, v103, v104
    v_mfma_f32_16x16x32_bf16 v[36:39], v[56:59], v[92:95], v[36:39]
    v_max3_u32 v149, v149, v105, v106
    v_max_u32 v149, v149, v107
    v_cmp_eq_u32 vcc, -1, v149
    v_mfma_f32_16x16x32_bf16 v[40:43], v[56:59], v[96:99], v[40:43]
    s_cbranch_vccnz so_stub_3
so_back_3:
    s_waitcnt lgkmcnt(0)
    v_mfma_f32_16x16x32_bf16 v[12:15], v[60:63], v[100:103], v[12:15]
    ds_read_b64_tr_b16 v[44:45], v225 offset:49152
    ds_read_b64_tr_b16 v[46:47], v225 offset:49664
    v_mfma_f32_16x16x32_bf16 v[16:19], v[60:63], v[104:107], v[16:19]
    ds_read_b64_tr_b16 v[48:49], v226 offset:49152
    ds_read_b64_tr_b16 v[50:51], v226 offset:49664
    v_mfma_f32_16x16x32_bf16 v[20:23], v[64:67], v[100:103], v[20:23]
    ds_read_b64_tr_b16 v[52:53], v227 offset:49152
    ds_read_b64_tr_b16 v[54:55], v227 offset:49664
    v_mfma_f32_16x16x32_bf16 v[24:27], v[64:67], v[104:107], v[24:27]
    ds_read_b64_tr_b16 v[56:57], v228 offset:49152
    ds_read_b64_tr_b16 v[58:59], v228 offset:49664
    s_add_u32 s30, s61, 19456
    buffer_load_dwordx4 v[92:95], v4, s[4:7], s30 offen sc1
    v_mfma_f32_16x16x32_bf16 v[28:31], v[68:71], v[100:103], v[28:31]
    buffer_load_dwordx4 v[96:99], v148, s[4:7], s30 offen sc1
    v_mfma_f32_16x16x32_bf16 v[32:35], v[68:71], v[104:107], v[32:35]
    s_waitcnt vmcnt(14)
    v_max3_u32 v149, v108, v109, v110
    v_max3_u32 v149, v149, v111, v112
    v_mfma_f32_16x16x32_bf16 v[36:39], v[72:75], v[100:103], v[36:39]
    v_max3_u32 v149, v149, v113, v114
    v_max_u32 v149, v149, v115
    v_cmp_eq_u32 vcc, -1, v149
    v_mfma_f32_16x16x32_bf16 v[40:43], v[72:75], v[104:107], v[40:43]
    s_cbranch_vccnz so_stub_4
so_back_4:
    s_waitcnt lgkmcnt(0)
    v_mfma_f32_16x16x32_bf16 v[12:15], v[44:47], v[108:111], v[12:15]
    ds_read_b64_tr_b16 v[60:61], v225 offset:53248
    ds_read_b64_tr_b16 v[62:63], v225 offset:53760
    v_mfma_f32_16x16x32_bf16 v[16:19], v[44:47], v[112:115], v[16:19]
    ds_read_b64_tr_b16 v[64:65], v226 offset:53248
    ds_read_b64_tr_b16 v[66:67], v226 offset:53760
    v_mfma_f32_16x16x32_bf16 v[20:23], v[48:51], v[108:111], v[20:23]
    ds_read_b64_tr_b16 v[68:69], v227 offset:53248
    ds_read_b64_tr_b16 v[70:71], v227 offset:53760
    v_mfma_f32_16x16x32_bf16 v[24:27], v[48:51], v[112:115], v[24:27]
    ds_read_b64_tr_b16 v[72:73], v228 offset:53248
    ds_read_b64_tr_b16 v[74:75], v228 offset:53760
    s_add_u32 s31, s61, 20480
    buffer_load_dwordx4 v[100:103], v4, s[4:7], s31 offen sc1
    v_mfma_f32_16x16x32_bf16 v[28:31], v[52:55], v[108:111], v[28:31]
    buffer_load_dwordx4 v[104:107], v148, s[4:7], s31 offen sc1
    v_mfma_f32_16x16x32_bf16 v[32:35], v[52:55], v[112:115], v[32:35]
    s_waitcnt vmcnt(14)
    v_max3_u32 v149, v116, v117, v118
    v_max3_u32 v149, v149, v119, v120
    v_mfma_f32_16x16x32_bf16 v[36:39], v[56:59], v[108:111], v[36:39]
    v_max3_u32 v149, v149, v121, v122
    v_max_u32 v149, v149, v123
    v_cmp_eq_u32 vcc, -1, v149
    v_mfma_f32_16x16x32_bf16 v[40:43], v[56:59], v[112:115], v[40:43]
    s_cbranch_vccnz so_stub_5
so_back_5:
    s_waitcnt lgkmcnt(0)
    v_mfma_f32_16x16x32_bf16 v[12:15], v[60:63], v[116:119], v[12:15]
    ds_read_b64_tr_b16 v[44:45], v225 offset:57344
    ds_read_b64_tr_b16 v[46:47], v225 offset:57856
    v_mfma_f32_16x16x32_bf16 v[16:19], v[60:63], v[120:123], v[16:19]
    ds_read_b64_tr_b16 v[48:49], v226 offset:57344
    ds_read_b64_tr_b16 v[50:51], v226 offset:57856
    v_mfma_f32_16x16x32_bf16 v[20:23], v[64:67], v[116:119], v[20:23]
    ds_read_b64_tr_b16 v[52:53], v227 offset:57344
    ds_read_b64_tr_b16 v[54:55], v227 offset:57856
    v_mfma_f32_16x16x32_bf16 v[24:27], v[64:67], v[120:123], v[24:27]
    ds_read_b64_tr_b16 v[56:57], v228 offset:57344
    ds_read_b64_tr_b16 v[58:59], v228 offset:57856
    s_add_u32 s32, s61, 21504
    buffer_load_dwordx4 v[108:111], v4, s[4:7], s32 offen sc1
    v_mfma_f32_16x16x32_bf16 v[28:31], v[68:71], v[116:119], v[28:31]
    buffer_load_dwordx4 v[112:115], v148, s[4:7], s32 offen sc1
    v_mfma_f32_16x16x32_bf16 v[32:35], v[68:71], v[120:123], v[32:35]
    s_waitcnt vmcnt(14)
    v_max3_u32 v149, v124, v125, v126
    v_max3_u32 v149, v149, v127, v128
    v_mfma_f32_16x16x32_bf16 v[36:39], v[72:75], v[116:119], v[36:39]
    v_max3_u32 v149, v149, v129, v130
    v_max_u32 v149, v149, v131
    v_cmp_eq_u32 vcc, -1, v149
    v_mfma_f32_16x16x32_bf16 v[40:43], v[72:75], v[120:123], v[40:43]
    s_cbranch_vccnz so_stub_6
so_back_6:
    s_waitcnt lgkmcnt(0)
    v_mfma_f32_16x16x32_bf16 v[12:15], v[44:47], v[124:127], v[12:15]
    ds_read_b64_tr_b16 v[60:61], v225 offset:61440
    ds_read_b64_tr_b16 v[62:63], v225 offset:61952
    v_mfma_f32_16x16x32_bf16 v[16:19], v[44:47], v[128:131], v[16:19]
    ds_read_b64_tr_b16 v[64:65], v226 offset:61440
    ds_read_b64_tr_b16 v[66:67], v226 offset:61952
    v_mfma_f32_16x16x32_bf16 v[20:23], v[48:51], v[124:127], v[20:23]
    ds_read_b64_tr_b16 v[68:69], v227 offset:61440
    ds_read_b64_tr_b16 v[70:71], v227 offset:61952
    v_mfma_f32_16x16x32_bf16 v[24:27], v[48:51], v[128:131], v[24:27]
    ds_read_b64_tr_b16 v[72:73], v228 offset:61440
    ds_read_b64_tr_b16 v[74:75], v228 offset:61952
    s_add_u32 s33, s61, 24576
    buffer_load_dwordx4 v[116:119], v4, s[4:7], s33 offen sc1
    v_mfma_f32_16x16x32_bf16 v[28:31], v[52:55], v[124:127], v[28:31]
    buffer_load_dwordx4 v[120:123], v148, s[4:7], s33 offen sc1
    v_mfma_f32_16x16x32_bf16 v[32:35], v[52:55], v[128:131], v[32:35]
    s_waitcnt vmcnt(14)
    v_max3_u32 v149, v132, v133, v134
    v_max3_u32 v149, v149, v135, v136
    v_mfma_f32_16x16x32_bf16 v[36:39], v[56:59], v[124:127], v[36:39]
    v_max3_u32 v149, v149, v137, v138
    v_max_u32 v149, v149, v139
    v_cmp_eq_u32 vcc, -1, v149
    v_mfma_f32_16x16x32_bf16 v[40:43], v[56:59], v[128:131], v[40:43]
    s_cbranch_vccnz so_stub_7
so_back_7:
    s_waitcnt lgkmcnt(0)
    v_mfma_f32_16x16x32_bf16 v[12:15], v[60:63], v[132:135], v[12:15]
    ds_read_b64_tr_b16 v[44:45], v229 offset:0
    ds_read_b64_tr_b16 v[46:47], v229 offset:512
    v_mfma_f32_16x16x32_bf16 v[16:19], v[60:63], v[136:139], v[16:19]
    ds_read_b64_tr_b16 v[48:49], v230 offset:0
    ds_read_b64_tr_b16 v[50:51], v230 offset:512
    v_mfma_f32_16x16x32_bf16 v[20:23], v[64:67], v[132:135], v[20:23]
    ds_read_b64_tr_b16 v[52:53], v231 offset:0
    ds_read_b64_tr_b16 v[54:55], v231 offset:512
    v_mfma_f32_16x16x32_bf16 v[24:27], v[64:67], v[136:139], v[24:27]
    ds_read_b64_tr_b16 v[56:57], v232 offset:0
    ds_read_b64_tr_b16 v[58:59], v232 offset:512
    s_add_u32 s34, s61, 25600
    buffer_load_dwordx4 v[124:127], v4, s[4:7], s34 offen sc1
    v_mfma_f32_16x16x32_bf16 v[28:31], v[68:71], v[132:135], v[28:31]
    buffer_load_dwordx4 v[128:131], v148, s[4:7], s34 offen sc1
    v_mfma_f32_16x16x32_bf16 v[32:35], v[68:71], v[136:139], v[32:35]
    s_waitcnt vmcnt(14)
    v_max3_u32 v149, v140, v141, v142
    v_max3_u32 v149, v149, v143, v144
    v_mfma_f32_16x16x32_bf16 v[36:39], v[72:75], v[132:135], v[36:39]
    v_max3_u32 v149, v149, v145, v146
    v_max_u32 v149, v149, v147
    v_cmp_eq_u32 vcc, -1, v149
    v_mfma_f32_16x16x32_bf16 v[40:43], v[72:75], v[136:139], v[40:43]
    s_cbranch_vccnz so_stub_8
so_back_8:
    s_waitcnt lgkmcnt(0)
    v_mfma_f32_16x16x32_bf16 v[12:15], v[44:47], v[140:143], v[12:15]
    ds_read_b64_tr_b16 v[60:61], v229 offset:4096
    ds_read_b64_tr_b16 v[62:63], v229 offset:4608
    v_mfma_f32_16x16x32_bf16 v[16:19], v[44:47], v[144:147], v[16:19]
    ds_read_b64_tr_b16 v[64:65], v230 offset:4096
    ds_read_b64_tr_b16 v[66:67], v230 offset:4608
    v_mfma_f32_16x16x32_bf16 v[20:23], v[48:51], v[140:143], v[20:23]
    ds_read_b64_tr_b16 v[68:69], v231 offset:4096
    ds_read_b64_tr_b16 v[70:71], v231 offset:4608
    v_mfma_f32_16x16x32_bf16 v[24:27], v[48:51], v[144:147], v[24:27]
    ds_read_b64_tr_b16 v[72:73], v232 offset:4096
    ds_read_b64_tr_b16 v[74:75], v232 offset:4608
    s_add_u32 s35, s61, 26624
    buffer_load_dwordx4 v[132:135], v4, s[4:7], s35 offen sc1
    v_mfma_f32_16x16x32_bf16 v[28:31], v[52:55], v[140:143], v[28:31]
    buffer_load_dwordx4 v[136:139], v148, s[4:7], s35 offen sc1
    v_mfma_f32_16x16x32_bf16 v[32:35], v[52:55], v[144:147], v[32:35]
    s_waitcnt vmcnt(14)
    v_max3_u32 v149, v76, v77, v78
    v_max3_u32 v149, v149, v79, v80
    v_mfma_f32_16x16x32_bf16 v[36:39], v[56:59], v[140:143], v[36:39]
    v_max3_u32 v149, v149, v81, v82
    v_max_u32 v149, v149, v83
    v_cmp_eq_u32 vcc, -1, v149
    v_mfma_f32_16x16x32_bf16 v[40:43], v[56:59], v[144:147], v[40:43]
    s_cbranch_vccnz so_stub_9
so_back_9:
    s_waitcnt lgkmcnt(0)
    v_mfma_f32_16x16x32_bf16 v[12:15], v[60:63], v[76:79], v[12:15]
    ds_read_b64_tr_b16 v[44:45], v229 offset:8192
    ds_read_b64_tr_b16 v[46:47], v229 offset:8704
    v_mfma_f32_16x16x32_bf16 v[16:19], v[60:63], v[80:83], v[16:19]
    ds_read_b64_tr_b16 v[48:49], v230 offset:8192
    ds_read_b64_tr_b16 v[50:51], v230 offset:8704
    v_mfma_f32_16x16x32_bf16 v[20:23], v[64:67], v[76:79], v[20:23]
    ds_read_b64_tr_b16 v[52:53], v231 offset:8192
    ds_read_b64_tr_b16 v[54:55], v231 offset:8704
    v_mfma_f32_16x16x32_bf16 v[24:27], v[64:67], v[80:83], v[24:27]
    ds_read_b64_tr_b16 v[56:57], v232 offset:8192
    ds_read_b64_tr_b16 v[58:59], v232 offset:8704
    s_add_u32 s8, s61, 27648
    buffer_load_dwordx4 v[140:143], v4, s[4:7], s8 offen sc1
    v_mfma_f32_16x16x32_bf16 v[28:31], v[68:71], v[76:79], v[28:31]
    buffer_load_dwordx4 v[144:147], v148, s[4:7], s8 offen sc1
    v_mfma_f32_16x16x32_bf16 v[32:35], v[68:71], v[80:83], v[32:35]
    s_waitcnt vmcnt(14)
    v_max3_u32 v149, v84, v85, v86
    v_max3_u32 v149, v149, v87, v88
    v_mfma_f32_16x16x32_bf16 v[36:39], v[72:75], v[76:79], v[36:39]
    v_max3_u32 v149, v149, v89, v90
    v_max_u32 v149, v149, v91
    v_cmp_eq_u32 vcc, -1, v149
    v_mfma_f32_16x16x32_bf16 v[40:43], v[72:75], v[80:83], v[40:43]
    s_cbranch_vccnz so_stub_10
so_back_10:
    s_waitcnt lgkmcnt(0)
    v_mfma_f32_16x16x32_bf16 v[12:15], v[44:47], v[84:87], v[12:15]
    ds_read_b64_tr_b16 v[60:61], v229 offset:12288
    ds_read_b64_tr_b16 v[62:63], v229 offset:12800
    v_mfma_f32_16x16x32_bf16 v[16:19], v[44:47], v[88:91], v[16:19]
    ds_read_b64_tr_b16 v[64:65], v230 offset:12288
    ds_read_b64_tr_b16 v[66:67], v230 offset:12800
    v_mfma_f32_16x16x32_bf16 v[20:23], v[48:51], v[84:87], v[20:23]
    ds_read_b64_tr_b16 v[68:69], v231 offset:12288
    ds_read_b64_tr_b16 v[70:71], v231 offset:12800
    v_mfma_f32_16x16x32_bf16 v[24:27], v[48:51], v[88:91], v[24:27]
    ds_read_b64_tr_b16 v[72:73], v232 offset:12288
    ds_read_b64_tr_b16 v[74:75], v232 offset:12800
    s_add_u32 s28, s61, 28672
    buffer_load_dwordx4 v[76:79], v4, s[4:7], s28 offen sc1
    v_mfma_f32_16x16x32_bf16 v[28:31], v[52:55], v[84:87], v[28:31]
    buffer_load_dwordx4 v[80:83], v148, s[4:7], s28 offen sc1
    v_mfma_f32_16x16x32_bf16 v[32:35], v[52:55], v[88:91], v[32:35]
    s_waitcnt vmcnt(14)
    v_max3_u32 v149, v92, v93, v94
    v_max3_u32 v149, v149, v95, v96
    v_mfma_f32_16x16x32_bf16 v[36:39], v[56:59], v[84:87], v[36:39]
    v_max3_u32 v149, v149, v97, v98
    v_max_u32 v149, v149, v99
    v_cmp_eq_u32 vcc, -1, v149
    v_mfma_f32_16x16x32_bf16 v[40:43], v[56:59], v[88:91], v[40:43]
    s_cbranch_vccnz so_stub_11
so_back_11:
    s_waitcnt lgkmcnt(0)
    v_mfma_f32_16x16x32_bf16 v[12:15], v[60:63], v[92:95], v[12:15]
    ds_read_b64_tr_b16 v[44:45], v229 offset:16384
    ds_read_b64_tr_b16 v[46:47], v229 offset:16896
    v_mfma_f32_16x16x32_bf16 v[16:19], v[60:63], v[96:99], v[16:19]
    ds_read_b64_tr_b16 v[48:49], v230 offset:16384
    ds_read_b64_tr_b16 v[50:51], v230 offset:16896
    v_mfma_f32_16x16x32_bf16 v[20:23], v[64:67], v[92:95], v[20:23]
    ds_read_b64_tr_b16 v[52:53], v231 offset:16384
    ds_read_b64_tr_b16 v[54:55], v231 offset:16896
    v_mfma_f32_16x16x32_bf16 v[24:27], v[64:67], v[96:99], v[24:27]
    ds_read_b64_tr_b16 v[56:57], v232 offset:16384
    ds_read_b64_tr_b16 v[58:59], v232 offset:16896
    s_add_u32 s29, s61, 29696
    buffer_load_dwordx4 v[84:87], v4, s[4:7], s29 offen sc1
    v_mfma_f32_16x16x32_bf16 v[28:31], v[68:71], v[92:95], v[28:31]
    buffer_load_dwordx4 v[88:91], v148, s[4:7], s29 offen sc1
    v_mfma_f32_16x16x32_bf16 v[32:35], v[68:71], v[96:99], v[32:35]
    s_waitcnt vmcnt(14)
    v_max3_u32 v149, v100, v101, v102
    v_max3_u32 v149, v149, v103, v104
    v_mfma_f32_16x16x32_bf16 v[36:39], v[72:75], v[92:95], v[36:39]
    v_max3_u32 v149, v149, v105, v106
    v_max_u32 v149, v149, v107
    v_cmp_eq_u32 vcc, -1, v149
    v_mfma_f32_16x16x32_bf16 v[40:43], v[72:75], v[96:99], v[40:43]
    s_cbranch_vccnz so_stub_12
so_back_12:
    s_waitcnt lgkmcnt(0)
    v_mfma_f32_16x16x32_bf16 v[12:15], v[44:47], v[100:103], v[12:15]
    ds_read_b64_tr_b16 v[60:61], v229 offset:20480
    ds_read_b64_tr_b16 v[62:63], v229 offset:20992
    v_mfma_f32_16x16x32_bf16 v[16:19], v[44:47], v[104:107], v[16:19]
    ds_read_b64_tr_b16 v[64:65], v230 offset:20480
    ds_read_b64_tr_b16 v[66:67], v230 offset:20992
    v_mfma_f32_16x16x32_bf16 v[20:23], v[48:51], v[100:103], v[20:23]
    ds_read_b64_tr_b16 v[68:69], v231 offset:20480
    ds_read_b64_tr_b16 v[70:71], v231 offset:20992
    v_mfma_f32_16x16x32_bf16 v[24:27], v[48:51], v[104:107], v[24:27]
    ds_read_b64_tr_b16 v[72:73], v232 offset:20480
    ds_read_b64_tr_b16 v[74:75], v232 offset:20992
    s_add_u32 s30, s61, 30720
    buffer_load_dwordx4 v[92:95], v4, s[4:7], s30 offen sc1
    v_mfma_f32_16x16x32_bf16 v[28:31], v[52:55], v[100:103], v[28:31]
    buffer_load_dwordx4 v[96:99], v148, s[4:7], s30 offen sc1
    v_mfma_f32_16x16x32_bf16 v[32:35], v[52:55], v[104:107], v[32:35]
    s_waitcnt vmcnt(14)
    v_max3_u32 v149, v108, v109, v110
    v_max3_u32 v149, v149, v111, v112
    v_mfma_f32_16x16x32_bf16 v[36:39], v[56:59], v[100:103], v[36:39]
    v_max3_u32 v149, v149, v113, v114
    v_max_u32 v149, v149, v115
    v_cmp_eq_u32 vcc, -1, v149
    v_mfma_f32_16x16x32_bf16 v[40:43], v[56:59], v[104:107], v[40:43]
    s_cbranch_vccnz so_stub_13
so_back_13:
    s_waitcnt lgkmcnt(0)
    v_mfma_f32_16x16x32_bf16 v[12:15], v[60:63], v[108:111], v[12:15]
    ds_read_b64_tr_b16 v[44:45], v229 offset:32768
    ds_read_b64_tr_b16 v[46:47], v229 offset:33280
    v_mfma_f32_16x16x32_bf16 v[16:19], v[60:63], v[112:115], v[16:19]
    ds_read_b64_tr_b16 v[48:49], v230 offset:32768
    ds_read_b64_tr_b16 v[50:51], v230 offset:33280
    v_mfma_f32_16x16x32_bf16 v[20:23], v[64:67], v[108:111], v[20:23]
    ds_read_b64_tr_b16 v[52:53], v231 offset:32768
    ds_read_b64_tr_b16 v[54:55], v231 offset:33280
    v_mfma_f32_16x16x32_bf16 v[24:27], v[64:67], v[112:115], v[24:27]
    ds_read_b64_tr_b16 v[56:57], v232 offset:32768
    ds_read_b64_tr_b16 v[58:59], v232 offset:33280
    s_add_u32 s31, s61, 31744
    buffer_load_dwordx4 v[100:103], v4, s[4:7], s31 offen sc1
    v_mfma_f32_16x16x32_bf16 v[28:31], v[68:71], v[108:111], v[28:31]
    buffer_load_dwordx4 v[104:107], v148, s[4:7], s31 offen sc1
    v_mfma_f32_16x16x32_bf16 v[32:35], v[68:71], v[112:115], v[32:35]
    s_waitcnt vmcnt(14)
    v_max3_u32 v149, v116, v117, v118
    v_max3_u32 v149, v149, v119, v120
    v_mfma_f32_16x16x32_bf16 v[36:39], v[72:75], v[108:111], v[36:39]
    v_max3_u32 v149, v149, v121, v122
    v_max_u32 v149, v149, v123
    v_cmp_eq_u32 vcc, -1, v149
    v_mfma_f32_16x16x32_bf16 v[40:43], v[72:75], v[112:115], v[40:43]
    s_cbranch_vccnz so_stub_14
so_back_14:
    s_waitcnt lgkmcnt(0)
    v_mfma_f32_16x16x32_bf16 v[12:15], v[44:47], v[116:119], v[12:15]
    ds_read_b64_tr_b16 v[60:61], v229 offset:36864
    ds_read_b64_tr_b16 v[62:63], v229 offset:37376
    v_mfma_f32_16x16x32_bf16 v[16:19], v[44:47], v[120:123], v[16:19]
    ds_read_b64_tr_b16 v[64:65], v230 offset:36864
    ds_read_b64_tr_b16 v[66:67], v230 offset:37376
    v_mfma_f32_16x16x32_bf16 v[20:23], v[48:51], v[116:119], v[20:23]
    ds_read_b64_tr_b16 v[68:69], v231 offset:36864
    ds_read_b64_tr_b16 v[70:71], v231 offset:37376
    v_mfma_f32_16x16x32_bf16 v[24:27], v[48:51], v[120:123], v[24:27]
    ds_read_b64_tr_b16 v[72:73], v232 offset:36864
    ds_read_b64_tr_b16 v[74:75], v232 offset:37376
    s_add_u32 s32, s61, 0
    buffer_load_dwordx4 v[108:111], v4, s[4:7], s32 offen sc1
    v_mfma_f32_16x16x32_bf16 v[28:31], v[52:55], v[116:119], v[28:31]
    buffer_load_dwordx4 v[112:115], v148, s[4:7], s32 offen sc1
    v_mfma_f32_16x16x32_bf16 v[32:35], v[52:55], v[120:123], v[32:35]
    s_waitcnt vmcnt(14)
    v_max3_u32 v149, v124, v125, v126
    v_max3_u32 v149, v149, v127, v128
    v_mfma_f32_16x16x32_bf16 v[36:39], v[56:59], v[116:119], v[36:39]
    v_max3_u32 v149, v149, v129, v130
    v_max_u32 v149, v149, v131
    v_cmp_eq_u32 vcc, -1, v149
    v_mfma_f32_16x16x32_bf16 v[40:43], v[56:59], v[120:123], v[40:43]
    s_cbranch_vccnz so_stub_15
so_back_15:
    s_waitcnt lgkmcnt(0)
    v_mfma_f32_16x16x32_bf16 v[12:15], v[60:63], v[124:127], v[12:15]
    ds_read_b64_tr_b16 v[44:45], v229 offset:40960
    ds_read_b64_tr_b16 v[46:47], v229 offset:41472
    v_mfma_f32_16x16x32_bf16 v[16:19], v[60:63], v[128:131], v[16:19]
    ds_read_b64_tr_b16 v[48:49], v230 offset:40960
    ds_read_b64_tr_b16 v[50:51], v230 offset:41472
    v_mfma_f32_16x16x32_bf16 v[20:23], v[64:67], v[124:127], v[20:23]
    ds_read_b64_tr_b16 v[52:53], v231 offset:40960
    ds_read_b64_tr_b16 v[54:55], v231 offset:41472
    v_mfma_f32_16x16x32_bf16 v[24:27], v[64:67], v[128:131], v[24:27]
    ds_read_b64_tr_b16 v[56:57], v232 offset:40960
    ds_read_b64_tr_b16 v[58:59], v232 offset:41472
    s_add_u32 s33, s61, 1024
    buffer_load_dwordx4 v[116:119], v4, s[4:7], s33 offen sc1
    v_mfma_f32_16x16x32_bf16 v[28:31], v[68:71], v[124:127], v[28:31]
    buffer_load_dwordx4 v[120:123], v148, s[4:7], s33 offen sc1
    v_mfma_f32_16x16x32_bf16 v[32:35], v[68:71], v[128:131], v[32:35]
    s_waitcnt vmcnt(14)
    v_max3_u32 v149, v132, v133, v134
    v_max3_u32 v149, v149, v135, v136
    v_mfma_f32_16x16x32_bf16 v[36:39], v[72:75], v[124:127], v[36:39]
    v_max3_u32 v149, v149, v137, v138
    v_max_u32 v149, v149, v139
    v_cmp_eq_u32 vcc, -1, v149
    v_mfma_f32_16x16x32_bf16 v[40:43], v[72:75], v[128:131], v[40:43]
    s_cbranch_vccnz so_stub_16
so_back_16:
    s_waitcnt lgkmcnt(0)
    v_mfma_f32_16x16x32_bf16 v[12:15], v[44:47], v[132:135], v[12:15]
    ds_read_b64_tr_b16 v[60:61], v229 offset:45056
    ds_read_b64_tr_b16 v[62:63], v229 offset:45568
    v_mfma_f32_16x16x32_bf16 v[16:19], v[44:47], v[136:139], v[16:19]
    ds_read_b64_tr_b16 v[64:65], v230 offset:45056
    ds_read_b64_tr_b16 v[66:67], v230 offset:45568
    v_mfma_f32_16x16x32_bf16 v[20:23], v[48:51], v[132:135], v[20:23]
    ds_read_b64_tr_b16 v[68:69], v231 offset:45056
    ds_read_b64_tr_b16 v[70:71], v231 offset:45568
    v_mfma_f32_16x16x32_bf16 v[24:27], v[48:51], v[136:139], v[24:27]
    ds_read_b64_tr_b16 v[72:73], v232 offset:45056
    ds_read_b64_tr_b16 v[74:75], v232 offset:45568
    s_add_u32 s34, s61, 2048
    buffer_load_dwordx4 v[124:127], v4, s[4:7], s34 offen sc1
    v_mfma_f32_16x16x32_bf16 v[28:31], v[52:55], v[132:135], v[28:31]
    buffer_load_dwordx4 v[128:131], v148, s[4:7], s34 offen sc1
    v_mfma_f32_16x16x32_bf16 v[32:35], v[52:55], v[136:139], v[32:35]
    s_waitcnt vmcnt(14)
    v_max3_u32 v149, v140, v141, v142
    v_max3_u32 v149, v149, v143, v144
    v_mfma_f32_16x16x32_bf16 v[36:39], v[56:59], v[132:135], v[36:39]
    v_max3_u32 v149, v149, v145, v146
    v_max_u32 v149, v149, v147
    v_cmp_eq_u32 vcc, -1, v149
    v_mfma_f32_16x16x32_bf16 v[40:43], v[56:59], v[136:139], v[40:43]
    s_cbranch_vccnz so_stub_17
so_back_17:
    s_waitcnt lgkmcnt(0)
    v_mfma_f32_16x16x32_bf16 v[12:15], v[60:63], v[140:143], v[12:15]
    ds_read_b64_tr_b16 v[44:45], v229 offset:49152
    ds_read_b64_tr_b16 v[46:47], v229 offset:49664
    v_mfma_f32_16x16x32_bf16 v[16:19], v[60:63], v[144:147], v[16:19]
    ds_read_b64_tr_b16 v[48:49], v230 offset:49152
    ds_read_b64_tr_b16 v[50:51], v230 offset:49664
    v_mfma_f32_16x16x32_bf16 v[20:23], v[64:67], v[140:143], v[20:23]
    ds_read_b64_tr_b16 v[52:53], v231 offset:49152
    ds_read_b64_tr_b16 v[54:55], v231 offset:49664
    v_mfma_f32_16x16x32_bf16 v[24:27], v[64:67], v[144:147], v[24:27]
    ds_read_b64_tr_b16 v[56:57], v232 offset:49152
    ds_read_b64_tr_b16 v[58:59], v232 offset:49664
    s_add_u32 s35, s61, 3072
    buffer_load_dwordx4 v[132:135], v4, s[4:7], s35 offen sc1
    v_mfma_f32_16x16x32_bf16 v[28:31], v[68:71], v[140:143], v[28:31]
    buffer_load_dwordx4 v[136:139], v148, s[4:7], s35 offen sc1
    v_mfma_f32_16x16x32_bf16 v[32:35], v[68:71], v[144:147], v[32:35]
    s_waitcnt vmcnt(14)
    v_max3_u32 v149, v76, v77, v78
    v_max3_u32 v149, v149, v79, v80
    v_mfma_f32_16x16x32_bf16 v[36:39], v[72:75], v[140:143], v[36:39]
    v_max3_u32 v149, v149, v81, v82
    v_max_u32 v149, v149, v83
    v_cmp_eq_u32 vcc, -1, v149
    v_mfma_f32_16x16x32_bf16 v[40:43], v[72:75], v[144:147], v[40:43]
    s_cbranch_vccnz so_stub_18
so_back_18:
    s_waitcnt lgkmcnt(0)
    v_mfma_f32_16x16x32_bf16 v[12:15], v[44:47], v[76:79], v[12:15]
    ds_read_b64_tr_b16 v[60:61], v229 offset:53248
    ds_read_b64_tr_b16 v[62:63], v229 offset:53760
    v_mfma_f32_16x16x32_bf16 v[16:19], v[44:47], v[80:83], v[16:19]
    ds_read_b64_tr_b16 v[64:65], v230 offset:53248
    ds_read_b64_tr_b16 v[66:67], v230 offset:53760
    v_mfma_f32_16x16x32_bf16 v[20:23], v[48:51], v[76:79], v[20:23]
    ds_read_b64_tr_b16 v[68:69], v231 offset:53248
    ds_read_b64_tr_b16 v[70:71], v231 offset:53760
    v_mfma_f32_16x16x32_bf16 v[24:27], v[48:51], v[80:83], v[24:27]
    ds_read_b64_tr_b16 v[72:73], v232 offset:53248
    ds_read_b64_tr_b16 v[74:75], v232 offset:53760
    s_add_u32 s8, s61, 4096
    buffer_load_dwordx4 v[140:143], v4, s[4:7], s8 offen sc1
    v_mfma_f32_16x16x32_bf16 v[28:31], v[52:55], v[76:79], v[28:31]
    buffer_load_dwordx4 v[144:147], v148, s[4:7], s8 offen sc1
    v_mfma_f32_16x16x32_bf16 v[32:35], v[52:55], v[80:83], v[32:35]
    s_waitcnt vmcnt(14)
    v_max3_u32 v149, v84, v85, v86
    v_max3_u32 v149, v149, v87, v88
    v_mfma_f32_16x16x32_bf16 v[36:39], v[56:59], v[76:79], v[36:39]
    v_max3_u32 v149, v149, v89, v90
    v_max_u32 v149, v149, v91
    v_cmp_eq_u32 vcc, -1, v149
    v_mfma_f32_16x16x32_bf16 v[40:43], v[56:59], v[80:83], v[40:43]
    s_cbranch_vccnz so_stub_19
so_back_19:
    s_waitcnt lgkmcnt(0)
    v_mfma_f32_16x16x32_bf16 v[12:15], v[60:63], v[84:87], v[12:15]
    ds_read_b64_tr_b16 v[44:45], v229 offset:57344
    ds_read_b64_tr_b16 v[46:47], v229 offset:57856
    v_mfma_f32_16x16x32_bf16 v[16:19], v[60:63], v[88:91], v[16:19]
    ds_read_b64_tr_b16 v[48:49], v230 offset:57344
    ds_read_b64_tr_b16 v[50:51], v230 offset:57856
    v_mfma_f32_16x16x32_bf16 v[20:23], v[64:67], v[84:87], v[20:23]
    ds_read_b64_tr_b16 v[52:53], v231 offset:57344
    ds_read_b64_tr_b16 v[54:55], v231 offset:57856
    v_mfma_f32_16x16x32_bf16 v[24:27], v[64:67], v[88:91], v[24:27]
    ds_read_b64_tr_b16 v[56:57], v232 offset:57344
    ds_read_b64_tr_b16 v[58:59], v232 offset:57856
    s_add_u32 s28, s61, 5120
    buffer_load_dwordx4 v[76:79], v4, s[4:7], s28 offen sc1
    v_mfma_f32_16x16x32_bf16 v[28:31], v[68:71], v[84:87], v[28:31]
    buffer_load_dwordx4 v[80:83], v148, s[4:7], s28 offen sc1
    v_mfma_f32_16x16x32_bf16 v[32:35], v[68:71], v[88:91], v[32:35]
    s_waitcnt vmcnt(14)
    v_max3_u32 v149, v92, v93, v94
    v_max3_u32 v149, v149, v95, v96
    v_mfma_f32_16x16x32_bf16 v[36:39], v[72:75], v[84:87], v[36:39]
    v_max3_u32 v149, v149, v97, v98
    v_max_u32 v149, v149, v99
    v_cmp_eq_u32 vcc, -1, v149
    v_mfma_f32_16x16x32_bf16 v[40:43], v[72:75], v[88:91], v[40:43]
    s_cbranch_vccnz so_stub_20
so_back_20:
    s_waitcnt lgkmcnt(0)
    v_mfma_f32_16x16x32_bf16 v[12:15], v[44:47], v[92:95], v[12:15]
    ds_read_b64_tr_b16 v[60:61], v229 offset:61440
    ds_read_b64_tr_b16 v[62:63], v229 offset:61952
    v_mfma_f32_16x16x32_bf16 v[16:19], v[44:47], v[96:99], v[16:19]
    ds_read_b64_tr_b16 v[64:65], v230 offset:61440
    ds_read_b64_tr_b16 v[66:67], v230 offset:61952
    v_mfma_f32_16x16x32_bf16 v[20:23], v[48:51], v[92:95], v[20:23]
    ds_read_b64_tr_b16 v[68:69], v231 offset:61440
    ds_read_b64_tr_b16 v[70:71], v231 offset:61952
    v_mfma_f32_16x16x32_bf16 v[24:27], v[48:51], v[96:99], v[24:27]
    ds_read_b64_tr_b16 v[72:73], v232 offset:61440
    ds_read_b64_tr_b16 v[74:75], v232 offset:61952
    s_add_u32 s29, s61, 6144
    buffer_load_dwordx4 v[84:87], v4, s[4:7], s29 offen sc1
    v_mfma_f32_16x16x32_bf16 v[28:31], v[52:55], v[92:95], v[28:31]
    buffer_load_dwordx4 v[88:91], v148, s[4:7], s29 offen sc1
    v_mfma_f32_16x16x32_bf16 v[32:35], v[52:55], v[96:99], v[32:35]
    s_waitcnt vmcnt(14)
    v_max3_u32 v149, v100, v101, v102
    v_max3_u32 v149, v149, v103, v104
    v_mfma_f32_16x16x32_bf16 v[36:39], v[56:59], v[92:95], v[36:39]
    v_max3_u32 v149, v149, v105, v106
    v_max_u32 v149, v149, v107
    v_cmp_eq_u32 vcc, -1, v149
    v_mfma_f32_16x16x32_bf16 v[40:43], v[56:59], v[96:99], v[40:43]
    s_cbranch_vccnz so_stub_21
so_back_21:
    s_waitcnt lgkmcnt(0)
    v_mfma_f32_16x16x32_bf16 v[12:15], v[60:63], v[100:103], v[12:15]
    ds_read_b64_tr_b16 v[44:45], v225 offset:0
    ds_read_b64_tr_b16 v[46:47], v225 offset:512
    v_mfma_f32_16x16x32_bf16 v[16:19], v[60:63], v[104:107], v[16:19]
    ds_read_b64_tr_b16 v[48:49], v226 offset:0
    ds_read_b64_tr_b16 v[50:51], v226 offset:512
    v_mfma_f32_16x16x32_bf16 v[20:23], v[64:67], v[100:103], v[20:23]
    ds_read_b64_tr_b16 v[52:53], v227 offset:0
    ds_read_b64_tr_b16 v[54:55], v227 offset:512
    v_mfma_f32_16x16x32_bf16 v[24:27], v[64:67], v[104:107], v[24:27]
    ds_read_b64_tr_b16 v[56:57], v228 offset:0
    ds_read_b64_tr_b16 v[58:59], v228 offset:512
    s_add_u32 s30, s61, 7168
    buffer_load_dwordx4 v[92:95], v4, s[4:7], s30 offen sc1
    v_mfma_f32_16x16x32_bf16 v[28:31], v[68:71], v[100:103], v[28:31]
    buffer_load_dwordx4 v[96:99], v148, s[4:7], s30 offen sc1
    v_mfma_f32_16x16x32_bf16 v[32:35], v[68:71], v[104:107], v[32:35]
    s_waitcnt vmcnt(14)
    v_max3_u32 v149, v108, v109, v110
    v_max3_u32 v149, v149, v111, v112
    v_mfma_f32_16x16x32_bf16 v[36:39], v[72:75], v[100:103], v[36:39]
    v_max3_u32 v149, v149, v113, v114
    v_max_u32 v149, v149, v115
    v_cmp_eq_u32 vcc, -1, v149
    v_mfma_f32_16x16x32_bf16 v[40:43], v[72:75], v[104:107], v[40:43]
    s_cbranch_vccnz so_stub_22
so_back_22:
    s_waitcnt lgkmcnt(0)
    v_mfma_f32_16x16x32_bf16 v[12:15], v[44:47], v[108:111], v[12:15]
    ds_read_b64_tr_b16 v[60:61], v225 offset:4096
    ds_read_b64_tr_b16 v[62:63], v225 offset:4608
    v_mfma_f32_16x16x32_bf16 v[16:19], v[44:47], v[112:115], v[16:19]
    ds_read_b64_tr_b16 v[64:65], v226 offset:4096
    ds_read_b64_tr_b16 v[66:67], v226 offset:4608
    v_mfma_f32_16x16x32_bf16 v[20:23], v[48:51], v[108:111], v[20:23]
    ds_read_b64_tr_b16 v[68:69], v227 offset:4096
    ds_read_b64_tr_b16 v[70:71], v227 offset:4608
    v_mfma_f32_16x16x32_bf16 v[24:27], v[48:51], v[112:115], v[24:27]
    ds_read_b64_tr_b16 v[72:73], v228 offset:4096
    ds_read_b64_tr_b16 v[74:75], v228 offset:4608
    s_add_u32 s31, s61, 22528
    buffer_load_dwordx4 v[100:103], v4, s[4:7], s31 offen sc1
    v_mfma_f32_16x16x32_bf16 v[28:31], v[52:55], v[108:111], v[28:31]
    buffer_load_dwordx4 v[104:107], v148, s[4:7], s31 offen sc1
    v_mfma_f32_16x16x32_bf16 v[32:35], v[52:55], v[112:115], v[32:35]
    s_waitcnt vmcnt(14)
    v_max3_u32 v149, v116, v117, v118
    v_max3_u32 v149, v149, v119, v120
    v_mfma_f32_16x16x32_bf16 v[36:39], v[56:59], v[108:111], v[36:39]
    v_max3_u32 v149, v149, v121, v122
    v_max_u32 v149, v149, v123
    v_cmp_eq_u32 vcc, -1, v149
    v_mfma_f32_16x16x32_bf16 v[40:43], v[56:59], v[112:115], v[40:43]
    s_cbranch_vccnz so_stub_23
so_back_23:
    s_waitcnt lgkmcnt(0)
    v_mfma_f32_16x16x32_bf16 v[12:15], v[60:63], v[116:119], v[12:15]
    ds_read_b64_tr_b16 v[44:45], v225 offset:8192
    ds_read_b64_tr_b16 v[46:47], v225 offset:8704
    v_mfma_f32_16x16x32_bf16 v[16:19], v[60:63], v[120:123], v[16:19]
    ds_read_b64_tr_b16 v[48:49], v226 offset:8192
    ds_read_b64_tr_b16 v[50:51], v226 offset:8704
    v_mfma_f32_16x16x32_bf16 v[20:23], v[64:67], v[116:119], v[20:23]
    ds_read_b64_tr_b16 v[52:53], v227 offset:8192
    ds_read_b64_tr_b16 v[54:55], v227 offset:8704
    v_mfma_f32_16x16x32_bf16 v[24:27], v[64:67], v[120:123], v[24:27]
    ds_read_b64_tr_b16 v[56:57], v228 offset:8192
    ds_read_b64_tr_b16 v[58:59], v228 offset:8704
    s_add_u32 s32, s61, 23552
    buffer_load_dwordx4 v[108:111], v4, s[4:7], s32 offen sc1
    v_mfma_f32_16x16x32_bf16 v[28:31], v[68:71], v[116:119], v[28:31]
    buffer_load_dwordx4 v[112:115], v148, s[4:7], s32 offen sc1
    v_mfma_f32_16x16x32_bf16 v[32:35], v[68:71], v[120:123], v[32:35]
    s_waitcnt vmcnt(14)
    v_max3_u32 v149, v124, v125, v126
    v_max3_u32 v149, v149, v127, v128
    v_mfma_f32_16x16x32_bf16 v[36:39], v[72:75], v[116:119], v[36:39]
    v_max3_u32 v149, v149, v129, v130
    v_max_u32 v149, v149, v131
    v_cmp_eq_u32 vcc, -1, v149
    v_mfma_f32_16x16x32_bf16 v[40:43], v[72:75], v[120:123], v[40:43]
    s_cbranch_vccnz so_stub_24
so_back_24:
    s_waitcnt lgkmcnt(0)
    v_mfma_f32_16x16x32_bf16 v[12:15], v[44:47], v[124:127], v[12:15]
    ds_read_b64_tr_b16 v[60:61], v225 offset:12288
    ds_read_b64_tr_b16 v[62:63], v225 offset:12800
    v_mfma_f32_16x16x32_bf16 v[16:19], v[44:47], v[128:131], v[16:19]
    ds_read_b64_tr_b16 v[64:65], v226 offset:12288
    ds_read_b64_tr_b16 v[66:67], v226 offset:12800
    v_mfma_f32_16x16x32_bf16 v[20:23], v[48:51], v[124:127], v[20:23]
    ds_read_b64_tr_b16 v[68:69], v227 offset:12288
    ds_read_b64_tr_b16 v[70:71], v227 offset:12800
    v_mfma_f32_16x16x32_bf16 v[24:27], v[48:51], v[128:131], v[24:27]
    ds_read_b64_tr_b16 v[72:73], v228 offset:12288
    ds_read_b64_tr_b16 v[74:75], v228 offset:12800
    v_mfma_f32_16x16x32_bf16 v[28:31], v[52:55], v[124:127], v[28:31]
    v_mfma_f32_16x16x32_bf16 v[32:35], v[52:55], v[128:131], v[32:35]
    s_waitcnt vmcnt(12)
    v_max3_u32 v149, v132, v133, v134
    v_max3_u32 v149, v149, v135, v136
    v_mfma_f32_16x16x32_bf16 v[36:39], v[56:59], v[124:127], v[36:39]
    v_max3_u32 v149, v149, v137, v138
    v_max_u32 v149, v149, v139
    v_cmp_eq_u32 vcc, -1, v149
    v_mfma_f32_16x16x32_bf16 v[40:43], v[56:59], v[128:131], v[40:43]
    s_cbranch_vccnz so_stub_25
so_back_25:
    s_waitcnt lgkmcnt(0)
    v_mfma_f32_16x16x32_bf16 v[12:15], v[60:63], v[132:135], v[12:15]
    ds_read_b64_tr_b16 v[44:45], v225 offset:16384
    ds_read_b64_tr_b16 v[46:47], v225 offset:16896
    v_mfma_f32_16x16x32_bf16 v[16:19], v[60:63], v[136:139], v[16:19]
    ds_read_b64_tr_b16 v[48:49], v226 offset:16384
    ds_read_b64_tr_b16 v[50:51], v226 offset:16896
    v_mfma_f32_16x16x32_bf16 v[20:23], v[64:67], v[132:135], v[20:23]
    ds_read_b64_tr_b16 v[52:53], v227 offset:16384
    ds_read_b64_tr_b16 v[54:55], v227 offset:16896
    v_mfma_f32_16x16x32_bf16 v[24:27], v[64:67], v[136:139], v[24:27]
    ds_read_b64_tr_b16 v[56:57], v228 offset:16384
    ds_read_b64_tr_b16 v[58:59], v228 offset:16896
    v_mfma_f32_16x16x32_bf16 v[28:31], v[68:71], v[132:135], v[28:31]
    v_mfma_f32_16x16x32_bf16 v[32:35], v[68:71], v[136:139], v[32:35]
    s_waitcnt vmcnt(10)
    v_max3_u32 v149, v140, v141, v142
    v_max3_u32 v149, v149, v143, v144
    v_mfma_f32_16x16x32_bf16 v[36:39], v[72:75], v[132:135], v[36:39]
    v_max3_u32 v149, v149, v145, v146
    v_max_u32 v149, v149, v147
    v_cmp_eq_u32 vcc, -1, v149
    v_mfma_f32_16x16x32_bf16 v[40:43], v[72:75], v[136:139], v[40:43]
    s_cbranch_vccnz so_stub_26
so_back_26:
    s_waitcnt lgkmcnt(0)
    v_mfma_f32_16x16x32_bf16 v[12:15], v[44:47], v[140:143], v[12:15]
    ds_read_b64_tr_b16 v[60:61], v225 offset:20480
    ds_read_b64_tr_b16 v[62:63], v225 offset:20992
    v_mfma_f32_16x16x32_bf16 v[16:19], v[44:47], v[144:147], v[16:19]
    ds_read_b64_tr_b16 v[64:65], v226 offset:20480
    ds_read_b64_tr_b16 v[66:67], v226 offset:20992
    v_mfma_f32_16x16x32_bf16 v[20:23], v[48:51], v[140:143], v[20:23]
    ds_read_b64_tr_b16 v[68:69], v227 offset:20480
    ds_read_b64_tr_b16 v[70:71], v227 offset:20992
    v_mfma_f32_16x16x32_bf16 v[24:27], v[48:51], v[144:147], v[24:27]
    ds_read_b64_tr_b16 v[72:73], v228 offset:20480
    ds_read_b64_tr_b16 v[74:75], v228 offset:20992
    v_mfma_f32_16x16x32_bf16 v[28:31], v[52:55], v[140:143], v[28:31]
    v_mfma_f32_16x16x32_bf16 v[32:35], v[52:55], v[144:147], v[32:35]
    s_waitcnt vmcnt(8)
    v_max3_u32 v149, v76, v77, v78
    v_max3_u32 v149, v149, v79, v80
    v_mfma_f32_16x16x32_bf16 v[36:39], v[56:59], v[140:143], v[36:39]
    v_max3_u32 v149, v149, v81, v82
    v_max_u32 v149, v149, v83
    v_cmp_eq_u32 vcc, -1, v149
    v_mfma_f32_16x16x32_bf16 v[40:43], v[56:59], v[144:147], v[40:43]
    s_cbranch_vccnz so_stub_27
so_back_27:
    s_waitcnt lgkmcnt(0)
    v_mfma_f32_16x16x32_bf16 v[12:15], v[60:63], v[76:79], v[12:15]
    ds_read_b64_tr_b16 v[44:45], v225 offset:24576
    ds_read_b64_tr_b16 v[46:47], v225 offset:25088
    v_mfma_f32_16x16x32_bf16 v[16:19], v[60:63], v[80:83], v[16:19]
    ds_read_b64_tr_b16 v[48:49], v226 offset:24576
    ds_read_b64_tr_b16 v[50:51], v226 offset:25088
    v_mfma_f32_16x16x32_bf16 v[20:23], v[64:67], v[76:79], v[20:23]
    ds_read_b64_tr_b16 v[52:53], v227 offset:24576
    ds_read_b64_tr_b16 v[54:55], v227 offset:25088
    v_mfma_f32_16x16x32_bf16 v[24:27], v[64:67], v[80:83], v[24:27]
    ds_read_b64_tr_b16 v[56:57], v228 offset:24576
    ds_read_b64_tr_b16 v[58:59], v228 offset:25088
    v_mfma_f32_16x16x32_bf16 v[28:31], v[68:71], v[76:79], v[28:31]
    v_mfma_f32_16x16x32_bf16 v[32:35], v[68:71], v[80:83], v[32:35]
    s_waitcnt vmcnt(6)
    v_max3_u32 v149, v84, v85, v86
    v_max3_u32 v149, v149, v87, v88
    v_mfma_f32_16x16x32_bf16 v[36:39], v[72:75], v[76:79], v[36:39]
    v_max3_u32 v149, v149, v89, v90
    v_max_u32 v149, v149, v91
    v_cmp_eq_u32 vcc, -1, v149
    v_mfma_f32_16x16x32_bf16 v[40:43], v[72:75], v[80:83], v[40:43]
    s_cbranch_vccnz so_stub_28
so_back_28:
    s_waitcnt lgkmcnt(0)
    v_mfma_f32_16x16x32_bf16 v[12:15], v[44:47], v[84:87], v[12:15]
    ds_read_b64_tr_b16 v[60:61], v225 offset:28672
    ds_read_b64_tr_b16 v[62:63], v225 offset:29184
    v_mfma_f32_16x16x32_bf16 v[16:19], v[44:47], v[88:91], v[16:19]
    ds_read_b64_tr_b16 v[64:65], v226 offset:28672
    ds_read_b64_tr_b16 v[66:67], v226 offset:29184
    v_mfma_f32_16x16x32_bf16 v[20:23], v[48:51], v[84:87], v[20:23]
    ds_read_b64_tr_b16 v[68:69], v227 offset:28672
    ds_read_b64_tr_b16 v[70:71], v227 offset:29184
    v_mfma_f32_16x16x32_bf16 v[24:27], v[48:51], v[88:91], v[24:27]
    ds_read_b64_tr_b16 v[72:73], v228 offset:28672
    ds_read_b64_tr_b16 v[74:75], v228 offset:29184
    v_mfma_f32_16x16x32_bf16 v[28:31], v[52:55], v[84:87], v[28:31]
    v_mfma_f32_16x16x32_bf16 v[32:35], v[52:55], v[88:91], v[32:35]
    s_waitcnt vmcnt(4)
    v_max3_u32 v149, v92, v93, v94
    v_max3_u32 v149, v149, v95, v96
    v_mfma_f32_16x16x32_bf16 v[36:39], v[56:59], v[84:87], v[36:39]
    v_max3_u32 v149, v149, v97, v98
    v_max_u32 v149, v149, v99
    v_cmp_eq_u32 vcc, -1, v149
    v_mfma_f32_16x16x32_bf16 v[40:43], v[56:59], v[88:91], v[40:43]
    s_cbranch_vccnz so_stub_29
so_back_29:
    s_waitcnt lgkmcnt(0)
    v_mfma_f32_16x16x32_bf16 v[12:15], v[60:63], v[92:95], v[12:15]
    ds_read_b64_tr_b16 v[44:45], v229 offset:24576
    ds_read_b64_tr_b16 v[46:47], v229 offset:25088
    v_mfma_f32_16x16x32_bf16 v[16:19], v[60:63], v[96:99], v[16:19]
    ds_read_b64_tr_b16 v[48:49], v230 offset:24576
    ds_read_b64_tr_b16 v[50:51], v230 offset:25088
    v_mfma_f32_16x16x32_bf16 v[20:23], v[64:67], v[92:95], v[20:23]
    ds_read_b64_tr_b16 v[52:53], v231 offset:24576
    ds_read_b64_tr_b16 v[54:55], v231 offset:25088
    v_mfma_f32_16x16x32_bf16 v[24:27], v[64:67], v[96:99], v[24:27]
    ds_read_b64_tr_b16 v[56:57], v232 offset:24576
    ds_read_b64_tr_b16 v[58:59], v232 offset:25088
    v_mfma_f32_16x16x32_bf16 v[28:31], v[68:71], v[92:95], v[28:31]
    v_mfma_f32_16x16x32_bf16 v[32:35], v[68:71], v[96:99], v[32:35]
    s_waitcnt vmcnt(2)
    v_max3_u32 v149, v100, v101, v102
    v_max3_u32 v149, v149, v103, v104
    v_mfma_f32_16x16x32_bf16 v[36:39], v[72:75], v[92:95], v[36:39]
    v_max3_u32 v149, v149, v105, v106
    v_max_u32 v149, v149, v107
    v_cmp_eq_u32 vcc, -1, v149
    v_mfma_f32_16x16x32_bf16 v[40:43], v[72:75], v[96:99], v[40:43]
    s_cbranch_vccnz so_stub_30
so_back_30:
    s_waitcnt lgkmcnt(0)
    v_mfma_f32_16x16x32_bf16 v[12:15], v[44:47], v[100:103], v[12:15]
    ds_read_b64_tr_b16 v[60:61], v229 offset:28672
    ds_read_b64_tr_b16 v[62:63], v229 offset:29184
    v_mfma_f32_16x16x32_bf16 v[16:19], v[44:47], v[104:107], v[16:19]
    ds_read_b64_tr_b16 v[64:65], v230 offset:28672
    ds_read_b64_tr_b16 v[66:67], v230 offset:29184
    v_mfma_f32_16x16x32_bf16 v[20:23], v[48:51], v[100:103], v[20:23]
    ds_read_b64_tr_b16 v[68:69], v231 offset:28672
    ds_read_b64_tr_b16 v[70:71], v231 offset:29184
    v_mfma_f32_16x16x32_bf16 v[24:27], v[48:51], v[104:107], v[24:27]
    ds_read_b64_tr_b16 v[72:73], v232 offset:28672
    ds_read_b64_tr_b16 v[74:75], v232 offset:29184
    v_mfma_f32_16x16x32_bf16 v[28:31], v[52:55], v[100:103], v[28:31]
    v_mfma_f32_16x16x32_bf16 v[32:35], v[52:55], v[104:107], v[32:35]
    s_waitcnt vmcnt(0)
    v_max3_u32 v149, v108, v109, v110
    v_max3_u32 v149, v149, v111, v112
    v_mfma_f32_16x16x32_bf16 v[36:39], v[56:59], v[100:103], v[36:39]
    v_max3_u32 v149, v149, v113, v114
    v_max_u32 v149, v149, v115
    v_cmp_eq_u32 vcc, -1, v149
    v_mfma_f32_16x16x32_bf16 v[40:43], v[56:59], v[104:107], v[40:43]
    s_cbranch_vccnz so_stub_31
so_back_31:
    s_waitcnt lgkmcnt(0)
    v_mfma_f32_16x16x32_bf16 v[12:15], v[60:63], v[108:111], v[12:15]
    s_add_u32 s48, s42, 1
    s_lshl_b32 s45, s48, 22
    v_mfma_f32_16x16x32_bf16 v[16:19], v[60:63], v[112:115], v[16:19]
    s_lshl_b32 s49, s38, 18
    s_add_u32 s45, s45, s49
    v_mfma_f32_16x16x32_bf16 v[20:23], v[64:67], v[108:111], v[20:23]
    s_lshl_b32 s49, s39, 14
    s_add_u32 s45, s45, s49
    v_mfma_f32_16x16x32_bf16 v[24:27], v[64:67], v[112:115], v[24:27]
    s_lshl_b32 s49, s40, 12
    s_add_u32 s45, s45, s49
    v_mfma_f32_16x16x32_bf16 v[28:31], v[68:71], v[108:111], v[28:31]
    s_lshl_b32 s47, s48, 18
    s_lshl_b32 s49, s38, 14
    v_mfma_f32_16x16x32_bf16 v[32:35], v[68:71], v[112:115], v[32:35]
    s_add_u32 s47, s47, s49
    s_lshl_b32 s49, s39, 10
    v_mfma_f32_16x16x32_bf16 v[36:39], v[72:75], v[108:111], v[36:39]
    s_add_u32 s47, s47, s49
    s_lshl_b32 s49, s40, 8
    v_mfma_f32_16x16x32_bf16 v[40:43], v[72:75], v[112:115], v[40:43]
    s_add_u32 s47, s47, s49
    s_add_u32 s47, s47, 33554432
    v_cvt_pk_bf16_f32 v204, v12, v13
    v_cvt_pk_bf16_f32 v205, v14, v15
    v_cvt_pk_bf16_f32 v206, v20, v21
    v_cvt_pk_bf16_f32 v207, v22, v23
    v_cvt_pk_bf16_f32 v208, v28, v29
    v_cvt_pk_bf16_f32 v209, v30, v31
    v_cvt_pk_bf16_f32 v210, v36, v37
    v_cvt_pk_bf16_f32 v211, v38, v39
    v_cvt_pk_bf16_f32 v212, v16, v17
    v_cvt_pk_bf16_f32 v213, v18, v19
    v_cvt_pk_bf16_f32 v214, v24, v25
    v_cvt_pk_bf16_f32 v215, v26, v27
    v_cvt_pk_bf16_f32 v216, v32, v33
    v_cvt_pk_bf16_f32 v217, v34, v35
    v_cvt_pk_bf16_f32 v218, v40, v41
    v_cvt_pk_bf16_f32 v219, v42, v43
    v_permlane16_swap_b32 v204, v206
    v_permlane16_swap_b32 v205, v207
    v_permlane16_swap_b32 v208, v210
    v_permlane16_swap_b32 v209, v211
    v_permlane16_swap_b32 v212, v214
    v_permlane16_swap_b32 v213, v215
    v_permlane16_swap_b32 v216, v218
    v_permlane16_swap_b32 v217, v219
    s_cmp_eq_u32 s42, 3
    s_cbranch_scc1 b_final
    buffer_store_dwordx4 v[204:207], v223, s[4:7], s45 offen offset:0 sc1
    buffer_store_dwordx4 v[208:211], v223, s[4:7], s45 offen offset:1024 sc1
    buffer_store_dwordx4 v[212:215], v223, s[4:7], s45 offen offset:2048 sc1
    buffer_store_dwordx4 v[216:219], v223, s[4:7], s45 offen offset:3072 sc1
    v_mov_b32 v116, 0x3f803f80
    v_mov_b32 v117, 0x3f803f80
    v_mov_b32 v118, 0x3f803f80
    v_mov_b32 v119, 0x3f803f80
    s_barrier
    s_nop 0
    v_mfma_f32_16x16x32_bf16 v[120:123], v[116:119], v[204:207], 0
    v_mfma_f32_16x16x32_bf16 v[124:127], v[204:207], v[204:207], 0
    v_mfma_f32_16x16x32_bf16 v[128:131], v[116:119], v[212:215], 0
    v_mfma_f32_16x16x32_bf16 v[132:135], v[212:215], v[212:215], 0
    v_mfma_f32_16x16x32_bf16 v[120:123], v[116:119], v[208:211], v[120:123]
    v_mfma_f32_16x16x32_bf16 v[124:127], v[208:211], v[208:211], v[124:127]
    v_mfma_f32_16x16x32_bf16 v[128:131], v[116:119], v[216:219], v[128:131]
    v_mfma_f32_16x16x32_bf16 v[132:135], v[216:219], v[216:219], v[132:135]
    s_nop 5
    v_cndmask_b32 v121, v124, v125, s[88:89]
    v_cndmask_b32 v121, v121, v126, s[90:91]
    v_cndmask_b32 v121, v121, v127, s[92:93]
    v_cndmask_b32 v129, v132, v133, s[88:89]
    v_cndmask_b32 v129, v129, v134, s[90:91]
    v_cndmask_b32 v129, v129, v135, s[92:93]
    s_mov_b64 exec, s[94:95]
    buffer_store_dwordx2 v[120:121], v224, s[4:7], s47 offen offset:0 sc1
    buffer_store_dwordx2 v[128:129], v224, s[4:7], s47 offen offset:128 sc1
    s_mov_b64 exec, -1
    s_lshl_b32 s49, s40, 12
    v_add_u32 v7, s49, v223
    ds_write_b128 v7, v[204:207] offset:0
    ds_write_b128 v7, v[208:211] offset:1024
    ds_write_b128 v7, v[212:215] offset:2048
    ds_write_b128 v7, v[216:219] offset:3072
    v_permlane16_swap_b32 v204, v206
    v_permlane16_swap_b32 v205, v207
    v_permlane16_swap_b32 v208, v210
    v_permlane16_swap_b32 v209, v211
    v_permlane16_swap_b32 v212, v214
    v_permlane16_swap_b32 v213, v215
    v_permlane16_swap_b32 v216, v218
    v_permlane16_swap_b32 v217, v219
    s_lshl_b32 s50, s38, 9
    s_lshl_b32 s49, s40, 7
    s_add_u32 s50, s50, s49
    s_lshl_b32 s49, s39, 2
    s_add_u32 s50, s50, s49
    s_add_u32 s50, s50, 35651584
    s_add_u32 s42, s42, 1
    s_add_u32 s44, s44, 1
    s_mov_b32 s55, -1
    v_mov_b32 v10, v4
    v_add_u32 v11, 1024, v4
    s_waitcnt vmcnt(2)
    s_barrier
    s_waitcnt vmcnt(0)
    v_mov_b32 v7, s44
    s_mov_b64 exec, 1
    buffer_store_dword v7, off, s[4:7], s50 sc1
    s_mov_b64 exec, -1
    s_bitcmp1_b32 s40, 0
    s_cbranch_scc1 a_cons_p1
    s_branch a_cons_p0
so_stub_0:
    s_call_b64 s[12:13], so_fix
    s_branch so_back_0
so_stub_1:
    s_call_b64 s[12:13], so_fix
    s_branch so_back_1
so_stub_2:
    s_call_b64 s[12:13], so_fix
    s_branch so_back_2
so_stub_3:
    s_call_b64 s[12:13], so_fix
    s_branch so_back_3
so_stub_4:
    s_call_b64 s[12:13], so_fix
    s_branch so_back_4
so_stub_5:
    s_call_b64 s[12:13], so_fix
    s_branch so_back_5
so_stub_6:
    s_call_b64 s[12:13], so_fix
    s_branch so_back_6
so_stub_7:
    s_call_b64 s[12:13], so_fix
    s_branch so_back_7
so_stub_8:
    s_call_b64 s[12:13], so_fix
    s_branch so_back_8
so_stub_9:
    s_call_b64 s[12:13], so_fix
    s_branch so_back_9
so_stub_10:
    s_call_b64 s[12:13], so_fix
    s_branch so_back_10
so_stub_11:
    s_call_b64 s[12:13], so_fix
    s_branch so_back_11
so_stub_12:
    s_call_b64 s[12:13], so_fix
    s_branch so_back_12
so_stub_13:
    s_call_b64 s[12:13], so_fix
    s_branch so_back_13
so_stub_14:
    s_call_b64 s[12:13], so_fix
    s_branch so_back_14
so_stub_15:
    s_call_b64 s[12:13], so_fix
    s_branch so_back_15
so_stub_16:
    s_call_b64 s[12:13], so_fix
    s_branch so_back_16
so_stub_17:
    s_call_b64 s[12:13], so_fix
    s_branch so_back_17
so_stub_18:
    s_call_b64 s[12:13], so_fix
    s_branch so_back_18
so_stub_19:
    s_call_b64 s[12:13], so_fix
    s_branch so_back_19
so_stub_20:
    s_call_b64 s[12:13], so_fix
    s_branch so_back_20
so_stub_21:
    s_call_b64 s[12:13], so_fix
    s_branch so_back_21
so_stub_22:
    s_call_b64 s[12:13], so_fix
    s_branch so_back_22
so_stub_23:
    s_call_b64 s[12:13], so_fix
    s_branch so_back_23
so_stub_24:
    s_call_b64 s[12:13], so_fix
    s_branch so_back_24
so_stub_25:
    s_call_b64 s[12:13], so_fix
    s_branch so_back_25
so_stub_26:
    s_call_b64 s[12:13], so_fix
    s_branch so_back_26
so_stub_27:
    s_call_b64 s[12:13], so_fix
    s_branch so_back_27
so_stub_28:
    s_call_b64 s[12:13], so_fix
    s_branch so_back_28
so_stub_29:
    s_call_b64 s[12:13], so_fix
    s_branch so_back_29
so_stub_30:
    s_call_b64 s[12:13], so_fix
    s_branch so_back_30
so_stub_31:
    s_call_b64 s[12:13], so_fix
    s_branch so_back_31
so_fix:
    s_mov_b32 s63, 0
so_fix_loop:
    s_waitcnt vmcnt(0)
    s_mov_b32 s14, 0
    v_max3_u32 v150, v76, v77, v78
    v_max3_u32 v150, v150, v79, v80
    v_max3_u32 v150, v150, v81, v82
    v_max_u32 v150, v150, v83
    v_cmp_eq_u32 vcc, -1, v150
    s_cbranch_vccz so_fix_ok_0
    buffer_load_dwordx4 v[76:79], v4, s[4:7], s28 offen sc1
    buffer_load_dwordx4 v[80:83], v148, s[4:7], s28 offen sc1
    s_mov_b32 s14, 1
so_fix_ok_0:
    v_max3_u32 v150, v84, v85, v86
    v_max3_u32 v150, v150, v87, v88
    v_max3_u32 v150, v150, v89, v90
    v_max_u32 v150, v150, v91
    v_cmp_eq_u32 vcc, -1, v150
    s_cbranch_vccz so_fix_ok_1
    buffer_load_dwordx4 v[84:87], v4, s[4:7], s29 offen sc1
    buffer_load_dwordx4 v[88:91], v148, s[4:7], s29 offen sc1
    s_mov_b32 s14, 1
so_fix_ok_1:
    v_max3_u32 v150, v92, v93, v94
    v_max3_u32 v150, v150, v95, v96
    v_max3_u32 v150, v150, v97, v98
    v_max_u32 v150, v150, v99
    v_cmp_eq_u32 vcc, -1, v150
    s_cbranch_vccz so_fix_ok_2
    buffer_load_dwordx4 v[92:95], v4, s[4:7], s30 offen sc1
    buffer_load_dwordx4 v[96:99], v148, s[4:7], s30 offen sc1
    s_mov_b32 s14, 1
so_fix_ok_2:
    v_max3_u32 v150, v100, v101, v102
    v_max3_u32 v150, v150, v103, v104
    v_max3_u32 v150, v150, v105, v106
    v_max_u32 v150, v150, v107
    v_cmp_eq_u32 vcc, -1, v150
    s_cbranch_vccz so_fix_ok_3
    buffer_load_dwordx4 v[100:103], v4, s[4:7], s31 offen sc1
    buffer_load_dwordx4 v[104:107], v148, s[4:7], s31 offen sc1
    s_mov_b32 s14, 1
so_fix_ok_3:
    v_max3_u32 v150, v108, v109, v110
    v_max3_u32 v150, v150, v111, v112
    v_max3_u32 v150, v150, v113, v114
    v_max_u32 v150, v150, v115
    v_cmp_eq_u32 vcc, -1, v150
    s_cbranch_vccz so_fix_ok_4
    buffer_load_dwordx4 v[108:111], v4, s[4:7], s32 offen sc1
    buffer_load_dwordx4 v[112:115], v148, s[4:7], s32 offen sc1
    s_mov_b32 s14, 1
so_fix_ok_4:
    v_max3_u32 v150, v116, v117, v118
    v_max3_u32 v150, v150, v119, v120
    v_max3_u32 v150, v150, v121, v122
    v_max_u32 v150, v150, v123
    v_cmp_eq_u32 vcc, -1, v150
    s_cbranch_vccz so_fix_ok_5
    buffer_load_dwordx4 v[116:119], v4, s[4:7], s33 offen sc1
    buffer_load_dwordx4 v[120:123], v148, s[4:7], s33 offen sc1
    s_mov_b32 s14, 1
so_fix_ok_5:
    v_max3_u32 v150, v124, v125, v126
    v_max3_u32 v150, v150, v127, v128
    v_max3_u32 v150, v150, v129, v130
    v_max_u32 v150, v150, v131
    v_cmp_eq_u32 vcc, -1, v150
    s_cbranch_vccz so_fix_ok_6
    buffer_load_dwordx4 v[124:127], v4, s[4:7], s34 offen sc1
    buffer_load_dwordx4 v[128:131], v148, s[4:7], s34 offen sc1
    s_mov_b32 s14, 1
so_fix_ok_6:
    v_max3_u32 v150, v132, v133, v134
    v_max3_u32 v150, v150, v135, v136
    v_max3_u32 v150, v150, v137, v138
    v_max_u32 v150, v150, v139
    v_cmp_eq_u32 vcc, -1, v150
    s_cbranch_vccz so_fix_ok_7
    buffer_load_dwordx4 v[132:135], v4, s[4:7], s35 offen sc1
    buffer_load_dwordx4 v[136:139], v148, s[4:7], s35 offen sc1
    s_mov_b32 s14, 1
so_fix_ok_7:
    v_max3_u32 v150, v140, v141, v142
    v_max3_u32 v150, v150, v143, v144
    v_max3_u32 v150, v150, v145, v146
    v_max_u32 v150, v150, v147
    v_cmp_eq_u32 vcc, -1, v150
    s_cbranch_vccz so_fix_ok_8
    buffer_load_dwordx4 v[140:143], v4, s[4:7], s8 offen sc1
    buffer_load_dwordx4 v[144:147], v148, s[4:7], s8 offen sc1
    s_mov_b32 s14, 1
so_fix_ok_8:
    s_cmp_eq_u32 s14, 0
    s_cbranch_scc1 so_fix_done
    s_add_u32 s63, s63, 1
    s_cmp_lt_u32 s63, 20000
    s_cbranch_scc1 so_fix_loop
    v_mov_b32 v150, 0x210
    s_mov_b32 s63, 16
    buffer_store_dword v150, off, s[24:27], s63
    s_waitcnt vmcnt(0)
so_fix_done:
    s_nop 4
    s_setpc_b64 s[12:13]
b_final:
    s_or_b32 s49, s2, s40
    s_cmp_lg_u32 s49, 0
    s_cbranch_scc1 b_final_rows
    s_mov_b32 s50, 35684352
    v_mov_b32 v7, s43
    s_mov_b64 exec, 1
    buffer_store_dword v7, off, s[4:7], s50 sc1
    s_mov_b64 exec, -1
b_final_rows:
    s_lshl_b32 s45, s38, 7
    s_and_b32 s49, s40, 1
    s_lshl_b32 s49, s49, 6
    s_add_u32 s45, s45, s49
    s_lshr_b32 s49, s40, 1
    s_add_u32 s45, s45, s49
    s_lshl_b32 s45, s45, 11
    s_lshl_b32 s49, s39, 7
    s_add_u32 s45, s45, s49
    s_add_u32 s46, s45, 65536
    buffer_store_dwordx4 v[204:207], v222, s[20:23], s45 offen offset:0 nt sc1
    buffer_store_dwordx4 v[208:211], v222, s[20:23], s45 offen offset:64 nt sc1
    buffer_store_dwordx4 v[212:215], v222, s[20:23], s46 offen offset:0 nt sc1
    buffer_store_dwordx4 v[216:219], v222, s[20:23], s46 offen offset:64 nt sc1
    s_endpgm
prod_w0:
    v_and_b32 v9, 63, v0
    v_lshrrev_b32 v10, 3, v9
    v_and_b32 v11, 7, v9
    v_lshrrev_b32 v12, 4, v9
    v_and_b32 v13, 15, v9
    v_lshlrev_b32 v1, 4, v9
    v_and_b32 v14, 1, v12
    v_or_b32 v14, 0, v14
    v_lshlrev_b32 v14, 1, v14
    v_xor_b32 v14, v14, v11
    v_lshlrev_b32 v14, 4, v14
    v_mul_u32_u24 v15, 6144, v10
    v_add_u32 v3, v14, v15
    v_and_b32 v14, 1, v12
    v_or_b32 v14, 2, v14
    v_lshlrev_b32 v14, 1, v14
    v_xor_b32 v14, v14, v11
    v_lshlrev_b32 v14, 4, v14
    v_mul_u32_u24 v15, 6144, v10
    v_add_u32 v4, v14, v15
    v_and_b32 v14, 1, v12
    v_or_b32 v14, 0, v14
    v_lshlrev_b32 v14, 1, v14
    v_xor_b32 v14, v14, v11
    v_lshlrev_b32 v14, 4, v14
    v_lshl_add_u32 v16, v10, 11, v14
    v_and_b32 v14, 1, v12
    v_or_b32 v14, 2, v14
    v_lshlrev_b32 v14, 1, v14
    v_xor_b32 v14, v14, v11
    v_lshlrev_b32 v14, 4, v14
    v_lshl_add_u32 v17, v10, 11, v14
    s_lshl_b32 s49, s39, 7
    v_add_u32 v16, s49, v16
    v_add_u32 v17, s49, v17
    s_mov_b32 s77, 14
    v_or_b32 v14, 0, v12
    v_xor_b32 v14, v14, v11
    v_lshlrev_b32 v14, 4, v14
    v_lshl_add_u32 v6, v10, 12, v14
    v_or_b32 v14, 4, v12
    v_xor_b32 v14, v14, v11
    v_lshlrev_b32 v14, 4, v14
    v_lshl_add_u32 v7, v10, 12, v14
    s_lshl_b32 s64, s37, 7
    s_mov_b32 s65, 393216
    s_mov_b32 s66, 49152
    s_and_b32 s67, s37, 7
    s_cmp_eq_u32 s67, 3
    s_cselect_b32 s67, 1, 0
    s_lshl_b32 s70, s36, 18
    s_sub_u32 s48, s36, 1
    s_max_i32 s48, s48, 0
    s_lshl_b32 s71, s48, 18
    s_mov_b32 s59, 55296
    s_mov_b32 s58, 0
    s_mul_i32 s51, s65, 4
    s_add_u32 m0, s59, 0
    s_add_u32 s51, s51, s64
    buffer_load_dwordx4 v3, s[8:11], s51 offen  lds
    s_add_u32 m0, s59, 1024
    s_add_u32 s51, s51, s66
    buffer_load_dwordx4 v4, s[8:11], s51 offen  lds
    s_add_u32 m0, s59, 2048
    s_add_u32 s51, s51, s66
    buffer_load_dwordx4 v3, s[8:11], s51 offen  lds
    s_add_u32 m0, s59, 3072
    s_add_u32 s51, s51, s66
    buffer_load_dwordx4 v4, s[8:11], s51 offen  lds
    s_add_u32 m0, s59, 4096
    s_add_u32 s51, s51, s66
    buffer_load_dwordx4 v3, s[8:11], s51 offen  lds
    s_add_u32 m0, s59, 5120
    s_add_u32 s51, s51, s66
    buffer_load_dwordx4 v4, s[8:11], s51 offen  lds
    s_add_u32 m0, s59, 6144
    s_add_u32 s51, s51, s66
    buffer_load_dwordx4 v3, s[8:11], s51 offen  lds
    s_add_u32 m0, s59, 7168
    s_add_u32 s51, s51, s66
    buffer_load_dwordx4 v4, s[8:11], s51 offen  lds
    s_add_u32 s59, s59, 24576
    s_cmp_eq_u32 s59, 153600
    s_cselect_b32 s59, 55296, s59
    s_add_u32 m0, s58, 0
    s_add_u32 s51, s70, 512
    buffer_load_dwordx4 v6, s[16:19], s51 offen lds
    s_add_u32 m0, s58, 1024
    s_add_u32 s51, s70, 33280
    buffer_load_dwordx4 v7, s[16:19], s51 offen lds
    s_add_u32 m0, s58, 2048
    s_add_u32 s51, s70, 66048
    buffer_load_dwordx4 v6, s[16:19], s51 offen lds
    s_add_u32 m0, s58, 3072
    s_add_u32 s51, s70, 98816
    buffer_load_dwordx4 v7, s[16:19], s51 offen lds
    s_add_u32 m0, s58, 4096
    s_add_u32 s51, s70, 131584
    buffer_load_dwordx4 v6, s[16:19], s51 offen lds
    s_add_u32 m0, s58, 5120
    s_add_u32 s51, s70, 164352
    buffer_load_dwordx4 v7, s[16:19], s51 offen lds
    s_add_u32 s58, s58, 18432
    s_cmp_eq_u32 s58, 55296
    s_cselect_b32 s58, 0, s58
    s_mul_i32 s51, s65, 5
    s_add_u32 m0, s59, 0
    s_add_u32 s51, s51, s64
    buffer_load_dwordx4 v3, s[8:11], s51 offen  lds
    s_add_u32 m0, s59, 1024
    s_add_u32 s51, s51, s66
    buffer_load_dwordx4 v4, s[8:11], s51 offen  lds
    s_add_u32 m0, s59, 2048
    s_add_u32 s51, s51, s66
    buffer_load_dwordx4 v3, s[8:11], s51 offen  lds
    s_add_u32 m0, s59, 3072
    s_add_u32 s51, s51, s66
    buffer_load_dwordx4 v4, s[8:11], s51 offen  lds
    s_add_u32 m0, s59, 4096
    s_add_u32 s51, s51, s66
    buffer_load_dwordx4 v3, s[8:11], s51 offen  lds
    s_add_u32 m0, s59, 5120
    s_add_u32 s51, s51, s66
    buffer_load_dwordx4 v4, s[8:11], s51 offen  lds
    s_add_u32 m0, s59, 6144
    s_add_u32 s51, s51, s66
    buffer_load_dwordx4 v3, s[8:11], s51 offen  lds
    s_add_u32 m0, s59, 7168
    s_add_u32 s51, s51, s66
    buffer_load_dwordx4 v4, s[8:11], s51 offen  lds
    s_add_u32 s59, s59, 24576
    s_cmp_eq_u32 s59, 153600
    s_cselect_b32 s59, 55296, s59
    s_add_u32 m0, s58, 0
    s_add_u32 s51, s70, 640
    buffer_load_dwordx4 v6, s[16:19], s51 offen lds
    s_add_u32 m0, s58, 1024
    s_add_u32 s51, s70, 33408
    buffer_load_dwordx4 v7, s[16:19], s51 offen lds
    s_add_u32 m0, s58, 2048
    s_add_u32 s51, s70, 66176
    buffer_load_dwordx4 v6, s[16:19], s51 offen lds
    s_add_u32 m0, s58, 3072
    s_add_u32 s51, s70, 98944
    buffer_load_dwordx4 v7, s[16:19], s51 offen lds
    s_add_u32 m0, s58, 4096
    s_add_u32 s51, s70, 131712
    buffer_load_dwordx4 v6, s[16:19], s51 offen lds
    s_add_u32 m0, s58, 5120
    s_add_u32 s51, s70, 164480
    buffer_load_dwordx4 v7, s[16:19], s51 offen lds
    s_add_u32 s58, s58, 18432
    s_cmp_eq_u32 s58, 55296
    s_cselect_b32 s58, 0, s58
    s_add_u32 m0, s58, 0
    s_add_u32 s51, s70, 768
    buffer_load_dwordx4 v6, s[16:19], s51 offen lds
    s_add_u32 m0, s58, 1024
    s_add_u32 s51, s70, 33536
    buffer_load_dwordx4 v7, s[16:19], s51 offen lds
    s_add_u32 m0, s58, 2048
    s_add_u32 s51, s70, 66304
    buffer_load_dwordx4 v6, s[16:19], s51 offen lds
    s_add_u32 m0, s58, 3072
    s_add_u32 s51, s70, 99072
    buffer_load_dwordx4 v7, s[16:19], s51 offen lds
    s_add_u32 m0, s58, 4096
    s_add_u32 s51, s70, 131840
    buffer_load_dwordx4 v6, s[16:19], s51 offen lds
    s_add_u32 m0, s58, 5120
    s_add_u32 s51, s70, 164608
    buffer_load_dwordx4 v7, s[16:19], s51 offen lds
    s_add_u32 s58, s58, 18432
    s_cmp_eq_u32 s58, 55296
    s_cselect_b32 s58, 0, s58
    s_mul_i32 s51, s65, 6
    s_add_u32 m0, s59, 0
    s_add_u32 s51, s51, s64
    buffer_load_dwordx4 v3, s[8:11], s51 offen  lds
    s_add_u32 m0, s59, 1024
    s_add_u32 s51, s51, s66
    buffer_load_dwordx4 v4, s[8:11], s51 offen  lds
    s_add_u32 m0, s59, 2048
    s_add_u32 s51, s51, s66
    buffer_load_dwordx4 v3, s[8:11], s51 offen  lds
    s_add_u32 m0, s59, 3072
    s_add_u32 s51, s51, s66
    buffer_load_dwordx4 v4, s[8:11], s51 offen  lds
    s_add_u32 m0, s59, 4096
    s_add_u32 s51, s51, s66
    buffer_load_dwordx4 v3, s[8:11], s51 offen  lds
    s_add_u32 m0, s59, 5120
    s_add_u32 s51, s51, s66
    buffer_load_dwordx4 v4, s[8:11], s51 offen  lds
    s_add_u32 m0, s59, 6144
    s_add_u32 s51, s51, s66
    buffer_load_dwordx4 v3, s[8:11], s51 offen  lds
    s_add_u32 m0, s59, 7168
    s_add_u32 s51, s51, s66
    buffer_load_dwordx4 v4, s[8:11], s51 offen  lds
    s_add_u32 s59, s59, 24576
    s_cmp_eq_u32 s59, 153600
    s_cselect_b32 s59, 55296, s59
    s_mul_i32 s51, s65, 7
    s_add_u32 m0, s59, 0
    s_add_u32 s51, s51, s64
    buffer_load_dwordx4 v3, s[8:11], s51 offen  lds
    s_add_u32 m0, s59, 1024
    s_add_u32 s51, s51, s66
    buffer_load_dwordx4 v4, s[8:11], s51 offen  lds
    s_add_u32 m0, s59, 2048
    s_add_u32 s51, s51, s66
    buffer_load_dwordx4 v3, s[8:11], s51 offen  lds
    s_add_u32 m0, s59, 3072
    s_add_u32 s51, s51, s66
    buffer_load_dwordx4 v4, s[8:11], s51 offen  lds
    s_add_u32 m0, s59, 4096
    s_add_u32 s51, s51, s66
    buffer_load_dwordx4 v3, s[8:11], s51 offen  lds
    s_add_u32 m0, s59, 5120
    s_add_u32 s51, s51, s66
    buffer_load_dwordx4 v4, s[8:11], s51 offen  lds
    s_add_u32 m0, s59, 6144
    s_add_u32 s51, s51, s66
    buffer_load_dwordx4 v3, s[8:11], s51 offen  lds
    s_add_u32 m0, s59, 7168
    s_add_u32 s51, s51, s66
    buffer_load_dwordx4 v4, s[8:11], s51 offen  lds
    s_add_u32 s59, s59, 24576
    s_cmp_eq_u32 s59, 153600
    s_cselect_b32 s59, 55296, s59
    s_mov_b32 s80, 0xfedc7654
    s_mov_b32 s81, 0xb3a29180
    s_mov_b32 s46, 0x3210eca8
    s_mov_b32 s47, 0x7654fdb9
    s_lshl_b32 s45, s37, 2
    s_lshr_b64 s[46:47], s[46:47], s45
    s_and_b32 s45, s46, 15
    s_lshl_b32 s45, s45, 2
    s_bfm_b64 s[46:47], s45, 0
    s_and_b64 s[46:47], s[46:47], s[80:81]
    s_lshl_b64 s[46:47], s[46:47], 4
    s_lshr_b64 s[48:49], s[80:81], s45
    s_lshr_b64 s[48:49], s[48:49], 4
    s_lshl_b64 s[48:49], s[48:49], 4
    s_lshl_b64 s[48:49], s[48:49], s45
    s_or_b64 s[80:81], s[46:47], s[48:49]
    s_or_b32 s80, s80, s37
    v_lshlrev_b32 v14, 8, v12
    v_or_b32 v15, 8, v13
    v_lshl_add_u32 v14, v15, 4, v14
    v_lshrrev_b32 v15, 3, v13
    v_lshlrev_b32 v15, 13, v15
    v_add_u32 v14, v14, v15
    v_add_u32 v2, 6144, v14
    v_lshlrev_b32 v14, 7, v12
    v_lshl_add_u32 v5, v13, 2, v14
    s_waitcnt lgkmcnt(0)
    s_add_u32 s43, s43, 256
    s_add_u32 s44, s43, 1
    s_waitcnt vmcnt(36)
    s_barrier
    s_bitcmp1_b32 s42, 0
    s_cselect_b32 s12, s34, s32
    s_cselect_b32 s13, s35, s33
    s_cmp_eq_u32 s67, 0
    s_cbranch_scc1 wo_notslow_13
    s_mov_b32 s12, s4
    s_mov_b32 s13, s5
    s_mov_b32 s14, s6
    s_and_b32 s75, s42, 1
    s_lshl_b32 s75, s75, 21
    s_lshl_b32 s49, s39, 17
    s_add_u32 s75, s75, s49
    s_add_u32 s75, s75, 54525952
    v_add_u32 v16, s75, v1
    v_mov_b32 v17, v16
    s_mov_b32 s77, 10
wo_notslow_13:
    s_waitcnt vmcnt(22)
    s_barrier
    s_add_u32 m0, s58, 0
    s_add_u32 s51, s70, 896
    buffer_load_dwordx4 v6, s[16:19], s51 offen lds
    s_add_u32 m0, s58, 1024
    s_add_u32 s51, s70, 33664
    buffer_load_dwordx4 v7, s[16:19], s51 offen lds
    s_add_u32 m0, s58, 2048
    s_add_u32 s51, s70, 66432
    buffer_load_dwordx4 v6, s[16:19], s51 offen lds
    s_add_u32 m0, s58, 3072
    s_add_u32 s51, s70, 99200
    buffer_load_dwordx4 v7, s[16:19], s51 offen lds
    s_add_u32 m0, s58, 4096
    s_add_u32 s51, s70, 131968
    buffer_load_dwordx4 v6, s[16:19], s51 offen lds
    s_add_u32 m0, s58, 5120
    s_add_u32 s51, s70, 164736
    buffer_load_dwordx4 v7, s[16:19], s51 offen lds
    s_add_u32 s58, s58, 18432
    s_cmp_eq_u32 s58, 55296
    s_cselect_b32 s58, 0, s58
    s_mul_i32 s51, s65, 12
    s_add_u32 m0, s59, 0
    s_add_u32 s51, s51, s64
    buffer_load_dwordx4 v3, s[8:11], s51 offen  lds
    s_add_u32 m0, s59, 1024
    s_add_u32 s51, s51, s66
    buffer_load_dwordx4 v4, s[8:11], s51 offen  lds
    s_add_u32 m0, s59, 2048
    s_add_u32 s51, s51, s66
    buffer_load_dwordx4 v3, s[8:11], s51 offen  lds
    s_add_u32 m0, s59, 3072
    s_add_u32 s51, s51, s66
    buffer_load_dwordx4 v4, s[8:11], s51 offen  lds
    s_add_u32 m0, s59, 4096
    s_add_u32 s51, s51, s66
    buffer_load_dwordx4 v3, s[8:11], s51 offen  lds
    s_add_u32 m0, s59, 5120
    s_add_u32 s51, s51, s66
    buffer_load_dwordx4 v4, s[8:11], s51 offen  lds
    s_add_u32 m0, s59, 6144
    s_add_u32 s51, s51, s66
    buffer_load_dwordx4 v3, s[8:11], s51 offen  lds
    s_add_u32 m0, s59, 7168
    s_add_u32 s51, s51, s66
    buffer_load_dwordx4 v4, s[8:11], s51 offen  lds
    s_add_u32 s59, s59, 24576
    s_cmp_eq_u32 s59, 153600
    s_cselect_b32 s59, 55296, s59
    s_waitcnt vmcnt(22)
    s_barrier
    s_add_u32 m0, s58, 0
    s_add_u32 s51, s70, 1536
    buffer_load_dwordx4 v6, s[16:19], s51 offen lds
    s_add_u32 m0, s58, 1024
    s_add_u32 s51, s70, 34304
    buffer_load_dwordx4 v7, s[16:19], s51 offen lds
    s_add_u32 m0, s58, 2048
    s_add_u32 s51, s70, 67072
    buffer_load_dwordx4 v6, s[16:19], s51 offen lds
    s_add_u32 m0, s58, 3072
    s_add_u32 s51, s70, 99840
    buffer_load_dwordx4 v7, s[16:19], s51 offen lds
    s_add_u32 m0, s58, 4096
    s_add_u32 s51, s70, 132608
    buffer_load_dwordx4 v6, s[16:19], s51 offen lds
    s_add_u32 m0, s58, 5120
    s_add_u32 s51, s70, 165376
    buffer_load_dwordx4 v7, s[16:19], s51 offen lds
    s_add_u32 s58, s58, 18432
    s_cmp_eq_u32 s58, 55296
    s_cselect_b32 s58, 0, s58
    s_mul_i32 s51, s65, 13
    s_add_u32 m0, s59, 0
    s_add_u32 s51, s51, s64
    buffer_load_dwordx4 v3, s[8:11], s51 offen  lds
    s_add_u32 m0, s59, 1024
    s_add_u32 s51, s51, s66
    buffer_load_dwordx4 v4, s[8:11], s51 offen  lds
    s_add_u32 m0, s59, 2048
    s_add_u32 s51, s51, s66
    buffer_load_dwordx4 v3, s[8:11], s51 offen  lds
    s_add_u32 m0, s59, 3072
    s_add_u32 s51, s51, s66
    buffer_load_dwordx4 v4, s[8:11], s51 offen  lds
    s_add_u32 m0, s59, 4096
    s_add_u32 s51, s51, s66
    buffer_load_dwordx4 v3, s[8:11], s51 offen  lds
    s_add_u32 m0, s59, 5120
    s_add_u32 s51, s51, s66
    buffer_load_dwordx4 v4, s[8:11], s51 offen  lds
    s_add_u32 m0, s59, 6144
    s_add_u32 s51, s51, s66
    buffer_load_dwordx4 v3, s[8:11], s51 offen  lds
    s_add_u32 m0, s59, 7168
    s_add_u32 s51, s51, s66
    buffer_load_dwordx4 v4, s[8:11], s51 offen  lds
    s_add_u32 s59, s59, 24576
    s_cmp_eq_u32 s59, 153600
    s_cselect_b32 s59, 55296, s59
    s_waitcnt vmcnt(22)
    s_barrier
    s_add_u32 m0, s58, 0
    s_add_u32 s51, s70, 1664
    buffer_load_dwordx4 v6, s[16:19], s51 offen lds
    s_add_u32 m0, s58, 1024
    s_add_u32 s51, s70, 34432
    buffer_load_dwordx4 v7, s[16:19], s51 offen lds
    s_add_u32 m0, s58, 2048
    s_add_u32 s51, s70, 67200
    buffer_load_dwordx4 v6, s[16:19], s51 offen lds
    s_add_u32 m0, s58, 3072
    s_add_u32 s51, s70, 99968
    buffer_load_dwordx4 v7, s[16:19], s51 offen lds
    s_add_u32 m0, s58, 4096
    s_add_u32 s51, s70, 132736
    buffer_load_dwordx4 v6, s[16:19], s51 offen lds
    s_add_u32 m0, s58, 5120
    s_add_u32 s51, s70, 165504
    buffer_load_dwordx4 v7, s[16:19], s51 offen lds
    s_add_u32 s58, s58, 18432
    s_cmp_eq_u32 s58, 55296
    s_cselect_b32 s58, 0, s58
    s_cmp_eq_u32 s67, 0
    s_cbranch_scc1 notslow_14
    s_mov_b32 s8, s4
    s_mov_b32 s9, s5
    s_mov_b32 s10, s6
    s_mov_b32 s65, 24576
    s_mov_b32 s66, 1024
    v_mov_b32 v3, v1
    v_mov_b32 v4, v1
    s_and_b32 s64, s42, 1
    s_mul_i32 s64, s64, 6291456
    s_mul_i32 s49, s37, 393216
    s_add_u32 s64, s64, s49
    s_add_u32 s64, s64, 41943040
notslow_14:
    s_mul_i32 s51, s65, 14
    s_add_u32 m0, s59, 0
    s_add_u32 s51, s51, s64
    buffer_load_dwordx4 v3, s[8:11], s51 offen  lds
    s_add_u32 m0, s59, 1024
    s_add_u32 s51, s51, s66
    buffer_load_dwordx4 v4, s[8:11], s51 offen  lds
    s_add_u32 m0, s59, 2048
    s_add_u32 s51, s51, s66
    buffer_load_dwordx4 v3, s[8:11], s51 offen  lds
    s_add_u32 m0, s59, 3072
    s_add_u32 s51, s51, s66
    buffer_load_dwordx4 v4, s[8:11], s51 offen  lds
    s_add_u32 m0, s59, 4096
    s_add_u32 s51, s51, s66
    buffer_load_dwordx4 v3, s[8:11], s51 offen  lds
    s_add_u32 m0, s59, 5120
    s_add_u32 s51, s51, s66
    buffer_load_dwordx4 v4, s[8:11], s51 offen  lds
    s_add_u32 m0, s59, 6144
    s_add_u32 s51, s51, s66
    buffer_load_dwordx4 v3, s[8:11], s51 offen  lds
    s_add_u32 m0, s59, 7168
    s_add_u32 s51, s51, s66
    buffer_load_dwordx4 v4, s[8:11], s51 offen  lds
    s_add_u32 s59, s59, 24576
    s_cmp_eq_u32 s59, 153600
    s_cselect_b32 s59, 55296, s59
    s_waitcnt vmcnt(22)
    s_barrier
    s_add_u32 m0, s58, 0
    s_add_u32 s51, s70, 1792
    buffer_load_dwordx4 v6, s[16:19], s51 offen lds
    s_add_u32 m0, s58, 1024
    s_add_u32 s51, s70, 34560
    buffer_load_dwordx4 v7, s[16:19], s51 offen lds
    s_add_u32 m0, s58, 2048
    s_add_u32 s51, s70, 67328
    buffer_load_dwordx4 v6, s[16:19], s51 offen lds
    s_add_u32 m0, s58, 3072
    s_add_u32 s51, s70, 100096
    buffer_load_dwordx4 v7, s[16:19], s51 offen lds
    s_add_u32 m0, s58, 4096
    s_add_u32 s51, s70, 132864
    buffer_load_dwordx4 v6, s[16:19], s51 offen lds
    s_add_u32 m0, s58, 5120
    s_add_u32 s51, s70, 165632
    buffer_load_dwordx4 v7, s[16:19], s51 offen lds
    s_add_u32 s58, s58, 18432
    s_cmp_eq_u32 s58, 55296
    s_cselect_b32 s58, 0, s58
    s_mul_i32 s51, s65, 15
    s_add_u32 m0, s59, 0
    s_add_u32 s51, s51, s64
    buffer_load_dwordx4 v3, s[8:11], s51 offen  lds
    s_add_u32 m0, s59, 1024
    s_add_u32 s51, s51, s66
    buffer_load_dwordx4 v4, s[8:11], s51 offen  lds
    s_add_u32 m0, s59, 2048
    s_add_u32 s51, s51, s66
    buffer_load_dwordx4 v3, s[8:11], s51 offen  lds
    s_add_u32 m0, s59, 3072
    s_add_u32 s51, s51, s66
    buffer_load_dwordx4 v4, s[8:11], s51 offen  lds
    s_add_u32 m0, s59, 4096
    s_add_u32 s51, s51, s66
    buffer_load_dwordx4 v3, s[8:11], s51 offen  lds
    s_add_u32 m0, s59, 5120
    s_add_u32 s51, s51, s66
    buffer_load_dwordx4 v4, s[8:11], s51 offen  lds
    s_add_u32 m0, s59, 6144
    s_add_u32 s51, s51, s66
    buffer_load_dwordx4 v3, s[8:11], s51 offen  lds
    s_add_u32 m0, s59, 7168
    s_add_u32 s51, s51, s66
    buffer_load_dwordx4 v4, s[8:11], s51 offen  lds
    s_add_u32 s59, s59, 24576
    s_cmp_eq_u32 s59, 153600
    s_cselect_b32 s59, 55296, s59
    s_waitcnt vmcnt(22)
    s_barrier
    s_add_u32 m0, s58, 0
    s_add_u32 s51, s70, 1920
    buffer_load_dwordx4 v6, s[16:19], s51 offen lds
    s_add_u32 m0, s58, 1024
    s_add_u32 s51, s70, 34688
    buffer_load_dwordx4 v7, s[16:19], s51 offen lds
    s_add_u32 m0, s58, 2048
    s_add_u32 s51, s70, 67456
    buffer_load_dwordx4 v6, s[16:19], s51 offen lds
    s_add_u32 m0, s58, 3072
    s_add_u32 s51, s70, 100224
    buffer_load_dwordx4 v7, s[16:19], s51 offen lds
    s_add_u32 m0, s58, 4096
    s_add_u32 s51, s70, 132992
    buffer_load_dwordx4 v6, s[16:19], s51 offen lds
    s_add_u32 m0, s58, 5120
    s_add_u32 s51, s70, 165760
    buffer_load_dwordx4 v7, s[16:19], s51 offen lds
    s_add_u32 s58, s58, 18432
    s_cmp_eq_u32 s58, 55296
    s_cselect_b32 s58, 0, s58
    s_mul_i32 s51, s65, 0
    s_add_u32 m0, s59, 0
    s_add_u32 s51, s51, s64
    buffer_load_dwordx4 v3, s[8:11], s51 offen  lds
    s_add_u32 m0, s59, 1024
    s_add_u32 s51, s51, s66
    buffer_load_dwordx4 v4, s[8:11], s51 offen  lds
    s_add_u32 m0, s59, 2048
    s_add_u32 s51, s51, s66
    buffer_load_dwordx4 v3, s[8:11], s51 offen  lds
    s_add_u32 m0, s59, 3072
    s_add_u32 s51, s51, s66
    buffer_load_dwordx4 v4, s[8:11], s51 offen  lds
    s_add_u32 m0, s59, 4096
    s_add_u32 s51, s51, s66
    buffer_load_dwordx4 v3, s[8:11], s51 offen  lds
    s_add_u32 m0, s59, 5120
    s_add_u32 s51, s51, s66
    buffer_load_dwordx4 v4, s[8:11], s51 offen  lds
    s_add_u32 m0, s59, 6144
    s_add_u32 s51, s51, s66
    buffer_load_dwordx4 v3, s[8:11], s51 offen  lds
    s_add_u32 m0, s59, 7168
    s_add_u32 s51, s51, s66
    buffer_load_dwordx4 v4, s[8:11], s51 offen  lds
    s_add_u32 s59, s59, 24576
    s_cmp_eq_u32 s59, 153600
    s_cselect_b32 s59, 55296, s59
    s_waitcnt vmcnt(22)
    s_barrier
    s_add_u32 m0, s58, 0
    s_add_u32 s51, s70, 0
    buffer_load_dwordx4 v6, s[16:19], s51 offen lds
    s_add_u32 m0, s58, 1024
    s_add_u32 s51, s70, 32768
    buffer_load_dwordx4 v7, s[16:19], s51 offen lds
    s_add_u32 m0, s58, 2048
    s_add_u32 s51, s70, 65536
    buffer_load_dwordx4 v6, s[16:19], s51 offen lds
    s_add_u32 m0, s58, 3072
    s_add_u32 s51, s70, 98304
    buffer_load_dwordx4 v7, s[16:19], s51 offen lds
    s_add_u32 m0, s58, 4096
    s_add_u32 s51, s70, 131072
    buffer_load_dwordx4 v6, s[16:19], s51 offen lds
    s_add_u32 m0, s58, 5120
    s_add_u32 s51, s70, 163840
    buffer_load_dwordx4 v7, s[16:19], s51 offen lds
    s_add_u32 s58, s58, 18432
    s_cmp_eq_u32 s58, 55296
    s_cselect_b32 s58, 0, s58
    s_mul_i32 s51, s65, 8
    s_add_u32 m0, s59, 0
    s_add_u32 s51, s51, s64
    buffer_load_dwordx4 v3, s[8:11], s51 offen  lds
    s_add_u32 m0, s59, 1024
    s_add_u32 s51, s51, s66
    buffer_load_dwordx4 v4, s[8:11], s51 offen  lds
    s_add_u32 m0, s59, 2048
    s_add_u32 s51, s51, s66
    buffer_load_dwordx4 v3, s[8:11], s51 offen  lds
    s_add_u32 m0, s59, 3072
    s_add_u32 s51, s51, s66
    buffer_load_dwordx4 v4, s[8:11], s51 offen  lds
    s_add_u32 m0, s59, 4096
    s_add_u32 s51, s51, s66
    buffer_load_dwordx4 v3, s[8:11], s51 offen  lds
    s_add_u32 m0, s59, 5120
    s_add_u32 s51, s51, s66
    buffer_load_dwordx4 v4, s[8:11], s51 offen  lds
    s_add_u32 m0, s59, 6144
    s_add_u32 s51, s51, s66
    buffer_load_dwordx4 v3, s[8:11], s51 offen  lds
    s_add_u32 m0, s59, 7168
    s_add_u32 s51, s51, s66
    buffer_load_dwordx4 v4, s[8:11], s51 offen  lds
    s_add_u32 s59, s59, 24576
    s_cmp_eq_u32 s59, 153600
    s_cselect_b32 s59, 55296, s59
    s_waitcnt vmcnt(22)
    s_barrier
    s_add_u32 m0, s58, 0
    s_add_u32 s51, s70, 1024
    buffer_load_dwordx4 v6, s[16:19], s51 offen lds
    s_add_u32 m0, s58, 1024
    s_add_u32 s51, s70, 33792
    buffer_load_dwordx4 v7, s[16:19], s51 offen lds
    s_add_u32 m0, s58, 2048
    s_add_u32 s51, s70, 66560
    buffer_load_dwordx4 v6, s[16:19], s51 offen lds
    s_add_u32 m0, s58, 3072
    s_add_u32 s51, s70, 99328
    buffer_load_dwordx4 v7, s[16:19], s51 offen lds
    s_add_u32 m0, s58, 4096
    s_add_u32 s51, s70, 132096
    buffer_load_dwordx4 v6, s[16:19], s51 offen lds
    s_add_u32 m0, s58, 5120
    s_add_u32 s51, s70, 164864
    buffer_load_dwordx4 v7, s[16:19], s51 offen lds
    s_add_u32 s58, s58, 18432
    s_cmp_eq_u32 s58, 55296
    s_cselect_b32 s58, 0, s58
    s_mul_i32 s51, s65, 1
    s_add_u32 m0, s59, 0
    s_add_u32 s51, s51, s64
    buffer_load_dwordx4 v3, s[8:11], s51 offen  lds
    s_add_u32 m0, s59, 1024
    s_add_u32 s51, s51, s66
    buffer_load_dwordx4 v4, s[8:11], s51 offen  lds
    s_add_u32 m0, s59, 2048
    s_add_u32 s51, s51, s66
    buffer_load_dwordx4 v3, s[8:11], s51 offen  lds
    s_add_u32 m0, s59, 3072
    s_add_u32 s51, s51, s66
    buffer_load_dwordx4 v4, s[8:11], s51 offen  lds
    s_add_u32 m0, s59, 4096
    s_add_u32 s51, s51, s66
    buffer_load_dwordx4 v3, s[8:11], s51 offen  lds
    s_add_u32 m0, s59, 5120
    s_add_u32 s51, s51, s66
    buffer_load_dwordx4 v4, s[8:11], s51 offen  lds
    s_add_u32 m0, s59, 6144
    s_add_u32 s51, s51, s66
    buffer_load_dwordx4 v3, s[8:11], s51 offen  lds
    s_add_u32 m0, s59, 7168
    s_add_u32 s51, s51, s66
    buffer_load_dwordx4 v4, s[8:11], s51 offen  lds
    s_add_u32 s59, s59, 24576
    s_cmp_eq_u32 s59, 153600
    s_cselect_b32 s59, 55296, s59
    s_waitcnt vmcnt(22)
    s_barrier
    s_add_u32 m0, s58, 0
    s_add_u32 s51, s70, 128
    buffer_load_dwordx4 v6, s[16:19], s51 offen lds
    s_add_u32 m0, s58, 1024
    s_add_u32 s51, s70, 32896
    buffer_load_dwordx4 v7, s[16:19], s51 offen lds
    s_add_u32 m0, s58, 2048
    s_add_u32 s51, s70, 65664
    buffer_load_dwordx4 v6, s[16:19], s51 offen lds
    s_add_u32 m0, s58, 3072
    s_add_u32 s51, s70, 98432
    buffer_load_dwordx4 v7, s[16:19], s51 offen lds
    s_add_u32 m0, s58, 4096
    s_add_u32 s51, s70, 131200
    buffer_load_dwordx4 v6, s[16:19], s51 offen lds
    s_add_u32 m0, s58, 5120
    s_add_u32 s51, s70, 163968
    buffer_load_dwordx4 v7, s[16:19], s51 offen lds
    s_add_u32 s58, s58, 18432
    s_cmp_eq_u32 s58, 55296
    s_cselect_b32 s58, 0, s58
    s_mul_i32 s51, s65, 9
    s_add_u32 m0, s59, 0
    s_add_u32 s51, s51, s64
    buffer_load_dwordx4 v3, s[8:11], s51 offen  lds
    s_add_u32 m0, s59, 1024
    s_add_u32 s51, s51, s66
    buffer_load_dwordx4 v4, s[8:11], s51 offen  lds
    s_add_u32 m0, s59, 2048
    s_add_u32 s51, s51, s66
    buffer_load_dwordx4 v3, s[8:11], s51 offen  lds
    s_add_u32 m0, s59, 3072
    s_add_u32 s51, s51, s66
    buffer_load_dwordx4 v4, s[8:11], s51 offen  lds
    s_add_u32 m0, s59, 4096
    s_add_u32 s51, s51, s66
    buffer_load_dwordx4 v3, s[8:11], s51 offen  lds
    s_add_u32 m0, s59, 5120
    s_add_u32 s51, s51, s66
    buffer_load_dwordx4 v4, s[8:11], s51 offen  lds
    s_add_u32 m0, s59, 6144
    s_add_u32 s51, s51, s66
    buffer_load_dwordx4 v3, s[8:11], s51 offen  lds
    s_add_u32 m0, s59, 7168
    s_add_u32 s51, s51, s66
    buffer_load_dwordx4 v4, s[8:11], s51 offen  lds
    s_add_u32 s59, s59, 24576
    s_cmp_eq_u32 s59, 153600
    s_cselect_b32 s59, 55296, s59
    s_waitcnt vmcnt(22)
    s_barrier
    s_add_u32 m0, s58, 0
    s_add_u32 s51, s70, 1152
    buffer_load_dwordx4 v6, s[16:19], s51 offen lds
    s_add_u32 m0, s58, 1024
    s_add_u32 s51, s70, 33920
    buffer_load_dwordx4 v7, s[16:19], s51 offen lds
    s_add_u32 m0, s58, 2048
    s_add_u32 s51, s70, 66688
    buffer_load_dwordx4 v6, s[16:19], s51 offen lds
    s_add_u32 m0, s58, 3072
    s_add_u32 s51, s70, 99456
    buffer_load_dwordx4 v7, s[16:19], s51 offen lds
    s_add_u32 m0, s58, 4096
    s_add_u32 s51, s70, 132224
    buffer_load_dwordx4 v6, s[16:19], s51 offen lds
    s_add_u32 m0, s58, 5120
    s_add_u32 s51, s70, 164992
    buffer_load_dwordx4 v7, s[16:19], s51 offen lds
    s_add_u32 s58, s58, 18432
    s_cmp_eq_u32 s58, 55296
    s_cselect_b32 s58, 0, s58
    s_mul_i32 s51, s65, 2
    s_add_u32 m0, s59, 0
    s_add_u32 s51, s51, s64
    buffer_load_dwordx4 v3, s[8:11], s51 offen  lds
    s_add_u32 m0, s59, 1024
    s_add_u32 s51, s51, s66
    buffer_load_dwordx4 v4, s[8:11], s51 offen  lds
    s_add_u32 m0, s59, 2048
    s_add_u32 s51, s51, s66
    buffer_load_dwordx4 v3, s[8:11], s51 offen  lds
    s_add_u32 m0, s59, 3072
    s_add_u32 s51, s51, s66
    buffer_load_dwordx4 v4, s[8:11], s51 offen  lds
    s_add_u32 m0, s59, 4096
    s_add_u32 s51, s51, s66
    buffer_load_dwordx4 v3, s[8:11], s51 offen  lds
    s_add_u32 m0, s59, 5120
    s_add_u32 s51, s51, s66
    buffer_load_dwordx4 v4, s[8:11], s51 offen  lds
    s_add_u32 m0, s59, 6144
    s_add_u32 s51, s51, s66
    buffer_load_dwordx4 v3, s[8:11], s51 offen  lds
    s_add_u32 m0, s59, 7168
    s_add_u32 s51, s51, s66
    buffer_load_dwordx4 v4, s[8:11], s51 offen  lds
    s_add_u32 s59, s59, 24576
    s_cmp_eq_u32 s59, 153600
    s_cselect_b32 s59, 55296, s59
    s_waitcnt vmcnt(22)
    s_barrier
    s_add_u32 m0, s58, 0
    s_add_u32 s51, s70, 256
    buffer_load_dwordx4 v6, s[16:19], s51 offen lds
    s_add_u32 m0, s58, 1024
    s_add_u32 s51, s70, 33024
    buffer_load_dwordx4 v7, s[16:19], s51 offen lds
    s_add_u32 m0, s58, 2048
    s_add_u32 s51, s70, 65792
    buffer_load_dwordx4 v6, s[16:19], s51 offen lds
    s_add_u32 m0, s58, 3072
    s_add_u32 s51, s70, 98560
    buffer_load_dwordx4 v7, s[16:19], s51 offen lds
    s_add_u32 m0, s58, 4096
    s_add_u32 s51, s70, 131328
    buffer_load_dwordx4 v6, s[16:19], s51 offen lds
    s_add_u32 m0, s58, 5120
    s_add_u32 s51, s70, 164096
    buffer_load_dwordx4 v7, s[16:19], s51 offen lds
    s_add_u32 s58, s58, 18432
    s_cmp_eq_u32 s58, 55296
    s_cselect_b32 s58, 0, s58
    s_mul_i32 s51, s65, 10
    s_add_u32 m0, s59, 0
    s_add_u32 s51, s51, s64
    buffer_load_dwordx4 v3, s[8:11], s51 offen  lds
    s_add_u32 m0, s59, 1024
    s_add_u32 s51, s51, s66
    buffer_load_dwordx4 v4, s[8:11], s51 offen  lds
    s_add_u32 m0, s59, 2048
    s_add_u32 s51, s51, s66
    buffer_load_dwordx4 v3, s[8:11], s51 offen  lds
    s_add_u32 m0, s59, 3072
    s_add_u32 s51, s51, s66
    buffer_load_dwordx4 v4, s[8:11], s51 offen  lds
    s_add_u32 m0, s59, 4096
    s_add_u32 s51, s51, s66
    buffer_load_dwordx4 v3, s[8:11], s51 offen  lds
    s_add_u32 m0, s59, 5120
    s_add_u32 s51, s51, s66
    buffer_load_dwordx4 v4, s[8:11], s51 offen  lds
    s_add_u32 m0, s59, 6144
    s_add_u32 s51, s51, s66
    buffer_load_dwordx4 v3, s[8:11], s51 offen  lds
    s_add_u32 m0, s59, 7168
    s_add_u32 s51, s51, s66
    buffer_load_dwordx4 v4, s[8:11], s51 offen  lds
    s_add_u32 s59, s59, 24576
    s_cmp_eq_u32 s59, 153600
    s_cselect_b32 s59, 55296, s59
    s_waitcnt vmcnt(22)
    s_barrier
    s_add_u32 m0, s58, 0
    s_add_u32 s51, s70, 1280
    buffer_load_dwordx4 v6, s[16:19], s51 offen lds
    s_add_u32 m0, s58, 1024
    s_add_u32 s51, s70, 34048
    buffer_load_dwordx4 v7, s[16:19], s51 offen lds
    s_add_u32 m0, s58, 2048
    s_add_u32 s51, s70, 66816
    buffer_load_dwordx4 v6, s[16:19], s51 offen lds
    s_add_u32 m0, s58, 3072
    s_add_u32 s51, s70, 99584
    buffer_load_dwordx4 v7, s[16:19], s51 offen lds
    s_add_u32 m0, s58, 4096
    s_add_u32 s51, s70, 132352
    buffer_load_dwordx4 v6, s[16:19], s51 offen lds
    s_add_u32 m0, s58, 5120
    s_add_u32 s51, s70, 165120
    buffer_load_dwordx4 v7, s[16:19], s51 offen lds
    s_add_u32 s58, s58, 18432
    s_cmp_eq_u32 s58, 55296
    s_cselect_b32 s58, 0, s58
    s_mul_i32 s51, s65, 3
    s_add_u32 m0, s59, 0
    s_add_u32 s51, s51, s64
    buffer_load_dwordx4 v3, s[8:11], s51 offen  lds
    s_add_u32 m0, s59, 1024
    s_add_u32 s51, s51, s66
    buffer_load_dwordx4 v4, s[8:11], s51 offen  lds
    s_add_u32 m0, s59, 2048
    s_add_u32 s51, s51, s66
    buffer_load_dwordx4 v3, s[8:11], s51 offen  lds
    s_add_u32 m0, s59, 3072
    s_add_u32 s51, s51, s66
    buffer_load_dwordx4 v4, s[8:11], s51 offen  lds
    s_add_u32 m0, s59, 4096
    s_add_u32 s51, s51, s66
    buffer_load_dwordx4 v3, s[8:11], s51 offen  lds
    s_add_u32 m0, s59, 5120
    s_add_u32 s51, s51, s66
    buffer_load_dwordx4 v4, s[8:11], s51 offen  lds
    s_add_u32 m0, s59, 6144
    s_add_u32 s51, s51, s66
    buffer_load_dwordx4 v3, s[8:11], s51 offen  lds
    s_add_u32 m0, s59, 7168
    s_add_u32 s51, s51, s66
    buffer_load_dwordx4 v4, s[8:11], s51 offen  lds
    s_add_u32 s59, s59, 24576
    s_cmp_eq_u32 s59, 153600
    s_cselect_b32 s59, 55296, s59
    s_waitcnt vmcnt(22)
    s_barrier
    s_add_u32 m0, s58, 0
    s_add_u32 s51, s70, 384
    buffer_load_dwordx4 v6, s[16:19], s51 offen lds
    s_add_u32 m0, s58, 1024
    s_add_u32 s51, s70, 33152
    buffer_load_dwordx4 v7, s[16:19], s51 offen lds
    s_add_u32 m0, s58, 2048
    s_add_u32 s51, s70, 65920
    buffer_load_dwordx4 v6, s[16:19], s51 offen lds
    s_add_u32 m0, s58, 3072
    s_add_u32 s51, s70, 98688
    buffer_load_dwordx4 v7, s[16:19], s51 offen lds
    s_add_u32 m0, s58, 4096
    s_add_u32 s51, s70, 131456
    buffer_load_dwordx4 v6, s[16:19], s51 offen lds
    s_add_u32 m0, s58, 5120
    s_add_u32 s51, s70, 164224
    buffer_load_dwordx4 v7, s[16:19], s51 offen lds
    s_add_u32 s58, s58, 18432
    s_cmp_eq_u32 s58, 55296
    s_cselect_b32 s58, 0, s58
    s_mul_i32 s51, s65, 11
    s_add_u32 m0, s59, 0
    s_add_u32 s51, s51, s64
    buffer_load_dwordx4 v3, s[8:11], s51 offen  lds
    s_add_u32 m0, s59, 1024
    s_add_u32 s51, s51, s66
    buffer_load_dwordx4 v4, s[8:11], s51 offen  lds
    s_add_u32 m0, s59, 2048
    s_add_u32 s51, s51, s66
    buffer_load_dwordx4 v3, s[8:11], s51 offen  lds
    s_add_u32 m0, s59, 3072
    s_add_u32 s51, s51, s66
    buffer_load_dwordx4 v4, s[8:11], s51 offen  lds
    s_add_u32 m0, s59, 4096
    s_add_u32 s51, s51, s66
    buffer_load_dwordx4 v3, s[8:11], s51 offen  lds
    s_add_u32 m0, s59, 5120
    s_add_u32 s51, s51, s66
    buffer_load_dwordx4 v4, s[8:11], s51 offen  lds
    s_add_u32 m0, s59, 6144
    s_add_u32 s51, s51, s66
    buffer_load_dwordx4 v3, s[8:11], s51 offen  lds
    s_add_u32 m0, s59, 7168
    s_add_u32 s51, s51, s66
    buffer_load_dwordx4 v4, s[8:11], s51 offen  lds
    s_add_u32 s59, s59, 24576
    s_cmp_eq_u32 s59, 153600
    s_cselect_b32 s59, 55296, s59
    s_waitcnt vmcnt(22)
    s_barrier
    s_add_u32 m0, s58, 0
    s_add_u32 s51, s70, 1408
    buffer_load_dwordx4 v6, s[16:19], s51 offen lds
    s_add_u32 m0, s58, 1024
    s_add_u32 s51, s70, 34176
    buffer_load_dwordx4 v7, s[16:19], s51 offen lds
    s_add_u32 m0, s58, 2048
    s_add_u32 s51, s70, 66944
    buffer_load_dwordx4 v6, s[16:19], s51 offen lds
    s_add_u32 m0, s58, 3072
    s_add_u32 s51, s70, 99712
    buffer_load_dwordx4 v7, s[16:19], s51 offen lds
    s_add_u32 m0, s58, 4096
    s_add_u32 s51, s70, 132480
    buffer_load_dwordx4 v6, s[16:19], s51 offen lds
    s_add_u32 m0, s58, 5120
    s_add_u32 s51, s70, 165248
    buffer_load_dwordx4 v7, s[16:19], s51 offen lds
    s_add_u32 s58, s58, 18432
    s_cmp_eq_u32 s58, 55296
    s_cselect_b32 s58, 0, s58
    s_mov_b32 m0, 55296
    s_lshl_b32 s51, 54, s77
    buffer_load_dwordx4 v16, s[12:15], s51 offen  lds
    s_mov_b32 m0, 56320
    s_lshl_b32 s51, 55, s77
    buffer_load_dwordx4 v17, s[12:15], s51 offen  lds
    s_mov_b32 m0, 57344
    s_lshl_b32 s51, 56, s77
    buffer_load_dwordx4 v16, s[12:15], s51 offen  lds
    s_mov_b32 m0, 58368
    s_lshl_b32 s51, 57, s77
    buffer_load_dwordx4 v17, s[12:15], s51 offen  lds
    s_mov_b32 m0, 59392
    s_lshl_b32 s51, 58, s77
    buffer_load_dwordx4 v16, s[12:15], s51 offen  lds
    s_mov_b32 m0, 60416
    s_lshl_b32 s51, 59, s77
    buffer_load_dwordx4 v17, s[12:15], s51 offen  lds
    s_mov_b32 m0, 61440
    s_lshl_b32 s51, 60, s77
    buffer_load_dwordx4 v16, s[12:15], s51 offen  lds
    s_mov_b32 m0, 62464
    s_lshl_b32 s51, 61, s77
    buffer_load_dwordx4 v17, s[12:15], s51 offen  lds
    s_waitcnt vmcnt(22)
    s_barrier
    s_mov_b32 m0, 18432
    s_lshl_b32 s51, 18, s77
    buffer_load_dwordx4 v16, s[12:15], s51 offen  lds
    s_mov_b32 m0, 19456
    s_lshl_b32 s51, 19, s77
    buffer_load_dwordx4 v17, s[12:15], s51 offen  lds
    s_mov_b32 m0, 20480
    s_lshl_b32 s51, 20, s77
    buffer_load_dwordx4 v16, s[12:15], s51 offen  lds
    s_mov_b32 m0, 21504
    s_lshl_b32 s51, 21, s77
    buffer_load_dwordx4 v17, s[12:15], s51 offen  lds
    s_mov_b32 m0, 22528
    s_lshl_b32 s51, 22, s77
    buffer_load_dwordx4 v16, s[12:15], s51 offen  lds
    s_mov_b32 m0, 23552
    s_lshl_b32 s51, 23, s77
    buffer_load_dwordx4 v17, s[12:15], s51 offen  lds
    s_mov_b32 m0, 24576
    s_lshl_b32 s51, 24, s77
    buffer_load_dwordx4 v16, s[12:15], s51 offen  lds
    s_mov_b32 m0, 25600
    s_lshl_b32 s51, 25, s77
    buffer_load_dwordx4 v17, s[12:15], s51 offen  lds
    s_mov_b32 m0, 26624
    s_lshl_b32 s51, 26, s77
    buffer_load_dwordx4 v16, s[12:15], s51 offen  lds
    s_mov_b32 m0, 27648
    s_lshl_b32 s51, 27, s77
    buffer_load_dwordx4 v17, s[12:15], s51 offen  lds
    s_mov_b32 m0, 28672
    s_lshl_b32 s51, 28, s77
    buffer_load_dwordx4 v16, s[12:15], s51 offen  lds
    s_mov_b32 m0, 29696
    s_lshl_b32 s51, 29, s77
    buffer_load_dwordx4 v17, s[12:15], s51 offen  lds
    s_mov_b32 m0, 30720
    s_lshl_b32 s51, 30, s77
    buffer_load_dwordx4 v16, s[12:15], s51 offen  lds
    s_mov_b32 m0, 31744
    s_lshl_b32 s51, 31, s77
    buffer_load_dwordx4 v17, s[12:15], s51 offen  lds
    s_waitcnt vmcnt(22)
    s_barrier
    s_mov_b32 m0, 36864
    s_lshl_b32 s51, 36, s77
    buffer_load_dwordx4 v16, s[12:15], s51 offen  lds
    s_mov_b32 m0, 37888
    s_lshl_b32 s51, 37, s77
    buffer_load_dwordx4 v17, s[12:15], s51 offen  lds
    s_mov_b32 m0, 38912
    s_lshl_b32 s51, 38, s77
    buffer_load_dwordx4 v16, s[12:15], s51 offen  lds
    s_mov_b32 m0, 39936
    s_lshl_b32 s51, 39, s77
    buffer_load_dwordx4 v17, s[12:15], s51 offen  lds
    s_mov_b32 m0, 40960
    s_lshl_b32 s51, 40, s77
    buffer_load_dwordx4 v16, s[12:15], s51 offen  lds
    s_mov_b32 m0, 41984
    s_lshl_b32 s51, 41, s77
    buffer_load_dwordx4 v17, s[12:15], s51 offen  lds
    s_mov_b32 m0, 43008
    s_lshl_b32 s51, 42, s77
    buffer_load_dwordx4 v16, s[12:15], s51 offen  lds
    s_mov_b32 m0, 44032
    s_lshl_b32 s51, 43, s77
    buffer_load_dwordx4 v17, s[12:15], s51 offen  lds
    s_mov_b32 m0, 45056
    s_lshl_b32 s51, 44, s77
    buffer_load_dwordx4 v16, s[12:15], s51 offen  lds
    s_mov_b32 m0, 46080
    s_lshl_b32 s51, 45, s77
    buffer_load_dwordx4 v17, s[12:15], s51 offen  lds
    s_mov_b32 m0, 47104
    s_lshl_b32 s51, 46, s77
    buffer_load_dwordx4 v16, s[12:15], s51 offen  lds
    s_mov_b32 m0, 48128
    s_lshl_b32 s51, 47, s77
    buffer_load_dwordx4 v17, s[12:15], s51 offen  lds
    s_mov_b32 m0, 49152
    s_lshl_b32 s51, 48, s77
    buffer_load_dwordx4 v16, s[12:15], s51 offen  lds
    s_mov_b32 m0, 50176
    s_lshl_b32 s51, 49, s77
    buffer_load_dwordx4 v17, s[12:15], s51 offen  lds
    s_barrier
    s_mov_b32 m0, 0
    s_lshl_b32 s51, 0, s77
    buffer_load_dwordx4 v16, s[12:15], s51 offen  lds
    s_mov_b32 m0, 1024
    s_lshl_b32 s51, 1, s77
    buffer_load_dwordx4 v17, s[12:15], s51 offen  lds
    s_mov_b32 m0, 2048
    s_lshl_b32 s51, 2, s77
    buffer_load_dwordx4 v16, s[12:15], s51 offen  lds
    s_mov_b32 m0, 3072
    s_lshl_b32 s51, 3, s77
    buffer_load_dwordx4 v17, s[12:15], s51 offen  lds
    s_mov_b32 m0, 4096
    s_lshl_b32 s51, 4, s77
    buffer_load_dwordx4 v16, s[12:15], s51 offen  lds
    s_mov_b32 m0, 5120
    s_lshl_b32 s51, 5, s77
    buffer_load_dwordx4 v17, s[12:15], s51 offen  lds
    s_branch prod_tail_w0
prod_layer_w0:
    s_lshl_b32 s45, s42, 22
    s_lshl_b32 s49, s36, 18
    s_add_u32 s70, s45, s49
    s_sub_u32 s48, s36, 1
    s_max_i32 s48, s48, 0
    s_lshl_b32 s49, s48, 18
    s_add_u32 s71, s45, s49
    s_mov_b32 s58, 0
    s_barrier
    s_mov_b32 s58, 18432
    s_bfe_u32 s79, s80, 0x40004
    s_lshl_b32 s79, s79, 14
    s_add_u32 s79, s79, s70
    s_add_u32 m0, s58, 0
    s_add_u32 s51, s79, 0
    buffer_load_dwordx4 v1, s[4:7], s51 offen offset:0 sc1 lds
    buffer_load_dwordx4 v1, s[4:7], s51 offen offset:1024 sc1 lds
    buffer_load_dwordx4 v1, s[4:7], s51 offen offset:2048 sc1 lds
    buffer_load_dwordx4 v1, s[4:7], s51 offen offset:3072 sc1 lds
    s_add_u32 m0, s58, 4096
    s_add_u32 s51, s79, 4096
    buffer_load_dwordx4 v1, s[4:7], s51 offen offset:0 sc1 lds
    buffer_load_dwordx4 v1, s[4:7], s51 offen offset:1024 sc1 lds
    s_add_u32 s58, s58, 18432
    s_cmp_eq_u32 s58, 55296
    s_cselect_b32 s58, 0, s58
    s_bfe_u32 s79, s80, 0x40008
    s_lshl_b32 s79, s79, 14
    s_add_u32 s79, s79, s70
    s_add_u32 m0, s58, 0
    s_add_u32 s51, s79, 0
    buffer_load_dwordx4 v1, s[4:7], s51 offen offset:0 sc1 lds
    buffer_load_dwordx4 v1, s[4:7], s51 offen offset:1024 sc1 lds
    buffer_load_dwordx4 v1, s[4:7], s51 offen offset:2048 sc1 lds
    buffer_load_dwordx4 v1, s[4:7], s51 offen offset:3072 sc1 lds
    s_add_u32 m0, s58, 4096
    s_add_u32 s51, s79, 4096
    buffer_load_dwordx4 v1, s[4:7], s51 offen offset:0 sc1 lds
    buffer_load_dwordx4 v1, s[4:7], s51 offen offset:1024 sc1 lds
    s_add_u32 s58, s58, 18432
    s_cmp_eq_u32 s58, 55296
    s_cselect_b32 s58, 0, s58
    s_waitcnt vmcnt(36)
    s_barrier
    s_bitcmp1_b32 s42, 0
    s_cselect_b32 s12, s34, s32
    s_cselect_b32 s13, s35, s33
    s_cmp_eq_u32 s67, 0
    s_cbranch_scc1 wo_notslow_15
    s_mov_b32 s12, s4
    s_mov_b32 s13, s5
    s_mov_b32 s14, s6
    s_and_b32 s75, s42, 1
    s_lshl_b32 s75, s75, 21
    s_lshl_b32 s49, s39, 17
    s_add_u32 s75, s75, s49
    s_add_u32 s75, s75, 54525952
    v_add_u32 v16, s75, v1
    v_mov_b32 v17, v16
    s_mov_b32 s77, 10
wo_notslow_15:
    s_waitcnt vmcnt(6)
    s_mov_b32 s63, 0
tchk_16:
    ds_read_b128 v[32:35], v1 offset:18432
    ds_read_b128 v[36:39], v1 offset:19456
    ds_read_b128 v[40:43], v1 offset:20480
    ds_read_b128 v[44:47], v1 offset:21504
    ds_read_b128 v[48:51], v1 offset:22528
    ds_read_b128 v[52:55], v1 offset:23552
    s_waitcnt lgkmcnt(0)
    v_max3_u32 v30, v32, v33, v34
    v_max3_u32 v31, v44, v45, v46
    v_max3_u32 v30, v30, v35, v36
    v_max3_u32 v31, v31, v47, v48
    v_max3_u32 v30, v30, v37, v38
    v_max3_u32 v31, v31, v49, v50
    v_max3_u32 v30, v30, v39, v40
    v_max3_u32 v31, v31, v51, v52
    v_max3_u32 v30, v30, v41, v42
    v_max3_u32 v31, v31, v53, v54
    v_max_u32 v30, v30, v43
    v_max_u32 v31, v31, v55
    v_max_u32 v30, v30, v31
    v_cmp_eq_u32 vcc, -1, v30
    s_cbranch_vccz tchk_ok_17
    s_bfe_u32 s79, s80, 0x40004
    s_lshl_b32 s79, s79, 14
    s_add_u32 s79, s79, s70
    s_mov_b32 m0, 18432
    s_add_u32 s51, s79, 0
    buffer_load_dwordx4 v1, s[4:7], s51 offen offset:0 sc1 lds
    buffer_load_dwordx4 v1, s[4:7], s51 offen offset:1024 sc1 lds
    buffer_load_dwordx4 v1, s[4:7], s51 offen offset:2048 sc1 lds
    buffer_load_dwordx4 v1, s[4:7], s51 offen offset:3072 sc1 lds
    s_mov_b32 m0, 22528
    s_add_u32 s51, s79, 4096
    buffer_load_dwordx4 v1, s[4:7], s51 offen offset:0 sc1 lds
    buffer_load_dwordx4 v1, s[4:7], s51 offen offset:1024 sc1 lds
    s_waitcnt vmcnt(0)
    s_add_u32 s63, s63, 1
    s_cmp_lt_u32 s63, 20000
    s_cbranch_scc1 tchk_16
    v_mov_b32 v30, 0x110
    s_mov_b32 s63, 16
    buffer_store_dword v30, off, s[24:27], s63
    s_waitcnt vmcnt(0)
tchk_ok_17:
    s_barrier
    s_bfe_u32 s79, s80, 0x4000c
    s_lshl_b32 s79, s79, 14
    s_add_u32 s79, s79, s70
    s_add_u32 m0, s58, 0
    s_add_u32 s51, s79, 0
    buffer_load_dwordx4 v1, s[4:7], s51 offen offset:0 sc1 lds
    buffer_load_dwordx4 v1, s[4:7], s51 offen offset:1024 sc1 lds
    buffer_load_dwordx4 v1, s[4:7], s51 offen offset:2048 sc1 lds
    buffer_load_dwordx4 v1, s[4:7], s51 offen offset:3072 sc1 lds
    s_add_u32 m0, s58, 4096
    s_add_u32 s51, s79, 4096
    buffer_load_dwordx4 v1, s[4:7], s51 offen offset:0 sc1 lds
    buffer_load_dwordx4 v1, s[4:7], s51 offen offset:1024 sc1 lds
    s_add_u32 s58, s58, 18432
    s_cmp_eq_u32 s58, 55296
    s_cselect_b32 s58, 0, s58
    s_waitcnt vmcnt(6)
    s_mov_b32 s63, 0
    ds_read_b128 v[32:35], v1 offset:36864
    ds_read_b128 v[36:39], v1 offset:37888
    ds_read_b128 v[40:43], v1 offset:38912
    ds_read_b128 v[44:47], v1 offset:39936
    ds_read_b128 v[48:51], v1 offset:40960
    ds_read_b128 v[52:55], v1 offset:41984
    s_bfe_u32 s51, s80, 0x40010
    s_mul_i32 s51, s51, s65
    s_add_u32 m0, s59, 0
    s_add_u32 s51, s51, s64
    buffer_load_dwordx4 v3, s[8:11], s51 offen  lds
    s_add_u32 m0, s59, 1024
    s_add_u32 s51, s51, s66
    buffer_load_dwordx4 v4, s[8:11], s51 offen  lds
    s_add_u32 m0, s59, 2048
    s_add_u32 s51, s51, s66
    buffer_load_dwordx4 v3, s[8:11], s51 offen  lds
    s_add_u32 m0, s59, 3072
    s_add_u32 s51, s51, s66
    buffer_load_dwordx4 v4, s[8:11], s51 offen  lds
    s_add_u32 m0, s59, 4096
    s_add_u32 s51, s51, s66
    buffer_load_dwordx4 v3, s[8:11], s51 offen  lds
    s_add_u32 m0, s59, 5120
    s_add_u32 s51, s51, s66
    buffer_load_dwordx4 v4, s[8:11], s51 offen  lds
    s_add_u32 m0, s59, 6144
    s_add_u32 s51, s51, s66
    buffer_load_dwordx4 v3, s[8:11], s51 offen  lds
    s_add_u32 m0, s59, 7168
    s_add_u32 s51, s51, s66
    buffer_load_dwordx4 v4, s[8:11], s51 offen  lds
    s_add_u32 s59, s59, 24576
    s_cmp_eq_u32 s59, 153600
    s_cselect_b32 s59, 55296, s59
tchk_18:
    s_waitcnt lgkmcnt(0)
    v_max3_u32 v30, v32, v33, v34
    v_max3_u32 v31, v44, v45, v46
    v_max3_u32 v30, v30, v35, v36
    v_max3_u32 v31, v31, v47, v48
    v_max3_u32 v30, v30, v37, v38
    v_max3_u32 v31, v31, v49, v50
    v_max3_u32 v30, v30, v39, v40
    v_max3_u32 v31, v31, v51, v52
    v_max3_u32 v30, v30, v41, v42
    v_max3_u32 v31, v31, v53, v54
    v_max_u32 v30, v30, v43
    v_max_u32 v31, v31, v55
    v_max_u32 v30, v30, v31
    v_cmp_eq_u32 vcc, -1, v30
    s_cbranch_vccz tchk_ok_19
    s_bfe_u32 s79, s80, 0x40008
    s_lshl_b32 s79, s79, 14
    s_add_u32 s79, s79, s70
    s_mov_b32 m0, 36864
    s_add_u32 s51, s79, 0
    buffer_load_dwordx4 v1, s[4:7], s51 offen offset:0 sc1 lds
    buffer_load_dwordx4 v1, s[4:7], s51 offen offset:1024 sc1 lds
    buffer_load_dwordx4 v1, s[4:7], s51 offen offset:2048 sc1 lds
    buffer_load_dwordx4 v1, s[4:7], s51 offen offset:3072 sc1 lds
    s_mov_b32 m0, 40960
    s_add_u32 s51, s79, 4096
    buffer_load_dwordx4 v1, s[4:7], s51 offen offset:0 sc1 lds
    buffer_load_dwordx4 v1, s[4:7], s51 offen offset:1024 sc1 lds
    s_waitcnt vmcnt(0)
    ds_read_b128 v[32:35], v1 offset:36864
    ds_read_b128 v[36:39], v1 offset:37888
    ds_read_b128 v[40:43], v1 offset:38912
    ds_read_b128 v[44:47], v1 offset:39936
    ds_read_b128 v[48:51], v1 offset:40960
    ds_read_b128 v[52:55], v1 offset:41984
    s_add_u32 s63, s63, 1
    s_cmp_lt_u32 s63, 20000
    s_cbranch_scc1 tchk_18
    v_mov_b32 v30, 0x110
    s_mov_b32 s63, 16
    buffer_store_dword v30, off, s[24:27], s63
    s_waitcnt vmcnt(0)
tchk_ok_19:
    s_barrier
    s_bfe_u32 s79, s80, 0x40010
    s_lshl_b32 s79, s79, 14
    s_add_u32 s79, s79, s70
    s_add_u32 m0, s58, 0
    s_add_u32 s51, s79, 0
    buffer_load_dwordx4 v1, s[4:7], s51 offen offset:0 sc1 lds
    buffer_load_dwordx4 v1, s[4:7], s51 offen offset:1024 sc1 lds
    buffer_load_dwordx4 v1, s[4:7], s51 offen offset:2048 sc1 lds
    buffer_load_dwordx4 v1, s[4:7], s51 offen offset:3072 sc1 lds
    s_add_u32 m0, s58, 4096
    s_add_u32 s51, s79, 4096
    buffer_load_dwordx4 v1, s[4:7], s51 offen offset:0 sc1 lds
    buffer_load_dwordx4 v1, s[4:7], s51 offen offset:1024 sc1 lds
    s_add_u32 s58, s58, 18432
    s_cmp_eq_u32 s58, 55296
    s_cselect_b32 s58, 0, s58
    s_waitcnt vmcnt(14)
    s_mov_b32 s63, 0
    ds_read_b128 v[32:35], v1 offset:0
    ds_read_b128 v[36:39], v1 offset:1024
    ds_read_b128 v[40:43], v1 offset:2048
    ds_read_b128 v[44:47], v1 offset:3072
    ds_read_b128 v[48:51], v1 offset:4096
    ds_read_b128 v[52:55], v1 offset:5120
    s_bfe_u32 s51, s80, 0x40014
    s_mul_i32 s51, s51, s65
    s_add_u32 m0, s59, 0
    s_add_u32 s51, s51, s64
    buffer_load_dwordx4 v3, s[8:11], s51 offen  lds
    s_add_u32 m0, s59, 1024
    s_add_u32 s51, s51, s66
    buffer_load_dwordx4 v4, s[8:11], s51 offen  lds
    s_add_u32 m0, s59, 2048
    s_add_u32 s51, s51, s66
    buffer_load_dwordx4 v3, s[8:11], s51 offen  lds
    s_add_u32 m0, s59, 3072
    s_add_u32 s51, s51, s66
    buffer_load_dwordx4 v4, s[8:11], s51 offen  lds
    s_add_u32 m0, s59, 4096
    s_add_u32 s51, s51, s66
    buffer_load_dwordx4 v3, s[8:11], s51 offen  lds
    s_add_u32 m0, s59, 5120
    s_add_u32 s51, s51, s66
    buffer_load_dwordx4 v4, s[8:11], s51 offen  lds
    s_add_u32 m0, s59, 6144
    s_add_u32 s51, s51, s66
    buffer_load_dwordx4 v3, s[8:11], s51 offen  lds
    s_add_u32 m0, s59, 7168
    s_add_u32 s51, s51, s66
    buffer_load_dwordx4 v4, s[8:11], s51 offen  lds
    s_add_u32 s59, s59, 24576
    s_cmp_eq_u32 s59, 153600
    s_cselect_b32 s59, 55296, s59
tchk_20:
    s_waitcnt lgkmcnt(0)
    v_max3_u32 v30, v32, v33, v34
    v_max3_u32 v31, v44, v45, v46
    v_max3_u32 v30, v30, v35, v36
    v_max3_u32 v31, v31, v47, v48
    v_max3_u32 v30, v30, v37, v38
    v_max3_u32 v31, v31, v49, v50
    v_max3_u32 v30, v30, v39, v40
    v_max3_u32 v31, v31, v51, v52
    v_max3_u32 v30, v30, v41, v42
    v_max3_u32 v31, v31, v53, v54
    v_max_u32 v30, v30, v43
    v_max_u32 v31, v31, v55
    v_max_u32 v30, v30, v31
    v_cmp_eq_u32 vcc, -1, v30
    s_cbranch_vccz tchk_ok_21
    s_bfe_u32 s79, s80, 0x4000c
    s_lshl_b32 s79, s79, 14
    s_add_u32 s79, s79, s70
    s_mov_b32 m0, 0
    s_add_u32 s51, s79, 0
    buffer_load_dwordx4 v1, s[4:7], s51 offen offset:0 sc1 lds
    buffer_load_dwordx4 v1, s[4:7], s51 offen offset:1024 sc1 lds
    buffer_load_dwordx4 v1, s[4:7], s51 offen offset:2048 sc1 lds
    buffer_load_dwordx4 v1, s[4:7], s51 offen offset:3072 sc1 lds
    s_mov_b32 m0, 4096
    s_add_u32 s51, s79, 4096
    buffer_load_dwordx4 v1, s[4:7], s51 offen offset:0 sc1 lds
    buffer_load_dwordx4 v1, s[4:7], s51 offen offset:1024 sc1 lds
    s_waitcnt vmcnt(0)
    ds_read_b128 v[32:35], v1 offset:0
    ds_read_b128 v[36:39], v1 offset:1024
    ds_read_b128 v[40:43], v1 offset:2048
    ds_read_b128 v[44:47], v1 offset:3072
    ds_read_b128 v[48:51], v1 offset:4096
    ds_read_b128 v[52:55], v1 offset:5120
    s_add_u32 s63, s63, 1
    s_cmp_lt_u32 s63, 20000
    s_cbranch_scc1 tchk_20
    v_mov_b32 v30, 0x110
    s_mov_b32 s63, 16
    buffer_store_dword v30, off, s[24:27], s63
    s_waitcnt vmcnt(0)
tchk_ok_21:
    s_barrier
    s_bfe_u32 s79, s80, 0x40014
    s_lshl_b32 s79, s79, 14
    s_add_u32 s79, s79, s70
    s_add_u32 m0, s58, 0
    s_add_u32 s51, s79, 0
    buffer_load_dwordx4 v1, s[4:7], s51 offen offset:0 sc1 lds
    buffer_load_dwordx4 v1, s[4:7], s51 offen offset:1024 sc1 lds
    buffer_load_dwordx4 v1, s[4:7], s51 offen offset:2048 sc1 lds
    buffer_load_dwordx4 v1, s[4:7], s51 offen offset:3072 sc1 lds
    s_add_u32 m0, s58, 4096
    s_add_u32 s51, s79, 4096
    buffer_load_dwordx4 v1, s[4:7], s51 offen offset:0 sc1 lds
    buffer_load_dwordx4 v1, s[4:7], s51 offen offset:1024 sc1 lds
    s_add_u32 s58, s58, 18432
    s_cmp_eq_u32 s58, 55296
    s_cselect_b32 s58, 0, s58
    s_bfe_u32 s51, s80, 0x40018
    s_mul_i32 s51, s51, s65
    s_add_u32 m0, s59, 0
    s_add_u32 s51, s51, s64
    buffer_load_dwordx4 v3, s[8:11], s51 offen  lds
    s_add_u32 m0, s59, 1024
    s_add_u32 s51, s51, s66
    buffer_load_dwordx4 v4, s[8:11], s51 offen  lds
    s_add_u32 m0, s59, 2048
    s_add_u32 s51, s51, s66
    buffer_load_dwordx4 v3, s[8:11], s51 offen  lds
    s_add_u32 m0, s59, 3072
    s_add_u32 s51, s51, s66
    buffer_load_dwordx4 v4, s[8:11], s51 offen  lds
    s_add_u32 m0, s59, 4096
    s_add_u32 s51, s51, s66
    buffer_load_dwordx4 v3, s[8:11], s51 offen  lds
    s_add_u32 m0, s59, 5120
    s_add_u32 s51, s51, s66
    buffer_load_dwordx4 v4, s[8:11], s51 offen  lds
    s_add_u32 m0, s59, 6144
    s_add_u32 s51, s51, s66
    buffer_load_dwordx4 v3, s[8:11], s51 offen  lds
    s_add_u32 m0, s59, 7168
    s_add_u32 s51, s51, s66
    buffer_load_dwordx4 v4, s[8:11], s51 offen  lds
    s_add_u32 s59, s59, 24576
    s_cmp_eq_u32 s59, 153600
    s_cselect_b32 s59, 55296, s59
    s_waitcnt vmcnt(22)
    s_barrier
    s_bfe_u32 s79, s80, 0x40018
    s_lshl_b32 s79, s79, 14
    s_add_u32 s79, s79, s70
    s_add_u32 m0, s58, 0
    s_add_u32 s51, s79, 0
    buffer_load_dwordx4 v1, s[4:7], s51 offen offset:0 sc1 lds
    buffer_load_dwordx4 v1, s[4:7], s51 offen offset:1024 sc1 lds
    buffer_load_dwordx4 v1, s[4:7], s51 offen offset:2048 sc1 lds
    buffer_load_dwordx4 v1, s[4:7], s51 offen offset:3072 sc1 lds
    s_add_u32 m0, s58, 4096
    s_add_u32 s51, s79, 4096
    buffer_load_dwordx4 v1, s[4:7], s51 offen offset:0 sc1 lds
    buffer_load_dwordx4 v1, s[4:7], s51 offen offset:1024 sc1 lds
    s_add_u32 s58, s58, 18432
    s_cmp_eq_u32 s58, 55296
    s_cselect_b32 s58, 0, s58
    s_bfe_u32 s51, s80, 0x4001c
    s_mul_i32 s51, s51, s65
    s_add_u32 m0, s59, 0
    s_add_u32 s51, s51, s64
    buffer_load_dwordx4 v3, s[8:11], s51 offen  lds
    s_add_u32 m0, s59, 1024
    s_add_u32 s51, s51, s66
    buffer_load_dwordx4 v4, s[8:11], s51 offen  lds
    s_add_u32 m0, s59, 2048
    s_add_u32 s51, s51, s66
    buffer_load_dwordx4 v3, s[8:11], s51 offen  lds
    s_add_u32 m0, s59, 3072
    s_add_u32 s51, s51, s66
    buffer_load_dwordx4 v4, s[8:11], s51 offen  lds
    s_add_u32 m0, s59, 4096
    s_add_u32 s51, s51, s66
    buffer_load_dwordx4 v3, s[8:11], s51 offen  lds
    s_add_u32 m0, s59, 5120
    s_add_u32 s51, s51, s66
    buffer_load_dwordx4 v4, s[8:11], s51 offen  lds
    s_add_u32 m0, s59, 6144
    s_add_u32 s51, s51, s66
    buffer_load_dwordx4 v3, s[8:11], s51 offen  lds
    s_add_u32 m0, s59, 7168
    s_add_u32 s51, s51, s66
    buffer_load_dwordx4 v4, s[8:11], s51 offen  lds
    s_add_u32 s59, s59, 24576
    s_cmp_eq_u32 s59, 153600
    s_cselect_b32 s59, 55296, s59
    s_waitcnt vmcnt(22)
    s_barrier
    s_bfe_u32 s79, s80, 0x4001c
    s_lshl_b32 s79, s79, 14
    s_add_u32 s79, s79, s70
    s_add_u32 m0, s58, 0
    s_add_u32 s51, s79, 0
    buffer_load_dwordx4 v1, s[4:7], s51 offen offset:0 sc1 lds
    buffer_load_dwordx4 v1, s[4:7], s51 offen offset:1024 sc1 lds
    buffer_load_dwordx4 v1, s[4:7], s51 offen offset:2048 sc1 lds
    buffer_load_dwordx4 v1, s[4:7], s51 offen offset:3072 sc1 lds
    s_add_u32 m0, s58, 4096
    s_add_u32 s51, s79, 4096
    buffer_load_dwordx4 v1, s[4:7], s51 offen offset:0 sc1 lds
    buffer_load_dwordx4 v1, s[4:7], s51 offen offset:1024 sc1 lds
    s_add_u32 s58, s58, 18432
    s_cmp_eq_u32 s58, 55296
    s_cselect_b32 s58, 0, s58
    s_bfe_u32 s51, s81, 0x40000
    s_mul_i32 s51, s51, s65
    s_add_u32 m0, s59, 0
    s_add_u32 s51, s51, s64
    buffer_load_dwordx4 v3, s[8:11], s51 offen  lds
    s_add_u32 m0, s59, 1024
    s_add_u32 s51, s51, s66
    buffer_load_dwordx4 v4, s[8:11], s51 offen  lds
    s_add_u32 m0, s59, 2048
    s_add_u32 s51, s51, s66
    buffer_load_dwordx4 v3, s[8:11], s51 offen  lds
    s_add_u32 m0, s59, 3072
    s_add_u32 s51, s51, s66
    buffer_load_dwordx4 v4, s[8:11], s51 offen  lds
    s_add_u32 m0, s59, 4096
    s_add_u32 s51, s51, s66
    buffer_load_dwordx4 v3, s[8:11], s51 offen  lds
    s_add_u32 m0, s59, 5120
    s_add_u32 s51, s51, s66
    buffer_load_dwordx4 v4, s[8:11], s51 offen  lds
    s_add_u32 m0, s59, 6144
    s_add_u32 s51, s51, s66
    buffer_load_dwordx4 v3, s[8:11], s51 offen  lds
    s_add_u32 m0, s59, 7168
    s_add_u32 s51, s51, s66
    buffer_load_dwordx4 v4, s[8:11], s51 offen  lds
    s_add_u32 s59, s59, 24576
    s_cmp_eq_u32 s59, 153600
    s_cselect_b32 s59, 55296, s59
    s_waitcnt vmcnt(22)
    s_barrier
    s_bfe_u32 s79, s81, 0x40000
    s_lshl_b32 s79, s79, 14
    s_add_u32 s79, s79, s70
    s_add_u32 m0, s58, 0
    s_add_u32 s51, s79, 0
    buffer_load_dwordx4 v1, s[4:7], s51 offen offset:0 sc1 lds
    buffer_load_dwordx4 v1, s[4:7], s51 offen offset:1024 sc1 lds
    buffer_load_dwordx4 v1, s[4:7], s51 offen offset:2048 sc1 lds
    buffer_load_dwordx4 v1, s[4:7], s51 offen offset:3072 sc1 lds
    s_add_u32 m0, s58, 4096
    s_add_u32 s51, s79, 4096
    buffer_load_dwordx4 v1, s[4:7], s51 offen offset:0 sc1 lds
    buffer_load_dwordx4 v1, s[4:7], s51 offen offset:1024 sc1 lds
    s_add_u32 s58, s58, 18432
    s_cmp_eq_u32 s58, 55296
    s_cselect_b32 s58, 0, s58
    s_bfe_u32 s51, s81, 0x40004
    s_mul_i32 s51, s51, s65
    s_add_u32 m0, s59, 0
    s_add_u32 s51, s51, s64
    buffer_load_dwordx4 v3, s[8:11], s51 offen  lds
    s_add_u32 m0, s59, 1024
    s_add_u32 s51, s51, s66
    buffer_load_dwordx4 v4, s[8:11], s51 offen  lds
    s_add_u32 m0, s59, 2048
    s_add_u32 s51, s51, s66
    buffer_load_dwordx4 v3, s[8:11], s51 offen  lds
    s_add_u32 m0, s59, 3072
    s_add_u32 s51, s51, s66
    buffer_load_dwordx4 v4, s[8:11], s51 offen  lds
    s_add_u32 m0, s59, 4096
    s_add_u32 s51, s51, s66
    buffer_load_dwordx4 v3, s[8:11], s51 offen  lds
    s_add_u32 m0, s59, 5120
    s_add_u32 s51, s51, s66
    buffer_load_dwordx4 v4, s[8:11], s51 offen  lds
    s_add_u32 m0, s59, 6144
    s_add_u32 s51, s51, s66
    buffer_load_dwordx4 v3, s[8:11], s51 offen  lds
    s_add_u32 m0, s59, 7168
    s_add_u32 s51, s51, s66
    buffer_load_dwordx4 v4, s[8:11], s51 offen  lds
    s_add_u32 s59, s59, 24576
    s_cmp_eq_u32 s59, 153600
    s_cselect_b32 s59, 55296, s59
    s_waitcnt vmcnt(22)
    s_barrier
    s_bfe_u32 s79, s81, 0x40004
    s_lshl_b32 s79, s79, 14
    s_add_u32 s79, s79, s70
    s_add_u32 m0, s58, 0
    s_add_u32 s51, s79, 0
    buffer_load_dwordx4 v1, s[4:7], s51 offen offset:0 sc1 lds
    buffer_load_dwordx4 v1, s[4:7], s51 offen offset:1024 sc1 lds
    buffer_load_dwordx4 v1, s[4:7], s51 offen offset:2048 sc1 lds
    buffer_load_dwordx4 v1, s[4:7], s51 offen offset:3072 sc1 lds
    s_add_u32 m0, s58, 4096
    s_add_u32 s51, s79, 4096
    buffer_load_dwordx4 v1, s[4:7], s51 offen offset:0 sc1 lds
    buffer_load_dwordx4 v1, s[4:7], s51 offen offset:1024 sc1 lds
    s_add_u32 s58, s58, 18432
    s_cmp_eq_u32 s58, 55296
    s_cselect_b32 s58, 0, s58
    s_bfe_u32 s51, s81, 0x40008
    s_mul_i32 s51, s51, s65
    s_add_u32 m0, s59, 0
    s_add_u32 s51, s51, s64
    buffer_load_dwordx4 v3, s[8:11], s51 offen  lds
    s_add_u32 m0, s59, 1024
    s_add_u32 s51, s51, s66
    buffer_load_dwordx4 v4, s[8:11], s51 offen  lds
    s_add_u32 m0, s59, 2048
    s_add_u32 s51, s51, s66
    buffer_load_dwordx4 v3, s[8:11], s51 offen  lds
    s_add_u32 m0, s59, 3072
    s_add_u32 s51, s51, s66
    buffer_load_dwordx4 v4, s[8:11], s51 offen  lds
    s_add_u32 m0, s59, 4096
    s_add_u32 s51, s51, s66
    buffer_load_dwordx4 v3, s[8:11], s51 offen  lds
    s_add_u32 m0, s59, 5120
    s_add_u32 s51, s51, s66
    buffer_load_dwordx4 v4, s[8:11], s51 offen  lds
    s_add_u32 m0, s59, 6144
    s_add_u32 s51, s51, s66
    buffer_load_dwordx4 v3, s[8:11], s51 offen  lds
    s_add_u32 m0, s59, 7168
    s_add_u32 s51, s51, s66
    buffer_load_dwordx4 v4, s[8:11], s51 offen  lds
    s_add_u32 s59, s59, 24576
    s_cmp_eq_u32 s59, 153600
    s_cselect_b32 s59, 55296, s59
    s_waitcnt vmcnt(22)
    s_barrier
    s_bfe_u32 s79, s81, 0x40008
    s_lshl_b32 s79, s79, 14
    s_add_u32 s79, s79, s70
    s_add_u32 m0, s58, 0
    s_add_u32 s51, s79, 0
    buffer_load_dwordx4 v1, s[4:7], s51 offen offset:0 sc1 lds
    buffer_load_dwordx4 v1, s[4:7], s51 offen offset:1024 sc1 lds
    buffer_load_dwordx4 v1, s[4:7], s51 offen offset:2048 sc1 lds
    buffer_load_dwordx4 v1, s[4:7], s51 offen offset:3072 sc1 lds
    s_add_u32 m0, s58, 4096
    s_add_u32 s51, s79, 4096
    buffer_load_dwordx4 v1, s[4:7], s51 offen offset:0 sc1 lds
    buffer_load_dwordx4 v1, s[4:7], s51 offen offset:1024 sc1 lds
    s_add_u32 s58, s58, 18432
    s_cmp_eq_u32 s58, 55296
    s_cselect_b32 s58, 0, s58
    s_bfe_u32 s51, s81, 0x4000c
    s_mul_i32 s51, s51, s65
    s_add_u32 m0, s59, 0
    s_add_u32 s51, s51, s64
    buffer_load_dwordx4 v3, s[8:11], s51 offen  lds
    s_add_u32 m0, s59, 1024
    s_add_u32 s51, s51, s66
    buffer_load_dwordx4 v4, s[8:11], s51 offen  lds
    s_add_u32 m0, s59, 2048
    s_add_u32 s51, s51, s66
    buffer_load_dwordx4 v3, s[8:11], s51 offen  lds
    s_add_u32 m0, s59, 3072
    s_add_u32 s51, s51, s66
    buffer_load_dwordx4 v4, s[8:11], s51 offen  lds
    s_add_u32 m0, s59, 4096
    s_add_u32 s51, s51, s66
    buffer_load_dwordx4 v3, s[8:11], s51 offen  lds
    s_add_u32 m0, s59, 5120
    s_add_u32 s51, s51, s66
    buffer_load_dwordx4 v4, s[8:11], s51 offen  lds
    s_add_u32 m0, s59, 6144
    s_add_u32 s51, s51, s66
    buffer_load_dwordx4 v3, s[8:11], s51 offen  lds
    s_add_u32 m0, s59, 7168
    s_add_u32 s51, s51, s66
    buffer_load_dwordx4 v4, s[8:11], s51 offen  lds
    s_add_u32 s59, s59, 24576
    s_cmp_eq_u32 s59, 153600
    s_cselect_b32 s59, 55296, s59
    s_waitcnt vmcnt(22)
    s_barrier
    s_bfe_u32 s79, s81, 0x4000c
    s_lshl_b32 s79, s79, 14
    s_add_u32 s79, s79, s70
    s_add_u32 m0, s58, 0
    s_add_u32 s51, s79, 0
    buffer_load_dwordx4 v1, s[4:7], s51 offen offset:0 sc1 lds
    buffer_load_dwordx4 v1, s[4:7], s51 offen offset:1024 sc1 lds
    buffer_load_dwordx4 v1, s[4:7], s51 offen offset:2048 sc1 lds
    buffer_load_dwordx4 v1, s[4:7], s51 offen offset:3072 sc1 lds
    s_add_u32 m0, s58, 4096
    s_add_u32 s51, s79, 4096
    buffer_load_dwordx4 v1, s[4:7], s51 offen offset:0 sc1 lds
    buffer_load_dwordx4 v1, s[4:7], s51 offen offset:1024 sc1 lds
    s_add_u32 s58, s58, 18432
    s_cmp_eq_u32 s58, 55296
    s_cselect_b32 s58, 0, s58
    s_bfe_u32 s51, s81, 0x40010
    s_mul_i32 s51, s51, s65
    s_add_u32 m0, s59, 0
    s_add_u32 s51, s51, s64
    buffer_load_dwordx4 v3, s[8:11], s51 offen  lds
    s_add_u32 m0, s59, 1024
    s_add_u32 s51, s51, s66
    buffer_load_dwordx4 v4, s[8:11], s51 offen  lds
    s_add_u32 m0, s59, 2048
    s_add_u32 s51, s51, s66
    buffer_load_dwordx4 v3, s[8:11], s51 offen  lds
    s_add_u32 m0, s59, 3072
    s_add_u32 s51, s51, s66
    buffer_load_dwordx4 v4, s[8:11], s51 offen  lds
    s_add_u32 m0, s59, 4096
    s_add_u32 s51, s51, s66
    buffer_load_dwordx4 v3, s[8:11], s51 offen  lds
    s_add_u32 m0, s59, 5120
    s_add_u32 s51, s51, s66
    buffer_load_dwordx4 v4, s[8:11], s51 offen  lds
    s_add_u32 m0, s59, 6144
    s_add_u32 s51, s51, s66
    buffer_load_dwordx4 v3, s[8:11], s51 offen  lds
    s_add_u32 m0, s59, 7168
    s_add_u32 s51, s51, s66
    buffer_load_dwordx4 v4, s[8:11], s51 offen  lds
    s_add_u32 s59, s59, 24576
    s_cmp_eq_u32 s59, 153600
    s_cselect_b32 s59, 55296, s59
    s_waitcnt vmcnt(22)
    s_barrier
    s_bfe_u32 s79, s81, 0x40010
    s_lshl_b32 s79, s79, 14
    s_add_u32 s79, s79, s70
    s_add_u32 m0, s58, 0
    s_add_u32 s51, s79, 0
    buffer_load_dwordx4 v1, s[4:7], s51 offen offset:0 sc1 lds
    buffer_load_dwordx4 v1, s[4:7], s51 offen offset:1024 sc1 lds
    buffer_load_dwordx4 v1, s[4:7], s51 offen offset:2048 sc1 lds
    buffer_load_dwordx4 v1, s[4:7], s51 offen offset:3072 sc1 lds
    s_add_u32 m0, s58, 4096
    s_add_u32 s51, s79, 4096
    buffer_load_dwordx4 v1, s[4:7], s51 offen offset:0 sc1 lds
    buffer_load_dwordx4 v1, s[4:7], s51 offen offset:1024 sc1 lds
    s_add_u32 s58, s58, 18432
    s_cmp_eq_u32 s58, 55296
    s_cselect_b32 s58, 0, s58
    s_bfe_u32 s51, s81, 0x40014
    s_mul_i32 s51, s51, s65
    s_add_u32 m0, s59, 0
    s_add_u32 s51, s51, s64
    buffer_load_dwordx4 v3, s[8:11], s51 offen  lds
    s_add_u32 m0, s59, 1024
    s_add_u32 s51, s51, s66
    buffer_load_dwordx4 v4, s[8:11], s51 offen  lds
    s_add_u32 m0, s59, 2048
    s_add_u32 s51, s51, s66
    buffer_load_dwordx4 v3, s[8:11], s51 offen  lds
    s_add_u32 m0, s59, 3072
    s_add_u32 s51, s51, s66
    buffer_load_dwordx4 v4, s[8:11], s51 offen  lds
    s_add_u32 m0, s59, 4096
    s_add_u32 s51, s51, s66
    buffer_load_dwordx4 v3, s[8:11], s51 offen  lds
    s_add_u32 m0, s59, 5120
    s_add_u32 s51, s51, s66
    buffer_load_dwordx4 v4, s[8:11], s51 offen  lds
    s_add_u32 m0, s59, 6144
    s_add_u32 s51, s51, s66
    buffer_load_dwordx4 v3, s[8:11], s51 offen  lds
    s_add_u32 m0, s59, 7168
    s_add_u32 s51, s51, s66
    buffer_load_dwordx4 v4, s[8:11], s51 offen  lds
    s_add_u32 s59, s59, 24576
    s_cmp_eq_u32 s59, 153600
    s_cselect_b32 s59, 55296, s59
    s_waitcnt vmcnt(22)
    s_barrier
    s_bfe_u32 s79, s81, 0x40014
    s_lshl_b32 s79, s79, 14
    s_add_u32 s79, s79, s70
    s_add_u32 m0, s58, 0
    s_add_u32 s51, s79, 0
    buffer_load_dwordx4 v1, s[4:7], s51 offen offset:0 sc1 lds
    buffer_load_dwordx4 v1, s[4:7], s51 offen offset:1024 sc1 lds
    buffer_load_dwordx4 v1, s[4:7], s51 offen offset:2048 sc1 lds
    buffer_load_dwordx4 v1, s[4:7], s51 offen offset:3072 sc1 lds
    s_add_u32 m0, s58, 4096
    s_add_u32 s51, s79, 4096
    buffer_load_dwordx4 v1, s[4:7], s51 offen offset:0 sc1 lds
    buffer_load_dwordx4 v1, s[4:7], s51 offen offset:1024 sc1 lds
    s_add_u32 s58, s58, 18432
    s_cmp_eq_u32 s58, 55296
    s_cselect_b32 s58, 0, s58
    s_bfe_u32 s51, s81, 0x40018
    s_mul_i32 s51, s51, s65
    s_add_u32 m0, s59, 0
    s_add_u32 s51, s51, s64
    buffer_load_dwordx4 v3, s[8:11], s51 offen  lds
    s_add_u32 m0, s59, 1024
    s_add_u32 s51, s51, s66
    buffer_load_dwordx4 v4, s[8:11], s51 offen  lds
    s_add_u32 m0, s59, 2048
    s_add_u32 s51, s51, s66
    buffer_load_dwordx4 v3, s[8:11], s51 offen  lds
    s_add_u32 m0, s59, 3072
    s_add_u32 s51, s51, s66
    buffer_load_dwordx4 v4, s[8:11], s51 offen  lds
    s_add_u32 m0, s59, 4096
    s_add_u32 s51, s51, s66
    buffer_load_dwordx4 v3, s[8:11], s51 offen  lds
    s_add_u32 m0, s59, 5120
    s_add_u32 s51, s51, s66
    buffer_load_dwordx4 v4, s[8:11], s51 offen  lds
    s_add_u32 m0, s59, 6144
    s_add_u32 s51, s51, s66
    buffer_load_dwordx4 v3, s[8:11], s51 offen  lds
    s_add_u32 m0, s59, 7168
    s_add_u32 s51, s51, s66
    buffer_load_dwordx4 v4, s[8:11], s51 offen  lds
    s_add_u32 s59, s59, 24576
    s_cmp_eq_u32 s59, 153600
    s_cselect_b32 s59, 55296, s59
    s_waitcnt vmcnt(22)
    s_barrier
    s_bfe_u32 s79, s81, 0x40018
    s_lshl_b32 s79, s79, 14
    s_add_u32 s79, s79, s70
    s_add_u32 m0, s58, 0
    s_add_u32 s51, s79, 0
    buffer_load_dwordx4 v1, s[4:7], s51 offen offset:0 sc1 lds
    buffer_load_dwordx4 v1, s[4:7], s51 offen offset:1024 sc1 lds
    buffer_load_dwordx4 v1, s[4:7], s51 offen offset:2048 sc1 lds
    buffer_load_dwordx4 v1, s[4:7], s51 offen offset:3072 sc1 lds
    s_add_u32 m0, s58, 4096
    s_add_u32 s51, s79, 4096
    buffer_load_dwordx4 v1, s[4:7], s51 offen offset:0 sc1 lds
    buffer_load_dwordx4 v1, s[4:7], s51 offen offset:1024 sc1 lds
    s_add_u32 s58, s58, 18432
    s_cmp_eq_u32 s58, 55296
    s_cselect_b32 s58, 0, s58
    s_bfe_u32 s51, s81, 0x4001c
    s_mul_i32 s51, s51, s65
    s_add_u32 m0, s59, 0
    s_add_u32 s51, s51, s64
    buffer_load_dwordx4 v3, s[8:11], s51 offen  lds
    s_add_u32 m0, s59, 1024
    s_add_u32 s51, s51, s66
    buffer_load_dwordx4 v4, s[8:11], s51 offen  lds
    s_add_u32 m0, s59, 2048
    s_add_u32 s51, s51, s66
    buffer_load_dwordx4 v3, s[8:11], s51 offen  lds
    s_add_u32 m0, s59, 3072
    s_add_u32 s51, s51, s66
    buffer_load_dwordx4 v4, s[8:11], s51 offen  lds
    s_add_u32 m0, s59, 4096
    s_add_u32 s51, s51, s66
    buffer_load_dwordx4 v3, s[8:11], s51 offen  lds
    s_add_u32 m0, s59, 5120
    s_add_u32 s51, s51, s66
    buffer_load_dwordx4 v4, s[8:11], s51 offen  lds
    s_add_u32 m0, s59, 6144
    s_add_u32 s51, s51, s66
    buffer_load_dwordx4 v3, s[8:11], s51 offen  lds
    s_add_u32 m0, s59, 7168
    s_add_u32 s51, s51, s66
    buffer_load_dwordx4 v4, s[8:11], s51 offen  lds
    s_add_u32 s59, s59, 24576
    s_cmp_eq_u32 s59, 153600
    s_cselect_b32 s59, 55296, s59
    s_waitcnt vmcnt(22)
    s_barrier
    s_bfe_u32 s79, s81, 0x4001c
    s_lshl_b32 s79, s79, 14
    s_add_u32 s79, s79, s70
    s_add_u32 m0, s58, 0
    s_add_u32 s51, s79, 0
    buffer_load_dwordx4 v1, s[4:7], s51 offen offset:0 sc1 lds
    buffer_load_dwordx4 v1, s[4:7], s51 offen offset:1024 sc1 lds
    buffer_load_dwordx4 v1, s[4:7], s51 offen offset:2048 sc1 lds
    buffer_load_dwordx4 v1, s[4:7], s51 offen offset:3072 sc1 lds
    s_add_u32 m0, s58, 4096
    s_add_u32 s51, s79, 4096
    buffer_load_dwordx4 v1, s[4:7], s51 offen offset:0 sc1 lds
    buffer_load_dwordx4 v1, s[4:7], s51 offen offset:1024 sc1 lds
    s_add_u32 s58, s58, 18432
    s_cmp_eq_u32 s58, 55296
    s_cselect_b32 s58, 0, s58
    s_mov_b32 m0, 55296
    s_lshl_b32 s51, 54, s77
    buffer_load_dwordx4 v16, s[12:15], s51 offen  lds
    s_mov_b32 m0, 56320
    s_lshl_b32 s51, 55, s77
    buffer_load_dwordx4 v17, s[12:15], s51 offen  lds
    s_mov_b32 m0, 57344
    s_lshl_b32 s51, 56, s77
    buffer_load_dwordx4 v16, s[12:15], s51 offen  lds
    s_mov_b32 m0, 58368
    s_lshl_b32 s51, 57, s77
    buffer_load_dwordx4 v17, s[12:15], s51 offen  lds
    s_mov_b32 m0, 59392
    s_lshl_b32 s51, 58, s77
    buffer_load_dwordx4 v16, s[12:15], s51 offen  lds
    s_mov_b32 m0, 60416
    s_lshl_b32 s51, 59, s77
    buffer_load_dwordx4 v17, s[12:15], s51 offen  lds
    s_mov_b32 m0, 61440
    s_lshl_b32 s51, 60, s77
    buffer_load_dwordx4 v16, s[12:15], s51 offen  lds
    s_mov_b32 m0, 62464
    s_lshl_b32 s51, 61, s77
    buffer_load_dwordx4 v17, s[12:15], s51 offen  lds
    s_waitcnt vmcnt(22)
    s_barrier
    s_mov_b32 m0, 18432
    s_lshl_b32 s51, 18, s77
    buffer_load_dwordx4 v16, s[12:15], s51 offen  lds
    s_mov_b32 m0, 19456
    s_lshl_b32 s51, 19, s77
    buffer_load_dwordx4 v17, s[12:15], s51 offen  lds
    s_mov_b32 m0, 20480
    s_lshl_b32 s51, 20, s77
    buffer_load_dwordx4 v16, s[12:15], s51 offen  lds
    s_mov_b32 m0, 21504
    s_lshl_b32 s51, 21, s77
    buffer_load_dwordx4 v17, s[12:15], s51 offen  lds
    s_mov_b32 m0, 22528
    s_lshl_b32 s51, 22, s77
    buffer_load_dwordx4 v16, s[12:15], s51 offen  lds
    s_mov_b32 m0, 23552
    s_lshl_b32 s51, 23, s77
    buffer_load_dwordx4 v17, s[12:15], s51 offen  lds
    s_mov_b32 m0, 24576
    s_lshl_b32 s51, 24, s77
    buffer_load_dwordx4 v16, s[12:15], s51 offen  lds
    s_mov_b32 m0, 25600
    s_lshl_b32 s51, 25, s77
    buffer_load_dwordx4 v17, s[12:15], s51 offen  lds
    s_mov_b32 m0, 26624
    s_lshl_b32 s51, 26, s77
    buffer_load_dwordx4 v16, s[12:15], s51 offen  lds
    s_mov_b32 m0, 27648
    s_lshl_b32 s51, 27, s77
    buffer_load_dwordx4 v17, s[12:15], s51 offen  lds
    s_mov_b32 m0, 28672
    s_lshl_b32 s51, 28, s77
    buffer_load_dwordx4 v16, s[12:15], s51 offen  lds
    s_mov_b32 m0, 29696
    s_lshl_b32 s51, 29, s77
    buffer_load_dwordx4 v17, s[12:15], s51 offen  lds
    s_mov_b32 m0, 30720
    s_lshl_b32 s51, 30, s77
    buffer_load_dwordx4 v16, s[12:15], s51 offen  lds
    s_mov_b32 m0, 31744
    s_lshl_b32 s51, 31, s77
    buffer_load_dwordx4 v17, s[12:15], s51 offen  lds
    s_waitcnt vmcnt(22)
    s_barrier
    s_mov_b32 m0, 36864
    s_lshl_b32 s51, 36, s77
    buffer_load_dwordx4 v16, s[12:15], s51 offen  lds
    s_mov_b32 m0, 37888
    s_lshl_b32 s51, 37, s77
    buffer_load_dwordx4 v17, s[12:15], s51 offen  lds
    s_mov_b32 m0, 38912
    s_lshl_b32 s51, 38, s77
    buffer_load_dwordx4 v16, s[12:15], s51 offen  lds
    s_mov_b32 m0, 39936
    s_lshl_b32 s51, 39, s77
    buffer_load_dwordx4 v17, s[12:15], s51 offen  lds
    s_mov_b32 m0, 40960
    s_lshl_b32 s51, 40, s77
    buffer_load_dwordx4 v16, s[12:15], s51 offen  lds
    s_mov_b32 m0, 41984
    s_lshl_b32 s51, 41, s77
    buffer_load_dwordx4 v17, s[12:15], s51 offen  lds
    s_mov_b32 m0, 43008
    s_lshl_b32 s51, 42, s77
    buffer_load_dwordx4 v16, s[12:15], s51 offen  lds
    s_mov_b32 m0, 44032
    s_lshl_b32 s51, 43, s77
    buffer_load_dwordx4 v17, s[12:15], s51 offen  lds
    s_mov_b32 m0, 45056
    s_lshl_b32 s51, 44, s77
    buffer_load_dwordx4 v16, s[12:15], s51 offen  lds
    s_mov_b32 m0, 46080
    s_lshl_b32 s51, 45, s77
    buffer_load_dwordx4 v17, s[12:15], s51 offen  lds
    s_mov_b32 m0, 47104
    s_lshl_b32 s51, 46, s77
    buffer_load_dwordx4 v16, s[12:15], s51 offen  lds
    s_mov_b32 m0, 48128
    s_lshl_b32 s51, 47, s77
    buffer_load_dwordx4 v17, s[12:15], s51 offen  lds
    s_mov_b32 m0, 49152
    s_lshl_b32 s51, 48, s77
    buffer_load_dwordx4 v16, s[12:15], s51 offen  lds
    s_mov_b32 m0, 50176
    s_lshl_b32 s51, 49, s77
    buffer_load_dwordx4 v17, s[12:15], s51 offen  lds
    s_barrier
    s_mov_b32 m0, 0
    s_lshl_b32 s51, 0, s77
    buffer_load_dwordx4 v16, s[12:15], s51 offen  lds
    s_mov_b32 m0, 1024
    s_lshl_b32 s51, 1, s77
    buffer_load_dwordx4 v17, s[12:15], s51 offen  lds
    s_mov_b32 m0, 2048
    s_lshl_b32 s51, 2, s77
    buffer_load_dwordx4 v16, s[12:15], s51 offen  lds
    s_mov_b32 m0, 3072
    s_lshl_b32 s51, 3, s77
    buffer_load_dwordx4 v17, s[12:15], s51 offen  lds
    s_mov_b32 m0, 4096
    s_lshl_b32 s51, 4, s77
    buffer_load_dwordx4 v16, s[12:15], s51 offen  lds
    s_mov_b32 m0, 5120
    s_lshl_b32 s51, 5, s77
    buffer_load_dwordx4 v17, s[12:15], s51 offen  lds
prod_tail_w0:
    s_waitcnt vmcnt(0)
    s_barrier
    s_cmp_eq_u32 s42, 3
    s_cbranch_scc1 prod_end_w0
    s_add_u32 s42, s42, 1
    s_add_u32 s44, s44, 1
    s_bitcmp1_b32 s42, 0
    s_cselect_b32 s8, s30, s28
    s_cselect_b32 s9, s31, s29
    s_cmp_eq_u32 s67, 0
    s_cbranch_scc1 notslow_22
    s_mov_b32 s8, s4
    s_mov_b32 s9, s5
    s_mov_b32 s10, s6
    s_mov_b32 s65, 24576
    s_mov_b32 s66, 1024
    v_mov_b32 v3, v1
    v_mov_b32 v4, v1
    s_and_b32 s64, s42, 1
    s_mul_i32 s64, s64, 6291456
    s_mul_i32 s49, s37, 393216
    s_add_u32 s64, s64, s49
    s_add_u32 s64, s64, 41943040
notslow_22:
    s_barrier
    s_mov_b32 s59, 55296
    s_bfe_u32 s51, s80, 0x40000
    s_mul_i32 s51, s51, s65
    s_add_u32 m0, s59, 0
    s_add_u32 s51, s51, s64
    buffer_load_dwordx4 v3, s[8:11], s51 offen  lds
    s_add_u32 m0, s59, 1024
    s_add_u32 s51, s51, s66
    buffer_load_dwordx4 v4, s[8:11], s51 offen  lds
    s_add_u32 m0, s59, 2048
    s_add_u32 s51, s51, s66
    buffer_load_dwordx4 v3, s[8:11], s51 offen  lds
    s_add_u32 m0, s59, 3072
    s_add_u32 s51, s51, s66
    buffer_load_dwordx4 v4, s[8:11], s51 offen  lds
    s_add_u32 m0, s59, 4096
    s_add_u32 s51, s51, s66
    buffer_load_dwordx4 v3, s[8:11], s51 offen  lds
    s_add_u32 m0, s59, 5120
    s_add_u32 s51, s51, s66
    buffer_load_dwordx4 v4, s[8:11], s51 offen  lds
    s_add_u32 m0, s59, 6144
    s_add_u32 s51, s51, s66
    buffer_load_dwordx4 v3, s[8:11], s51 offen  lds
    s_add_u32 m0, s59, 7168
    s_add_u32 s51, s51, s66
    buffer_load_dwordx4 v4, s[8:11], s51 offen  lds
    s_add_u32 s59, s59, 24576
    s_cmp_eq_u32 s59, 153600
    s_cselect_b32 s59, 55296, s59
    s_bfe_u32 s51, s80, 0x40004
    s_mul_i32 s51, s51, s65
    s_add_u32 m0, s59, 0
    s_add_u32 s51, s51, s64
    buffer_load_dwordx4 v3, s[8:11], s51 offen  lds
    s_add_u32 m0, s59, 1024
    s_add_u32 s51, s51, s66
    buffer_load_dwordx4 v4, s[8:11], s51 offen  lds
    s_add_u32 m0, s59, 2048
    s_add_u32 s51, s51, s66
    buffer_load_dwordx4 v3, s[8:11], s51 offen  lds
    s_add_u32 m0, s59, 3072
    s_add_u32 s51, s51, s66
    buffer_load_dwordx4 v4, s[8:11], s51 offen  lds
    s_add_u32 m0, s59, 4096
    s_add_u32 s51, s51, s66
    buffer_load_dwordx4 v3, s[8:11], s51 offen  lds
    s_add_u32 m0, s59, 5120
    s_add_u32 s51, s51, s66
    buffer_load_dwordx4 v4, s[8:11], s51 offen  lds
    s_add_u32 m0, s59, 6144
    s_add_u32 s51, s51, s66
    buffer_load_dwordx4 v3, s[8:11], s51 offen  lds
    s_add_u32 m0, s59, 7168
    s_add_u32 s51, s51, s66
    buffer_load_dwordx4 v4, s[8:11], s51 offen  lds
    s_add_u32 s59, s59, 24576
    s_cmp_eq_u32 s59, 153600
    s_cselect_b32 s59, 55296, s59
    s_bfe_u32 s51, s80, 0x40008
    s_mul_i32 s51, s51, s65
    s_add_u32 m0, s59, 0
    s_add_u32 s51, s51, s64
    buffer_load_dwordx4 v3, s[8:11], s51 offen  lds
    s_add_u32 m0, s59, 1024
    s_add_u32 s51, s51, s66
    buffer_load_dwordx4 v4, s[8:11], s51 offen  lds
    s_add_u32 m0, s59, 2048
    s_add_u32 s51, s51, s66
    buffer_load_dwordx4 v3, s[8:11], s51 offen  lds
    s_add_u32 m0, s59, 3072
    s_add_u32 s51, s51, s66
    buffer_load_dwordx4 v4, s[8:11], s51 offen  lds
    s_add_u32 m0, s59, 4096
    s_add_u32 s51, s51, s66
    buffer_load_dwordx4 v3, s[8:11], s51 offen  lds
    s_add_u32 m0, s59, 5120
    s_add_u32 s51, s51, s66
    buffer_load_dwordx4 v4, s[8:11], s51 offen  lds
    s_add_u32 m0, s59, 6144
    s_add_u32 s51, s51, s66
    buffer_load_dwordx4 v3, s[8:11], s51 offen  lds
    s_add_u32 m0, s59, 7168
    s_add_u32 s51, s51, s66
    buffer_load_dwordx4 v4, s[8:11], s51 offen  lds
    s_add_u32 s59, s59, 24576
    s_cmp_eq_u32 s59, 153600
    s_cselect_b32 s59, 55296, s59
    s_bfe_u32 s51, s80, 0x4000c
    s_mul_i32 s51, s51, s65
    s_add_u32 m0, s59, 0
    s_add_u32 s51, s51, s64
    buffer_load_dwordx4 v3, s[8:11], s51 offen  lds
    s_add_u32 m0, s59, 1024
    s_add_u32 s51, s51, s66
    buffer_load_dwordx4 v4, s[8:11], s51 offen  lds
    s_add_u32 m0, s59, 2048
    s_add_u32 s51, s51, s66
    buffer_load_dwordx4 v3, s[8:11], s51 offen  lds
    s_add_u32 m0, s59, 3072
    s_add_u32 s51, s51, s66
    buffer_load_dwordx4 v4, s[8:11], s51 offen  lds
    s_add_u32 m0, s59, 4096
    s_add_u32 s51, s51, s66
    buffer_load_dwordx4 v3, s[8:11], s51 offen  lds
    s_add_u32 m0, s59, 5120
    s_add_u32 s51, s51, s66
    buffer_load_dwordx4 v4, s[8:11], s51 offen  lds
    s_add_u32 m0, s59, 6144
    s_add_u32 s51, s51, s66
    buffer_load_dwordx4 v3, s[8:11], s51 offen  lds
    s_add_u32 m0, s59, 7168
    s_add_u32 s51, s51, s66
    buffer_load_dwordx4 v4, s[8:11], s51 offen  lds
    s_add_u32 s59, s59, 24576
    s_cmp_eq_u32 s59, 153600
    s_cselect_b32 s59, 55296, s59
    s_branch prod_layer_w0
prod_end_w0:
    s_endpgm
prod_w1:
    v_and_b32 v9, 63, v0
    v_lshrrev_b32 v10, 3, v9
    v_and_b32 v11, 7, v9
    v_lshrrev_b32 v12, 4, v9
    v_and_b32 v13, 15, v9
    v_lshlrev_b32 v1, 4, v9
    v_and_b32 v14, 1, v12
    v_or_b32 v14, 0, v14
    v_lshlrev_b32 v14, 1, v14
    v_xor_b32 v14, v14, v11
    v_lshlrev_b32 v14, 4, v14
    v_mul_u32_u24 v15, 6144, v10
    v_add_u32 v3, v14, v15
    v_and_b32 v14, 1, v12
    v_or_b32 v14, 2, v14
    v_lshlrev_b32 v14, 1, v14
    v_xor_b32 v14, v14, v11
    v_lshlrev_b32 v14, 4, v14
    v_mul_u32_u24 v15, 6144, v10
    v_add_u32 v4, v14, v15
    v_and_b32 v14, 1, v12
    v_or_b32 v14, 0, v14
    v_lshlrev_b32 v14, 1, v14
    v_xor_b32 v14, v14, v11
    v_lshlrev_b32 v14, 4, v14
    v_lshl_add_u32 v16, v10, 11, v14
    v_and_b32 v14, 1, v12
    v_or_b32 v14, 2, v14
    v_lshlrev_b32 v14, 1, v14
    v_xor_b32 v14, v14, v11
    v_lshlrev_b32 v14, 4, v14
    v_lshl_add_u32 v17, v10, 11, v14
    s_lshl_b32 s49, s39, 7
    v_add_u32 v16, s49, v16
    v_add_u32 v17, s49, v17
    s_mov_b32 s77, 14
    v_or_b32 v14, 0, v12
    v_xor_b32 v14, v14, v11
    v_lshlrev_b32 v14, 4, v14
    v_lshl_add_u32 v6, v10, 12, v14
    v_or_b32 v14, 4, v12
    v_xor_b32 v14, v14, v11
    v_lshlrev_b32 v14, 4, v14
    v_lshl_add_u32 v7, v10, 12, v14
    s_lshl_b32 s64, s37, 7
    s_add_u32 s64, s64, 2048
    s_mov_b32 s65, 393216
    s_mov_b32 s66, 49152
    s_and_b32 s67, s37, 7
    s_cmp_eq_u32 s67, 3
    s_cselect_b32 s67, 1, 0
    s_lshl_b32 s70, s36, 18
    s_sub_u32 s48, s36, 1
    s_max_i32 s48, s48, 0
    s_lshl_b32 s71, s48, 18
    s_mov_b32 s59, 55296
    s_mov_b32 s58, 0
    s_mul_i32 s51, s65, 4
    s_add_u32 m0, s59, 8192
    s_add_u32 s51, s51, s64
    buffer_load_dwordx4 v3, s[8:11], s51 offen  lds
    s_add_u32 m0, s59, 9216
    s_add_u32 s51, s51, s66
    buffer_load_dwordx4 v4, s[8:11], s51 offen  lds
    s_add_u32 m0, s59, 10240
    s_add_u32 s51, s51, s66
    buffer_load_dwordx4 v3, s[8:11], s51 offen  lds
    s_add_u32 m0, s59, 11264
    s_add_u32 s51, s51, s66
    buffer_load_dwordx4 v4, s[8:11], s51 offen  lds
    s_add_u32 m0, s59, 12288
    s_add_u32 s51, s51, s66
    buffer_load_dwordx4 v3, s[8:11], s51 offen  lds
    s_add_u32 m0, s59, 13312
    s_add_u32 s51, s51, s66
    buffer_load_dwordx4 v4, s[8:11], s51 offen  lds
    s_add_u32 m0, s59, 14336
    s_add_u32 s51, s51, s66
    buffer_load_dwordx4 v3, s[8:11], s51 offen  lds
    s_add_u32 m0, s59, 15360
    s_add_u32 s51, s51, s66
    buffer_load_dwordx4 v4, s[8:11], s51 offen  lds
    s_add_u32 s59, s59, 24576
    s_cmp_eq_u32 s59, 153600
    s_cselect_b32 s59, 55296, s59
    s_add_u32 m0, s58, 6144
    s_add_u32 s51, s70, 197120
    buffer_load_dwordx4 v6, s[16:19], s51 offen lds
    s_add_u32 m0, s58, 7168
    s_add_u32 s51, s70, 229888
    buffer_load_dwordx4 v7, s[16:19], s51 offen lds
    s_add_u32 m0, s58, 8192
    s_add_u32 s51, s70, 2560
    buffer_load_dwordx4 v6, s[16:19], s51 offen lds
    s_add_u32 m0, s58, 9216
    s_add_u32 s51, s70, 35328
    buffer_load_dwordx4 v7, s[16:19], s51 offen lds
    s_add_u32 m0, s58, 10240
    s_add_u32 s51, s70, 68096
    buffer_load_dwordx4 v6, s[16:19], s51 offen lds
    s_add_u32 m0, s58, 11264
    s_add_u32 s51, s70, 100864
    buffer_load_dwordx4 v7, s[16:19], s51 offen lds
    s_add_u32 s58, s58, 18432
    s_cmp_eq_u32 s58, 55296
    s_cselect_b32 s58, 0, s58
    s_mul_i32 s51, s65, 5
    s_add_u32 m0, s59, 8192
    s_add_u32 s51, s51, s64
    buffer_load_dwordx4 v3, s[8:11], s51 offen  lds
    s_add_u32 m0, s59, 9216
    s_add_u32 s51, s51, s66
    buffer_load_dwordx4 v4, s[8:11], s51 offen  lds
    s_add_u32 m0, s59, 10240
    s_add_u32 s51, s51, s66
    buffer_load_dwordx4 v3, s[8:11], s51 offen  lds
    s_add_u32 m0, s59, 11264
    s_add_u32 s51, s51, s66
    buffer_load_dwordx4 v4, s[8:11], s51 offen  lds
    s_add_u32 m0, s59, 12288
    s_add_u32 s51, s51, s66
    buffer_load_dwordx4 v3, s[8:11], s51 offen  lds
    s_add_u32 m0, s59, 13312
    s_add_u32 s51, s51, s66
    buffer_load_dwordx4 v4, s[8:11], s51 offen  lds
    s_add_u32 m0, s59, 14336
    s_add_u32 s51, s51, s66
    buffer_load_dwordx4 v3, s[8:11], s51 offen  lds
    s_add_u32 m0, s59, 15360
    s_add_u32 s51, s51, s66
    buffer_load_dwordx4 v4, s[8:11], s51 offen  lds
    s_add_u32 s59, s59, 24576
    s_cmp_eq_u32 s59, 153600
    s_cselect_b32 s59, 55296, s59
    s_add_u32 m0, s58, 6144
    s_add_u32 s51, s70, 197248
    buffer_load_dwordx4 v6, s[16:19], s51 offen lds
    s_add_u32 m0, s58, 7168
    s_add_u32 s51, s70, 230016
    buffer_load_dwordx4 v7, s[16:19], s51 offen lds
    s_add_u32 m0, s58, 8192
    s_add_u32 s51, s70, 2688
    buffer_load_dwordx4 v6, s[16:19], s51 offen lds
    s_add_u32 m0, s58, 9216
    s_add_u32 s51, s70, 35456
    buffer_load_dwordx4 v7, s[16:19], s51 offen lds
    s_add_u32 m0, s58, 10240
    s_add_u32 s51, s70, 68224
    buffer_load_dwordx4 v6, s[16:19], s51 offen lds
    s_add_u32 m0, s58, 11264
    s_add_u32 s51, s70, 100992
    buffer_load_dwordx4 v7, s[16:19], s51 offen lds
    s_add_u32 s58, s58, 18432
    s_cmp_eq_u32 s58, 55296
    s_cselect_b32 s58, 0, s58
    s_add_u32 m0, s58, 6144
    s_add_u32 s51, s70, 197376
    buffer_load_dwordx4 v6, s[16:19], s51 offen lds
    s_add_u32 m0, s58, 7168
    s_add_u32 s51, s70, 230144
    buffer_load_dwordx4 v7, s[16:19], s51 offen lds
    s_add_u32 m0, s58, 8192
    s_add_u32 s51, s70, 2816
    buffer_load_dwordx4 v6, s[16:19], s51 offen lds
    s_add_u32 m0, s58, 9216
    s_add_u32 s51, s70, 35584
    buffer_load_dwordx4 v7, s[16:19], s51 offen lds
    s_add_u32 m0, s58, 10240
    s_add_u32 s51, s70, 68352
    buffer_load_dwordx4 v6, s[16:19], s51 offen lds
    s_add_u32 m0, s58, 11264
    s_add_u32 s51, s70, 101120
    buffer_load_dwordx4 v7, s[16:19], s51 offen lds
    s_add_u32 s58, s58, 18432
    s_cmp_eq_u32 s58, 55296
    s_cselect_b32 s58, 0, s58
    s_mul_i32 s51, s65, 6
    s_add_u32 m0, s59, 8192
    s_add_u32 s51, s51, s64
    buffer_load_dwordx4 v3, s[8:11], s51 offen  lds
    s_add_u32 m0, s59, 9216
    s_add_u32 s51, s51, s66
    buffer_load_dwordx4 v4, s[8:11], s51 offen  lds
    s_add_u32 m0, s59, 10240
    s_add_u32 s51, s51, s66
    buffer_load_dwordx4 v3, s[8:11], s51 offen  lds
    s_add_u32 m0, s59, 11264
    s_add_u32 s51, s51, s66
    buffer_load_dwordx4 v4, s[8:11], s51 offen  lds
    s_add_u32 m0, s59, 12288
    s_add_u32 s51, s51, s66
    buffer_load_dwordx4 v3, s[8:11], s51 offen  lds
    s_add_u32 m0, s59, 13312
    s_add_u32 s51, s51, s66
    buffer_load_dwordx4 v4, s[8:11], s51 offen  lds
    s_add_u32 m0, s59, 14336
    s_add_u32 s51, s51, s66
    buffer_load_dwordx4 v3, s[8:11], s51 offen  lds
    s_add_u32 m0, s59, 15360
    s_add_u32 s51, s51, s66
    buffer_load_dwordx4 v4, s[8:11], s51 offen  lds
    s_add_u32 s59, s59, 24576
    s_cmp_eq_u32 s59, 153600
    s_cselect_b32 s59, 55296, s59
    s_mul_i32 s51, s65, 7
    s_add_u32 m0, s59, 8192
    s_add_u32 s51, s51, s64
    buffer_load_dwordx4 v3, s[8:11], s51 offen  lds
    s_add_u32 m0, s59, 9216
    s_add_u32 s51, s51, s66
    buffer_load_dwordx4 v4, s[8:11], s51 offen  lds
    s_add_u32 m0, s59, 10240
    s_add_u32 s51, s51, s66
    buffer_load_dwordx4 v3, s[8:11], s51 offen  lds
    s_add_u32 m0, s59, 11264
    s_add_u32 s51, s51, s66
    buffer_load_dwordx4 v4, s[8:11], s51 offen  lds
    s_add_u32 m0, s59, 12288
    s_add_u32 s51, s51, s66
    buffer_load_dwordx4 v3, s[8:11], s51 offen  lds
    s_add_u32 m0, s59, 13312
    s_add_u32 s51, s51, s66
    buffer_load_dwordx4 v4, s[8:11], s51 offen  lds
    s_add_u32 m0, s59, 14336
    s_add_u32 s51, s51, s66
    buffer_load_dwordx4 v3, s[8:11], s51 offen  lds
    s_add_u32 m0, s59, 15360
    s_add_u32 s51, s51, s66
    buffer_load_dwordx4 v4, s[8:11], s51 offen  lds
    s_add_u32 s59, s59, 24576
    s_cmp_eq_u32 s59, 153600
    s_cselect_b32 s59, 55296, s59
    s_mov_b32 s80, 0xfedc7654
    s_mov_b32 s81, 0xb3a29180
    s_mov_b32 s46, 0x3210eca8
    s_mov_b32 s47, 0x7654fdb9
    s_lshl_b32 s45, s37, 2
    s_lshr_b64 s[46:47], s[46:47], s45
    s_and_b32 s45, s46, 15
    s_lshl_b32 s45, s45, 2
    s_bfm_b64 s[46:47], s45, 0
    s_and_b64 s[46:47], s[46:47], s[80:81]
    s_lshl_b64 s[46:47], s[46:47], 4
    s_lshr_b64 s[48:49], s[80:81], s45
    s_lshr_b64 s[48:49], s[48:49], 4
    s_lshl_b64 s[48:49], s[48:49], 4
    s_lshl_b64 s[48:49], s[48:49], s45
    s_or_b64 s[80:81], s[46:47], s[48:49]
    s_or_b32 s80, s80, s37
    v_lshlrev_b32 v14, 8, v12
    v_or_b32 v15, 8, v13
    v_lshl_add_u32 v14, v15, 4, v14
    v_lshrrev_b32 v15, 3, v13
    v_lshlrev_b32 v15, 13, v15
    v_add_u32 v14, v14, v15
    v_add_u32 v2, 6144, v14
    s_waitcnt vmcnt(36)
    s_barrier
    s_bitcmp1_b32 s42, 0
    s_cselect_b32 s12, s34, s32
    s_cselect_b32 s13, s35, s33
    s_cmp_eq_u32 s67, 0
    s_cbranch_scc1 wo_notslow_23
    s_mov_b32 s12, s4
    s_mov_b32 s13, s5
    s_mov_b32 s14, s6
    s_and_b32 s75, s42, 1
    s_lshl_b32 s75, s75, 21
    s_lshl_b32 s49, s39, 17
    s_add_u32 s75, s75, s49
    s_add_u32 s75, s75, 54525952
    v_add_u32 v16, s75, v1
    v_mov_b32 v17, v16
    s_mov_b32 s77, 10
wo_notslow_23:
    s_waitcnt vmcnt(22)
    s_barrier
    s_add_u32 m0, s58, 6144
    s_add_u32 s51, s70, 197504
    buffer_load_dwordx4 v6, s[16:19], s51 offen lds
    s_add_u32 m0, s58, 7168
    s_add_u32 s51, s70, 230272
    buffer_load_dwordx4 v7, s[16:19], s51 offen lds
    s_add_u32 m0, s58, 8192
    s_add_u32 s51, s70, 2944
    buffer_load_dwordx4 v6, s[16:19], s51 offen lds
    s_add_u32 m0, s58, 9216
    s_add_u32 s51, s70, 35712
    buffer_load_dwordx4 v7, s[16:19], s51 offen lds
    s_add_u32 m0, s58, 10240
    s_add_u32 s51, s70, 68480
    buffer_load_dwordx4 v6, s[16:19], s51 offen lds
    s_add_u32 m0, s58, 11264
    s_add_u32 s51, s70, 101248
    buffer_load_dwordx4 v7, s[16:19], s51 offen lds
    s_add_u32 s58, s58, 18432
    s_cmp_eq_u32 s58, 55296
    s_cselect_b32 s58, 0, s58
    s_mul_i32 s51, s65, 12
    s_add_u32 m0, s59, 8192
    s_add_u32 s51, s51, s64
    buffer_load_dwordx4 v3, s[8:11], s51 offen  lds
    s_add_u32 m0, s59, 9216
    s_add_u32 s51, s51, s66
    buffer_load_dwordx4 v4, s[8:11], s51 offen  lds
    s_add_u32 m0, s59, 10240
    s_add_u32 s51, s51, s66
    buffer_load_dwordx4 v3, s[8:11], s51 offen  lds
    s_add_u32 m0, s59, 11264
    s_add_u32 s51, s51, s66
    buffer_load_dwordx4 v4, s[8:11], s51 offen  lds
    s_add_u32 m0, s59, 12288
    s_add_u32 s51, s51, s66
    buffer_load_dwordx4 v3, s[8:11], s51 offen  lds
    s_add_u32 m0, s59, 13312
    s_add_u32 s51, s51, s66
    buffer_load_dwordx4 v4, s[8:11], s51 offen  lds
    s_add_u32 m0, s59, 14336
    s_add_u32 s51, s51, s66
    buffer_load_dwordx4 v3, s[8:11], s51 offen  lds
    s_add_u32 m0, s59, 15360
    s_add_u32 s51, s51, s66
    buffer_load_dwordx4 v4, s[8:11], s51 offen  lds
    s_add_u32 s59, s59, 24576
    s_cmp_eq_u32 s59, 153600
    s_cselect_b32 s59, 55296, s59
    s_waitcnt vmcnt(22)
    s_barrier
    s_add_u32 m0, s58, 6144
    s_add_u32 s51, s70, 198144
    buffer_load_dwordx4 v6, s[16:19], s51 offen lds
    s_add_u32 m0, s58, 7168
    s_add_u32 s51, s70, 230912
    buffer_load_dwordx4 v7, s[16:19], s51 offen lds
    s_add_u32 m0, s58, 8192
    s_add_u32 s51, s70, 3584
    buffer_load_dwordx4 v6, s[16:19], s51 offen lds
    s_add_u32 m0, s58, 9216
    s_add_u32 s51, s70, 36352
    buffer_load_dwordx4 v7, s[16:19], s51 offen lds
    s_add_u32 m0, s58, 10240
    s_add_u32 s51, s70, 69120
    buffer_load_dwordx4 v6, s[16:19], s51 offen lds
    s_add_u32 m0, s58, 11264
    s_add_u32 s51, s70, 101888
    buffer_load_dwordx4 v7, s[16:19], s51 offen lds
    s_add_u32 s58, s58, 18432
    s_cmp_eq_u32 s58, 55296
    s_cselect_b32 s58, 0, s58
    s_mul_i32 s51, s65, 13
    s_add_u32 m0, s59, 8192
    s_add_u32 s51, s51, s64
    buffer_load_dwordx4 v3, s[8:11], s51 offen  lds
    s_add_u32 m0, s59, 9216
    s_add_u32 s51, s51, s66
    buffer_load_dwordx4 v4, s[8:11], s51 offen  lds
    s_add_u32 m0, s59, 10240
    s_add_u32 s51, s51, s66
    buffer_load_dwordx4 v3, s[8:11], s51 offen  lds
    s_add_u32 m0, s59, 11264
    s_add_u32 s51, s51, s66
    buffer_load_dwordx4 v4, s[8:11], s51 offen  lds
    s_add_u32 m0, s59, 12288
    s_add_u32 s51, s51, s66
    buffer_load_dwordx4 v3, s[8:11], s51 offen  lds
    s_add_u32 m0, s59, 13312
    s_add_u32 s51, s51, s66
    buffer_load_dwordx4 v4, s[8:11], s51 offen  lds
    s_add_u32 m0, s59, 14336
    s_add_u32 s51, s51, s66
    buffer_load_dwordx4 v3, s[8:11], s51 offen  lds
    s_add_u32 m0, s59, 15360
    s_add_u32 s51, s51, s66
    buffer_load_dwordx4 v4, s[8:11], s51 offen  lds
    s_add_u32 s59, s59, 24576
    s_cmp_eq_u32 s59, 153600
    s_cselect_b32 s59, 55296, s59
    s_waitcnt vmcnt(22)
    s_barrier
    s_add_u32 m0, s58, 6144
    s_add_u32 s51, s70, 198272
    buffer_load_dwordx4 v6, s[16:19], s51 offen lds
    s_add_u32 m0, s58, 7168
    s_add_u32 s51, s70, 231040
    buffer_load_dwordx4 v7, s[16:19], s51 offen lds
    s_add_u32 m0, s58, 8192
    s_add_u32 s51, s70, 3712
    buffer_load_dwordx4 v6, s[16:19], s51 offen lds
    s_add_u32 m0, s58, 9216
    s_add_u32 s51, s70, 36480
    buffer_load_dwordx4 v7, s[16:19], s51 offen lds
    s_add_u32 m0, s58, 10240
    s_add_u32 s51, s70, 69248
    buffer_load_dwordx4 v6, s[16:19], s51 offen lds
    s_add_u32 m0, s58, 11264
    s_add_u32 s51, s70, 102016
    buffer_load_dwordx4 v7, s[16:19], s51 offen lds
    s_add_u32 s58, s58, 18432
    s_cmp_eq_u32 s58, 55296
    s_cselect_b32 s58, 0, s58
    s_cmp_eq_u32 s67, 0
    s_cbranch_scc1 notslow_24
    s_mov_b32 s8, s4
    s_mov_b32 s9, s5
    s_mov_b32 s10, s6
    s_mov_b32 s65, 24576
    s_mov_b32 s66, 1024
    v_mov_b32 v3, v1
    v_mov_b32 v4, v1
    s_and_b32 s64, s42, 1
    s_mul_i32 s64, s64, 6291456
    s_mul_i32 s49, s37, 393216
    s_add_u32 s64, s64, s49
    s_add_u32 s64, s64, 41951232
notslow_24:
    s_mul_i32 s51, s65, 14
    s_add_u32 m0, s59, 8192
    s_add_u32 s51, s51, s64
    buffer_load_dwordx4 v3, s[8:11], s51 offen  lds
    s_add_u32 m0, s59, 9216
    s_add_u32 s51, s51, s66
    buffer_load_dwordx4 v4, s[8:11], s51 offen  lds
    s_add_u32 m0, s59, 10240
    s_add_u32 s51, s51, s66
    buffer_load_dwordx4 v3, s[8:11], s51 offen  lds
    s_add_u32 m0, s59, 11264
    s_add_u32 s51, s51, s66
    buffer_load_dwordx4 v4, s[8:11], s51 offen  lds
    s_add_u32 m0, s59, 12288
    s_add_u32 s51, s51, s66
    buffer_load_dwordx4 v3, s[8:11], s51 offen  lds
    s_add_u32 m0, s59, 13312
    s_add_u32 s51, s51, s66
    buffer_load_dwordx4 v4, s[8:11], s51 offen  lds
    s_add_u32 m0, s59, 14336
    s_add_u32 s51, s51, s66
    buffer_load_dwordx4 v3, s[8:11], s51 offen  lds
    s_add_u32 m0, s59, 15360
    s_add_u32 s51, s51, s66
    buffer_load_dwordx4 v4, s[8:11], s51 offen  lds
    s_add_u32 s59, s59, 24576
    s_cmp_eq_u32 s59, 153600
    s_cselect_b32 s59, 55296, s59
    s_waitcnt vmcnt(22)
    s_barrier
    s_add_u32 m0, s58, 6144
    s_add_u32 s51, s70, 198400
    buffer_load_dwordx4 v6, s[16:19], s51 offen lds
    s_add_u32 m0, s58, 7168
    s_add_u32 s51, s70, 231168
    buffer_load_dwordx4 v7, s[16:19], s51 offen lds
    s_add_u32 m0, s58, 8192
    s_add_u32 s51, s70, 3840
    buffer_load_dwordx4 v6, s[16:19], s51 offen lds
    s_add_u32 m0, s58, 9216
    s_add_u32 s51, s70, 36608
    buffer_load_dwordx4 v7, s[16:19], s51 offen lds
    s_add_u32 m0, s58, 10240
    s_add_u32 s51, s70, 69376
    buffer_load_dwordx4 v6, s[16:19], s51 offen lds
    s_add_u32 m0, s58, 11264
    s_add_u32 s51, s70, 102144
    buffer_load_dwordx4 v7, s[16:19], s51 offen lds
    s_add_u32 s58, s58, 18432
    s_cmp_eq_u32 s58, 55296
    s_cselect_b32 s58, 0, s58
    s_mul_i32 s51, s65, 15
    s_add_u32 m0, s59, 8192
    s_add_u32 s51, s51, s64
    buffer_load_dwordx4 v3, s[8:11], s51 offen  lds
    s_add_u32 m0, s59, 9216
    s_add_u32 s51, s51, s66
    buffer_load_dwordx4 v4, s[8:11], s51 offen  lds
    s_add_u32 m0, s59, 10240
    s_add_u32 s51, s51, s66
    buffer_load_dwordx4 v3, s[8:11], s51 offen  lds
    s_add_u32 m0, s59, 11264
    s_add_u32 s51, s51, s66
    buffer_load_dwordx4 v4, s[8:11], s51 offen  lds
    s_add_u32 m0, s59, 12288
    s_add_u32 s51, s51, s66
    buffer_load_dwordx4 v3, s[8:11], s51 offen  lds
    s_add_u32 m0, s59, 13312
    s_add_u32 s51, s51, s66
    buffer_load_dwordx4 v4, s[8:11], s51 offen  lds
    s_add_u32 m0, s59, 14336
    s_add_u32 s51, s51, s66
    buffer_load_dwordx4 v3, s[8:11], s51 offen  lds
    s_add_u32 m0, s59, 15360
    s_add_u32 s51, s51, s66
    buffer_load_dwordx4 v4, s[8:11], s51 offen  lds
    s_add_u32 s59, s59, 24576
    s_cmp_eq_u32 s59, 153600
    s_cselect_b32 s59, 55296, s59
    s_waitcnt vmcnt(22)
    s_barrier
    s_add_u32 m0, s58, 6144
    s_add_u32 s51, s70, 198528
    buffer_load_dwordx4 v6, s[16:19], s51 offen lds
    s_add_u32 m0, s58, 7168
    s_add_u32 s51, s70, 231296
    buffer_load_dwordx4 v7, s[16:19], s51 offen lds
    s_add_u32 m0, s58, 8192
    s_add_u32 s51, s70, 3968
    buffer_load_dwordx4 v6, s[16:19], s51 offen lds
    s_add_u32 m0, s58, 9216
    s_add_u32 s51, s70, 36736
    buffer_load_dwordx4 v7, s[16:19], s51 offen lds
    s_add_u32 m0, s58, 10240
    s_add_u32 s51, s70, 69504
    buffer_load_dwordx4 v6, s[16:19], s51 offen lds
    s_add_u32 m0, s58, 11264
    s_add_u32 s51, s70, 102272
    buffer_load_dwordx4 v7, s[16:19], s51 offen lds
    s_add_u32 s58, s58, 18432
    s_cmp_eq_u32 s58, 55296
    s_cselect_b32 s58, 0, s58
    s_mul_i32 s51, s65, 0
    s_add_u32 m0, s59, 8192
    s_add_u32 s51, s51, s64
    buffer_load_dwordx4 v3, s[8:11], s51 offen  lds
    s_add_u32 m0, s59, 9216
    s_add_u32 s51, s51, s66
    buffer_load_dwordx4 v4, s[8:11], s51 offen  lds
    s_add_u32 m0, s59, 10240
    s_add_u32 s51, s51, s66
    buffer_load_dwordx4 v3, s[8:11], s51 offen  lds
    s_add_u32 m0, s59, 11264
    s_add_u32 s51, s51, s66
    buffer_load_dwordx4 v4, s[8:11], s51 offen  lds
    s_add_u32 m0, s59, 12288
    s_add_u32 s51, s51, s66
    buffer_load_dwordx4 v3, s[8:11], s51 offen  lds
    s_add_u32 m0, s59, 13312
    s_add_u32 s51, s51, s66
    buffer_load_dwordx4 v4, s[8:11], s51 offen  lds
    s_add_u32 m0, s59, 14336
    s_add_u32 s51, s51, s66
    buffer_load_dwordx4 v3, s[8:11], s51 offen  lds
    s_add_u32 m0, s59, 15360
    s_add_u32 s51, s51, s66
    buffer_load_dwordx4 v4, s[8:11], s51 offen  lds
    s_add_u32 s59, s59, 24576
    s_cmp_eq_u32 s59, 153600
    s_cselect_b32 s59, 55296, s59
    s_waitcnt vmcnt(22)
    s_barrier
    s_add_u32 m0, s58, 6144
    s_add_u32 s51, s70, 196608
    buffer_load_dwordx4 v6, s[16:19], s51 offen lds
    s_add_u32 m0, s58, 7168
    s_add_u32 s51, s70, 229376
    buffer_load_dwordx4 v7, s[16:19], s51 offen lds
    s_add_u32 m0, s58, 8192
    s_add_u32 s51, s70, 2048
    buffer_load_dwordx4 v6, s[16:19], s51 offen lds
    s_add_u32 m0, s58, 9216
    s_add_u32 s51, s70, 34816
    buffer_load_dwordx4 v7, s[16:19], s51 offen lds
    s_add_u32 m0, s58, 10240
    s_add_u32 s51, s70, 67584
    buffer_load_dwordx4 v6, s[16:19], s51 offen lds
    s_add_u32 m0, s58, 11264
    s_add_u32 s51, s70, 100352
    buffer_load_dwordx4 v7, s[16:19], s51 offen lds
    s_add_u32 s58, s58, 18432
    s_cmp_eq_u32 s58, 55296
    s_cselect_b32 s58, 0, s58
    s_mul_i32 s51, s65, 8
    s_add_u32 m0, s59, 8192
    s_add_u32 s51, s51, s64
    buffer_load_dwordx4 v3, s[8:11], s51 offen  lds
    s_add_u32 m0, s59, 9216
    s_add_u32 s51, s51, s66
    buffer_load_dwordx4 v4, s[8:11], s51 offen  lds
    s_add_u32 m0, s59, 10240
    s_add_u32 s51, s51, s66
    buffer_load_dwordx4 v3, s[8:11], s51 offen  lds
    s_add_u32 m0, s59, 11264
    s_add_u32 s51, s51, s66
    buffer_load_dwordx4 v4, s[8:11], s51 offen  lds
    s_add_u32 m0, s59, 12288
    s_add_u32 s51, s51, s66
    buffer_load_dwordx4 v3, s[8:11], s51 offen  lds
    s_add_u32 m0, s59, 13312
    s_add_u32 s51, s51, s66
    buffer_load_dwordx4 v4, s[8:11], s51 offen  lds
    s_add_u32 m0, s59, 14336
    s_add_u32 s51, s51, s66
    buffer_load_dwordx4 v3, s[8:11], s51 offen  lds
    s_add_u32 m0, s59, 15360
    s_add_u32 s51, s51, s66
    buffer_load_dwordx4 v4, s[8:11], s51 offen  lds
    s_add_u32 s59, s59, 24576
    s_cmp_eq_u32 s59, 153600
    s_cselect_b32 s59, 55296, s59
    s_waitcnt vmcnt(22)
    s_barrier
    s_add_u32 m0, s58, 6144
    s_add_u32 s51, s70, 197632
    buffer_load_dwordx4 v6, s[16:19], s51 offen lds
    s_add_u32 m0, s58, 7168
    s_add_u32 s51, s70, 230400
    buffer_load_dwordx4 v7, s[16:19], s51 offen lds
    s_add_u32 m0, s58, 8192
    s_add_u32 s51, s70, 3072
    buffer_load_dwordx4 v6, s[16:19], s51 offen lds
    s_add_u32 m0, s58, 9216
    s_add_u32 s51, s70, 35840
    buffer_load_dwordx4 v7, s[16:19], s51 offen lds
    s_add_u32 m0, s58, 10240
    s_add_u32 s51, s70, 68608
    buffer_load_dwordx4 v6, s[16:19], s51 offen lds
    s_add_u32 m0, s58, 11264
    s_add_u32 s51, s70, 101376
    buffer_load_dwordx4 v7, s[16:19], s51 offen lds
    s_add_u32 s58, s58, 18432
    s_cmp_eq_u32 s58, 55296
    s_cselect_b32 s58, 0, s58
    s_mul_i32 s51, s65, 1
    s_add_u32 m0, s59, 8192
    s_add_u32 s51, s51, s64
    buffer_load_dwordx4 v3, s[8:11], s51 offen  lds
    s_add_u32 m0, s59, 9216
    s_add_u32 s51, s51, s66
    buffer_load_dwordx4 v4, s[8:11], s51 offen  lds
    s_add_u32 m0, s59, 10240
    s_add_u32 s51, s51, s66
    buffer_load_dwordx4 v3, s[8:11], s51 offen  lds
    s_add_u32 m0, s59, 11264
    s_add_u32 s51, s51, s66
    buffer_load_dwordx4 v4, s[8:11], s51 offen  lds
    s_add_u32 m0, s59, 12288
    s_add_u32 s51, s51, s66
    buffer_load_dwordx4 v3, s[8:11], s51 offen  lds
    s_add_u32 m0, s59, 13312
    s_add_u32 s51, s51, s66
    buffer_load_dwordx4 v4, s[8:11], s51 offen  lds
    s_add_u32 m0, s59, 14336
    s_add_u32 s51, s51, s66
    buffer_load_dwordx4 v3, s[8:11], s51 offen  lds
    s_add_u32 m0, s59, 15360
    s_add_u32 s51, s51, s66
    buffer_load_dwordx4 v4, s[8:11], s51 offen  lds
    s_add_u32 s59, s59, 24576
    s_cmp_eq_u32 s59, 153600
    s_cselect_b32 s59, 55296, s59
    s_waitcnt vmcnt(22)
    s_barrier
    s_add_u32 m0, s58, 6144
    s_add_u32 s51, s70, 196736
    buffer_load_dwordx4 v6, s[16:19], s51 offen lds
    s_add_u32 m0, s58, 7168
    s_add_u32 s51, s70, 229504
    buffer_load_dwordx4 v7, s[16:19], s51 offen lds
    s_add_u32 m0, s58, 8192
    s_add_u32 s51, s70, 2176
    buffer_load_dwordx4 v6, s[16:19], s51 offen lds
    s_add_u32 m0, s58, 9216
    s_add_u32 s51, s70, 34944
    buffer_load_dwordx4 v7, s[16:19], s51 offen lds
    s_add_u32 m0, s58, 10240
    s_add_u32 s51, s70, 67712
    buffer_load_dwordx4 v6, s[16:19], s51 offen lds
    s_add_u32 m0, s58, 11264
    s_add_u32 s51, s70, 100480
    buffer_load_dwordx4 v7, s[16:19], s51 offen lds
    s_add_u32 s58, s58, 18432
    s_cmp_eq_u32 s58, 55296
    s_cselect_b32 s58, 0, s58
    s_mul_i32 s51, s65, 9
    s_add_u32 m0, s59, 8192
    s_add_u32 s51, s51, s64
    buffer_load_dwordx4 v3, s[8:11], s51 offen  lds
    s_add_u32 m0, s59, 9216
    s_add_u32 s51, s51, s66
    buffer_load_dwordx4 v4, s[8:11], s51 offen  lds
    s_add_u32 m0, s59, 10240
    s_add_u32 s51, s51, s66
    buffer_load_dwordx4 v3, s[8:11], s51 offen  lds
    s_add_u32 m0, s59, 11264
    s_add_u32 s51, s51, s66
    buffer_load_dwordx4 v4, s[8:11], s51 offen  lds
    s_add_u32 m0, s59, 12288
    s_add_u32 s51, s51, s66
    buffer_load_dwordx4 v3, s[8:11], s51 offen  lds
    s_add_u32 m0, s59, 13312
    s_add_u32 s51, s51, s66
    buffer_load_dwordx4 v4, s[8:11], s51 offen  lds
    s_add_u32 m0, s59, 14336
    s_add_u32 s51, s51, s66
    buffer_load_dwordx4 v3, s[8:11], s51 offen  lds
    s_add_u32 m0, s59, 15360
    s_add_u32 s51, s51, s66
    buffer_load_dwordx4 v4, s[8:11], s51 offen  lds
    s_add_u32 s59, s59, 24576
    s_cmp_eq_u32 s59, 153600
    s_cselect_b32 s59, 55296, s59
    s_waitcnt vmcnt(22)
    s_barrier
    s_add_u32 m0, s58, 6144
    s_add_u32 s51, s70, 197760
    buffer_load_dwordx4 v6, s[16:19], s51 offen lds
    s_add_u32 m0, s58, 7168
    s_add_u32 s51, s70, 230528
    buffer_load_dwordx4 v7, s[16:19], s51 offen lds
    s_add_u32 m0, s58, 8192
    s_add_u32 s51, s70, 3200
    buffer_load_dwordx4 v6, s[16:19], s51 offen lds
    s_add_u32 m0, s58, 9216
    s_add_u32 s51, s70, 35968
    buffer_load_dwordx4 v7, s[16:19], s51 offen lds
    s_add_u32 m0, s58, 10240
    s_add_u32 s51, s70, 68736
    buffer_load_dwordx4 v6, s[16:19], s51 offen lds
    s_add_u32 m0, s58, 11264
    s_add_u32 s51, s70, 101504
    buffer_load_dwordx4 v7, s[16:19], s51 offen lds
    s_add_u32 s58, s58, 18432
    s_cmp_eq_u32 s58, 55296
    s_cselect_b32 s58, 0, s58
    s_mul_i32 s51, s65, 2
    s_add_u32 m0, s59, 8192
    s_add_u32 s51, s51, s64
    buffer_load_dwordx4 v3, s[8:11], s51 offen  lds
    s_add_u32 m0, s59, 9216
    s_add_u32 s51, s51, s66
    buffer_load_dwordx4 v4, s[8:11], s51 offen  lds
    s_add_u32 m0, s59, 10240
    s_add_u32 s51, s51, s66
    buffer_load_dwordx4 v3, s[8:11], s51 offen  lds
    s_add_u32 m0, s59, 11264
    s_add_u32 s51, s51, s66
    buffer_load_dwordx4 v4, s[8:11], s51 offen  lds
    s_add_u32 m0, s59, 12288
    s_add_u32 s51, s51, s66
    buffer_load_dwordx4 v3, s[8:11], s51 offen  lds
    s_add_u32 m0, s59, 13312
    s_add_u32 s51, s51, s66
    buffer_load_dwordx4 v4, s[8:11], s51 offen  lds
    s_add_u32 m0, s59, 14336
    s_add_u32 s51, s51, s66
    buffer_load_dwordx4 v3, s[8:11], s51 offen  lds
    s_add_u32 m0, s59, 15360
    s_add_u32 s51, s51, s66
    buffer_load_dwordx4 v4, s[8:11], s51 offen  lds
    s_add_u32 s59, s59, 24576
    s_cmp_eq_u32 s59, 153600
    s_cselect_b32 s59, 55296, s59
    s_waitcnt vmcnt(22)
    s_barrier
    s_add_u32 m0, s58, 6144
    s_add_u32 s51, s70, 196864
    buffer_load_dwordx4 v6, s[16:19], s51 offen lds
    s_add_u32 m0, s58, 7168
    s_add_u32 s51, s70, 229632
    buffer_load_dwordx4 v7, s[16:19], s51 offen lds
    s_add_u32 m0, s58, 8192
    s_add_u32 s51, s70, 2304
    buffer_load_dwordx4 v6, s[16:19], s51 offen lds
    s_add_u32 m0, s58, 9216
    s_add_u32 s51, s70, 35072
    buffer_load_dwordx4 v7, s[16:19], s51 offen lds
    s_add_u32 m0, s58, 10240
    s_add_u32 s51, s70, 67840
    buffer_load_dwordx4 v6, s[16:19], s51 offen lds
    s_add_u32 m0, s58, 11264
    s_add_u32 s51, s70, 100608
    buffer_load_dwordx4 v7, s[16:19], s51 offen lds
    s_add_u32 s58, s58, 18432
    s_cmp_eq_u32 s58, 55296
    s_cselect_b32 s58, 0, s58
    s_mul_i32 s51, s65, 10
    s_add_u32 m0, s59, 8192
    s_add_u32 s51, s51, s64
    buffer_load_dwordx4 v3, s[8:11], s51 offen  lds
    s_add_u32 m0, s59, 9216
    s_add_u32 s51, s51, s66
    buffer_load_dwordx4 v4, s[8:11], s51 offen  lds
    s_add_u32 m0, s59, 10240
    s_add_u32 s51, s51, s66
    buffer_load_dwordx4 v3, s[8:11], s51 offen  lds
    s_add_u32 m0, s59, 11264
    s_add_u32 s51, s51, s66
    buffer_load_dwordx4 v4, s[8:11], s51 offen  lds
    s_add_u32 m0, s59, 12288
    s_add_u32 s51, s51, s66
    buffer_load_dwordx4 v3, s[8:11], s51 offen  lds
    s_add_u32 m0, s59, 13312
    s_add_u32 s51, s51, s66
    buffer_load_dwordx4 v4, s[8:11], s51 offen  lds
    s_add_u32 m0, s59, 14336
    s_add_u32 s51, s51, s66
    buffer_load_dwordx4 v3, s[8:11], s51 offen  lds
    s_add_u32 m0, s59, 15360
    s_add_u32 s51, s51, s66
    buffer_load_dwordx4 v4, s[8:11], s51 offen  lds
    s_add_u32 s59, s59, 24576
    s_cmp_eq_u32 s59, 153600
    s_cselect_b32 s59, 55296, s59
    s_waitcnt vmcnt(22)
    s_barrier
    s_add_u32 m0, s58, 6144
    s_add_u32 s51, s70, 197888
    buffer_load_dwordx4 v6, s[16:19], s51 offen lds
    s_add_u32 m0, s58, 7168
    s_add_u32 s51, s70, 230656
    buffer_load_dwordx4 v7, s[16:19], s51 offen lds
    s_add_u32 m0, s58, 8192
    s_add_u32 s51, s70, 3328
    buffer_load_dwordx4 v6, s[16:19], s51 offen lds
    s_add_u32 m0, s58, 9216
    s_add_u32 s51, s70, 36096
    buffer_load_dwordx4 v7, s[16:19], s51 offen lds
    s_add_u32 m0, s58, 10240
    s_add_u32 s51, s70, 68864
    buffer_load_dwordx4 v6, s[16:19], s51 offen lds
    s_add_u32 m0, s58, 11264
    s_add_u32 s51, s70, 101632
    buffer_load_dwordx4 v7, s[16:19], s51 offen lds
    s_add_u32 s58, s58, 18432
    s_cmp_eq_u32 s58, 55296
    s_cselect_b32 s58, 0, s58
    s_mul_i32 s51, s65, 3
    s_add_u32 m0, s59, 8192
    s_add_u32 s51, s51, s64
    buffer_load_dwordx4 v3, s[8:11], s51 offen  lds
    s_add_u32 m0, s59, 9216
    s_add_u32 s51, s51, s66
    buffer_load_dwordx4 v4, s[8:11], s51 offen  lds
    s_add_u32 m0, s59, 10240
    s_add_u32 s51, s51, s66
    buffer_load_dwordx4 v3, s[8:11], s51 offen  lds
    s_add_u32 m0, s59, 11264
    s_add_u32 s51, s51, s66
    buffer_load_dwordx4 v4, s[8:11], s51 offen  lds
    s_add_u32 m0, s59, 12288
    s_add_u32 s51, s51, s66
    buffer_load_dwordx4 v3, s[8:11], s51 offen  lds
    s_add_u32 m0, s59, 13312
    s_add_u32 s51, s51, s66
    buffer_load_dwordx4 v4, s[8:11], s51 offen  lds
    s_add_u32 m0, s59, 14336
    s_add_u32 s51, s51, s66
    buffer_load_dwordx4 v3, s[8:11], s51 offen  lds
    s_add_u32 m0, s59, 15360
    s_add_u32 s51, s51, s66
    buffer_load_dwordx4 v4, s[8:11], s51 offen  lds
    s_add_u32 s59, s59, 24576
    s_cmp_eq_u32 s59, 153600
    s_cselect_b32 s59, 55296, s59
    s_waitcnt vmcnt(22)
    s_barrier
    s_add_u32 m0, s58, 6144
    s_add_u32 s51, s70, 196992
    buffer_load_dwordx4 v6, s[16:19], s51 offen lds
    s_add_u32 m0, s58, 7168
    s_add_u32 s51, s70, 229760
    buffer_load_dwordx4 v7, s[16:19], s51 offen lds
    s_add_u32 m0, s58, 8192
    s_add_u32 s51, s70, 2432
    buffer_load_dwordx4 v6, s[16:19], s51 offen lds
    s_add_u32 m0, s58, 9216
    s_add_u32 s51, s70, 35200
    buffer_load_dwordx4 v7, s[16:19], s51 offen lds
    s_add_u32 m0, s58, 10240
    s_add_u32 s51, s70, 67968
    buffer_load_dwordx4 v6, s[16:19], s51 offen lds
    s_add_u32 m0, s58, 11264
    s_add_u32 s51, s70, 100736
    buffer_load_dwordx4 v7, s[16:19], s51 offen lds
    s_add_u32 s58, s58, 18432
    s_cmp_eq_u32 s58, 55296
    s_cselect_b32 s58, 0, s58
    s_mul_i32 s51, s65, 11
    s_add_u32 m0, s59, 8192
    s_add_u32 s51, s51, s64
    buffer_load_dwordx4 v3, s[8:11], s51 offen  lds
    s_add_u32 m0, s59, 9216
    s_add_u32 s51, s51, s66
    buffer_load_dwordx4 v4, s[8:11], s51 offen  lds
    s_add_u32 m0, s59, 10240
    s_add_u32 s51, s51, s66
    buffer_load_dwordx4 v3, s[8:11], s51 offen  lds
    s_add_u32 m0, s59, 11264
    s_add_u32 s51, s51, s66
    buffer_load_dwordx4 v4, s[8:11], s51 offen  lds
    s_add_u32 m0, s59, 12288
    s_add_u32 s51, s51, s66
    buffer_load_dwordx4 v3, s[8:11], s51 offen  lds
    s_add_u32 m0, s59, 13312
    s_add_u32 s51, s51, s66
    buffer_load_dwordx4 v4, s[8:11], s51 offen  lds
    s_add_u32 m0, s59, 14336
    s_add_u32 s51, s51, s66
    buffer_load_dwordx4 v3, s[8:11], s51 offen  lds
    s_add_u32 m0, s59, 15360
    s_add_u32 s51, s51, s66
    buffer_load_dwordx4 v4, s[8:11], s51 offen  lds
    s_add_u32 s59, s59, 24576
    s_cmp_eq_u32 s59, 153600
    s_cselect_b32 s59, 55296, s59
    s_waitcnt vmcnt(22)
    s_barrier
    s_add_u32 m0, s58, 6144
    s_add_u32 s51, s70, 198016
    buffer_load_dwordx4 v6, s[16:19], s51 offen lds
    s_add_u32 m0, s58, 7168
    s_add_u32 s51, s70, 230784
    buffer_load_dwordx4 v7, s[16:19], s51 offen lds
    s_add_u32 m0, s58, 8192
    s_add_u32 s51, s70, 3456
    buffer_load_dwordx4 v6, s[16:19], s51 offen lds
    s_add_u32 m0, s58, 9216
    s_add_u32 s51, s70, 36224
    buffer_load_dwordx4 v7, s[16:19], s51 offen lds
    s_add_u32 m0, s58, 10240
    s_add_u32 s51, s70, 68992
    buffer_load_dwordx4 v6, s[16:19], s51 offen lds
    s_add_u32 m0, s58, 11264
    s_add_u32 s51, s70, 101760
    buffer_load_dwordx4 v7, s[16:19], s51 offen lds
    s_add_u32 s58, s58, 18432
    s_cmp_eq_u32 s58, 55296
    s_cselect_b32 s58, 0, s58
    s_mov_b32 m0, 63488
    s_lshl_b32 s51, 62, s77
    buffer_load_dwordx4 v16, s[12:15], s51 offen  lds
    s_mov_b32 m0, 64512
    s_lshl_b32 s51, 63, s77
    buffer_load_dwordx4 v17, s[12:15], s51 offen  lds
    s_mov_b32 m0, 65536
    s_lshl_b32 s51, 64, s77
    buffer_load_dwordx4 v16, s[12:15], s51 offen  lds
    s_mov_b32 m0, 66560
    s_lshl_b32 s51, 65, s77
    buffer_load_dwordx4 v17, s[12:15], s51 offen  lds
    s_mov_b32 m0, 67584
    s_lshl_b32 s51, 66, s77
    buffer_load_dwordx4 v16, s[12:15], s51 offen  lds
    s_mov_b32 m0, 68608
    s_lshl_b32 s51, 67, s77
    buffer_load_dwordx4 v17, s[12:15], s51 offen  lds
    s_mov_b32 m0, 69632
    s_lshl_b32 s51, 68, s77
    buffer_load_dwordx4 v16, s[12:15], s51 offen  lds
    s_mov_b32 m0, 70656
    s_lshl_b32 s51, 69, s77
    buffer_load_dwordx4 v17, s[12:15], s51 offen  lds
    s_waitcnt vmcnt(22)
    s_barrier
    s_mov_b32 m0, 32768
    s_lshl_b32 s51, 32, s77
    buffer_load_dwordx4 v16, s[12:15], s51 offen  lds
    s_mov_b32 m0, 33792
    s_lshl_b32 s51, 33, s77
    buffer_load_dwordx4 v17, s[12:15], s51 offen  lds
    s_mov_b32 m0, 34816
    s_lshl_b32 s51, 34, s77
    buffer_load_dwordx4 v16, s[12:15], s51 offen  lds
    s_mov_b32 m0, 35840
    s_lshl_b32 s51, 35, s77
    buffer_load_dwordx4 v17, s[12:15], s51 offen  lds
    s_mov_b32 m0, 79872
    s_lshl_b32 s51, 78, s77
    buffer_load_dwordx4 v16, s[12:15], s51 offen  lds
    s_mov_b32 m0, 80896
    s_lshl_b32 s51, 79, s77
    buffer_load_dwordx4 v17, s[12:15], s51 offen  lds
    s_mov_b32 m0, 81920
    s_lshl_b32 s51, 80, s77
    buffer_load_dwordx4 v16, s[12:15], s51 offen  lds
    s_mov_b32 m0, 82944
    s_lshl_b32 s51, 81, s77
    buffer_load_dwordx4 v17, s[12:15], s51 offen  lds
    s_mov_b32 m0, 83968
    s_lshl_b32 s51, 82, s77
    buffer_load_dwordx4 v16, s[12:15], s51 offen  lds
    s_mov_b32 m0, 84992
    s_lshl_b32 s51, 83, s77
    buffer_load_dwordx4 v17, s[12:15], s51 offen  lds
    s_mov_b32 m0, 86016
    s_lshl_b32 s51, 84, s77
    buffer_load_dwordx4 v16, s[12:15], s51 offen  lds
    s_mov_b32 m0, 87040
    s_lshl_b32 s51, 85, s77
    buffer_load_dwordx4 v17, s[12:15], s51 offen  lds
    s_mov_b32 m0, 88064
    s_lshl_b32 s51, 86, s77
    buffer_load_dwordx4 v16, s[12:15], s51 offen  lds
    s_mov_b32 m0, 89088
    s_lshl_b32 s51, 87, s77
    buffer_load_dwordx4 v17, s[12:15], s51 offen  lds
    s_waitcnt vmcnt(22)
    s_barrier
    s_mov_b32 m0, 51200
    s_lshl_b32 s51, 50, s77
    buffer_load_dwordx4 v16, s[12:15], s51 offen  lds
    s_mov_b32 m0, 52224
    s_lshl_b32 s51, 51, s77
    buffer_load_dwordx4 v17, s[12:15], s51 offen  lds
    s_mov_b32 m0, 53248
    s_lshl_b32 s51, 52, s77
    buffer_load_dwordx4 v16, s[12:15], s51 offen  lds
    s_mov_b32 m0, 54272
    s_lshl_b32 s51, 53, s77
    buffer_load_dwordx4 v17, s[12:15], s51 offen  lds
    s_mov_b32 m0, 104448
    s_lshl_b32 s51, 102, s77
    buffer_load_dwordx4 v16, s[12:15], s51 offen  lds
    s_mov_b32 m0, 105472
    s_lshl_b32 s51, 103, s77
    buffer_load_dwordx4 v17, s[12:15], s51 offen  lds
    s_mov_b32 m0, 106496
    s_lshl_b32 s51, 104, s77
    buffer_load_dwordx4 v16, s[12:15], s51 offen  lds
    s_mov_b32 m0, 107520
    s_lshl_b32 s51, 105, s77
    buffer_load_dwordx4 v17, s[12:15], s51 offen  lds
    s_mov_b32 m0, 108544
    s_lshl_b32 s51, 106, s77
    buffer_load_dwordx4 v16, s[12:15], s51 offen  lds
    s_mov_b32 m0, 109568
    s_lshl_b32 s51, 107, s77
    buffer_load_dwordx4 v17, s[12:15], s51 offen  lds
    s_mov_b32 m0, 110592
    s_lshl_b32 s51, 108, s77
    buffer_load_dwordx4 v16, s[12:15], s51 offen  lds
    s_mov_b32 m0, 111616
    s_lshl_b32 s51, 109, s77
    buffer_load_dwordx4 v17, s[12:15], s51 offen  lds
    s_mov_b32 m0, 112640
    s_lshl_b32 s51, 110, s77
    buffer_load_dwordx4 v16, s[12:15], s51 offen  lds
    s_mov_b32 m0, 113664
    s_lshl_b32 s51, 111, s77
    buffer_load_dwordx4 v17, s[12:15], s51 offen  lds
    s_barrier
    s_mov_b32 m0, 6144
    s_lshl_b32 s51, 6, s77
    buffer_load_dwordx4 v16, s[12:15], s51 offen  lds
    s_mov_b32 m0, 7168
    s_lshl_b32 s51, 7, s77
    buffer_load_dwordx4 v17, s[12:15], s51 offen  lds
    s_mov_b32 m0, 8192
    s_lshl_b32 s51, 8, s77
    buffer_load_dwordx4 v16, s[12:15], s51 offen  lds
    s_mov_b32 m0, 9216
    s_lshl_b32 s51, 9, s77
    buffer_load_dwordx4 v17, s[12:15], s51 offen  lds
    s_mov_b32 m0, 10240
    s_lshl_b32 s51, 10, s77
    buffer_load_dwordx4 v16, s[12:15], s51 offen  lds
    s_mov_b32 m0, 11264
    s_lshl_b32 s51, 11, s77
    buffer_load_dwordx4 v17, s[12:15], s51 offen  lds
    s_mov_b32 m0, 12288
    s_lshl_b32 s51, 12, s77
    buffer_load_dwordx4 v16, s[12:15], s51 offen  lds
    s_branch prod_tail_w1
prod_layer_w1:
    s_lshl_b32 s45, s42, 22
    s_lshl_b32 s49, s36, 18
    s_add_u32 s70, s45, s49
    s_sub_u32 s48, s36, 1
    s_max_i32 s48, s48, 0
    s_lshl_b32 s49, s48, 18
    s_add_u32 s71, s45, s49
    s_mov_b32 s58, 0
    s_barrier
    s_mov_b32 s58, 18432
    s_bfe_u32 s79, s80, 0x40004
    s_lshl_b32 s79, s79, 14
    s_add_u32 s79, s79, s70
    s_add_u32 m0, s58, 6144
    s_add_u32 s51, s79, 6144
    buffer_load_dwordx4 v1, s[4:7], s51 offen offset:0 sc1 lds
    buffer_load_dwordx4 v1, s[4:7], s51 offen offset:1024 sc1 lds
    buffer_load_dwordx4 v1, s[4:7], s51 offen offset:2048 sc1 lds
    buffer_load_dwordx4 v1, s[4:7], s51 offen offset:3072 sc1 lds
    s_add_u32 m0, s58, 10240
    s_add_u32 s51, s79, 10240
    buffer_load_dwordx4 v1, s[4:7], s51 offen offset:0 sc1 lds
    buffer_load_dwordx4 v1, s[4:7], s51 offen offset:1024 sc1 lds
    s_add_u32 s58, s58, 18432
    s_cmp_eq_u32 s58, 55296
    s_cselect_b32 s58, 0, s58
    s_bfe_u32 s79, s80, 0x40008
    s_lshl_b32 s79, s79, 14
    s_add_u32 s79, s79, s70
    s_add_u32 m0, s58, 6144
    s_add_u32 s51, s79, 6144
    buffer_load_dwordx4 v1, s[4:7], s51 offen offset:0 sc1 lds
    buffer_load_dwordx4 v1, s[4:7], s51 offen offset:1024 sc1 lds
    buffer_load_dwordx4 v1, s[4:7], s51 offen offset:2048 sc1 lds
    buffer_load_dwordx4 v1, s[4:7], s51 offen offset:3072 sc1 lds
    s_add_u32 m0, s58, 10240
    s_add_u32 s51, s79, 10240
    buffer_load_dwordx4 v1, s[4:7], s51 offen offset:0 sc1 lds
    buffer_load_dwordx4 v1, s[4:7], s51 offen offset:1024 sc1 lds
    s_add_u32 s58, s58, 18432
    s_cmp_eq_u32 s58, 55296
    s_cselect_b32 s58, 0, s58
    s_waitcnt vmcnt(36)
    s_barrier
    s_bitcmp1_b32 s42, 0
    s_cselect_b32 s12, s34, s32
    s_cselect_b32 s13, s35, s33
    s_cmp_eq_u32 s67, 0
    s_cbranch_scc1 wo_notslow_25
    s_mov_b32 s12, s4
    s_mov_b32 s13, s5
    s_mov_b32 s14, s6
    s_and_b32 s75, s42, 1
    s_lshl_b32 s75, s75, 21
    s_lshl_b32 s49, s39, 17
    s_add_u32 s75, s75, s49
    s_add_u32 s75, s75, 54525952
    v_add_u32 v16, s75, v1
    v_mov_b32 v17, v16
    s_mov_b32 s77, 10
wo_notslow_25:
    s_waitcnt vmcnt(6)
    s_mov_b32 s63, 0
tchk_26:
    ds_read_b128 v[32:35], v1 offset:24576
    ds_read_b128 v[36:39], v1 offset:25600
    ds_read_b128 v[40:43], v1 offset:26624
    ds_read_b128 v[44:47], v1 offset:27648
    ds_read_b128 v[48:51], v1 offset:28672
    ds_read_b128 v[52:55], v1 offset:29696
    s_waitcnt lgkmcnt(0)
    v_max3_u32 v30, v32, v33, v34
    v_max3_u32 v31, v44, v45, v46
    v_max3_u32 v30, v30, v35, v36
    v_max3_u32 v31, v31, v47, v48
    v_max3_u32 v30, v30, v37, v38
    v_max3_u32 v31, v31, v49, v50
    v_max3_u32 v30, v30, v39, v40
    v_max3_u32 v31, v31, v51, v52
    v_max3_u32 v30, v30, v41, v42
    v_max3_u32 v31, v31, v53, v54
    v_max_u32 v30, v30, v43
    v_max_u32 v31, v31, v55
    v_max_u32 v30, v30, v31
    v_cmp_eq_u32 vcc, -1, v30
    s_cbranch_vccz tchk_ok_27
    s_bfe_u32 s79, s80, 0x40004
    s_lshl_b32 s79, s79, 14
    s_add_u32 s79, s79, s70
    s_mov_b32 m0, 24576
    s_add_u32 s51, s79, 6144
    buffer_load_dwordx4 v1, s[4:7], s51 offen offset:0 sc1 lds
    buffer_load_dwordx4 v1, s[4:7], s51 offen offset:1024 sc1 lds
    buffer_load_dwordx4 v1, s[4:7], s51 offen offset:2048 sc1 lds
    buffer_load_dwordx4 v1, s[4:7], s51 offen offset:3072 sc1 lds
    s_mov_b32 m0, 28672
    s_add_u32 s51, s79, 10240
    buffer_load_dwordx4 v1, s[4:7], s51 offen offset:0 sc1 lds
    buffer_load_dwordx4 v1, s[4:7], s51 offen offset:1024 sc1 lds
    s_waitcnt vmcnt(0)
    s_add_u32 s63, s63, 1
    s_cmp_lt_u32 s63, 20000
    s_cbranch_scc1 tchk_26
    v_mov_b32 v30, 0x110
    s_mov_b32 s63, 16
    buffer_store_dword v30, off, s[24:27], s63
    s_waitcnt vmcnt(0)
tchk_ok_27:
    s_barrier
    s_bfe_u32 s79, s80, 0x4000c
    s_lshl_b32 s79, s79, 14
    s_add_u32 s79, s79, s70
    s_add_u32 m0, s58, 6144
    s_add_u32 s51, s79, 6144
    buffer_load_dwordx4 v1, s[4:7], s51 offen offset:0 sc1 lds
    buffer_load_dwordx4 v1, s[4:7], s51 offen offset:1024 sc1 lds
    buffer_load_dwordx4 v1, s[4:7], s51 offen offset:2048 sc1 lds
    buffer_load_dwordx4 v1, s[4:7], s51 offen offset:3072 sc1 lds
    s_add_u32 m0, s58, 10240
    s_add_u32 s51, s79, 10240
    buffer_load_dwordx4 v1, s[4:7], s51 offen offset:0 sc1 lds
    buffer_load_dwordx4 v1, s[4:7], s51 offen offset:1024 sc1 lds
    s_add_u32 s58, s58, 18432
    s_cmp_eq_u32 s58, 55296
    s_cselect_b32 s58, 0, s58
    s_waitcnt vmcnt(6)
    s_mov_b32 s63, 0
    ds_read_b128 v[32:35], v1 offset:43008
    ds_read_b128 v[36:39], v1 offset:44032
    ds_read_b128 v[40:43], v1 offset:45056
    ds_read_b128 v[44:47], v1 offset:46080
    ds_read_b128 v[48:51], v1 offset:47104
    ds_read_b128 v[52:55], v1 offset:48128
    s_bfe_u32 s51, s80, 0x40010
    s_mul_i32 s51, s51, s65
    s_add_u32 m0, s59, 8192
    s_add_u32 s51, s51, s64
    buffer_load_dwordx4 v3, s[8:11], s51 offen  lds
    s_add_u32 m0, s59, 9216
    s_add_u32 s51, s51, s66
    buffer_load_dwordx4 v4, s[8:11], s51 offen  lds
    s_add_u32 m0, s59, 10240
    s_add_u32 s51, s51, s66
    buffer_load_dwordx4 v3, s[8:11], s51 offen  lds
    s_add_u32 m0, s59, 11264
    s_add_u32 s51, s51, s66
    buffer_load_dwordx4 v4, s[8:11], s51 offen  lds
    s_add_u32 m0, s59, 12288
    s_add_u32 s51, s51, s66
    buffer_load_dwordx4 v3, s[8:11], s51 offen  lds
    s_add_u32 m0, s59, 13312
    s_add_u32 s51, s51, s66
    buffer_load_dwordx4 v4, s[8:11], s51 offen  lds
    s_add_u32 m0, s59, 14336
    s_add_u32 s51, s51, s66
    buffer_load_dwordx4 v3, s[8:11], s51 offen  lds
    s_add_u32 m0, s59, 15360
    s_add_u32 s51, s51, s66
    buffer_load_dwordx4 v4, s[8:11], s51 offen  lds
    s_add_u32 s59, s59, 24576
    s_cmp_eq_u32 s59, 153600
    s_cselect_b32 s59, 55296, s59
tchk_28:
    s_waitcnt lgkmcnt(0)
    v_max3_u32 v30, v32, v33, v34
    v_max3_u32 v31, v44, v45, v46
    v_max3_u32 v30, v30, v35, v36
    v_max3_u32 v31, v31, v47, v48
    v_max3_u32 v30, v30, v37, v38
    v_max3_u32 v31, v31, v49, v50
    v_max3_u32 v30, v30, v39, v40
    v_max3_u32 v31, v31, v51, v52
    v_max3_u32 v30, v30, v41, v42
    v_max3_u32 v31, v31, v53, v54
    v_max_u32 v30, v30, v43
    v_max_u32 v31, v31, v55
    v_max_u32 v30, v30, v31
    v_cmp_eq_u32 vcc, -1, v30
    s_cbranch_vccz tchk_ok_29
    s_bfe_u32 s79, s80, 0x40008
    s_lshl_b32 s79, s79, 14
    s_add_u32 s79, s79, s70
    s_mov_b32 m0, 43008
    s_add_u32 s51, s79, 6144
    buffer_load_dwordx4 v1, s[4:7], s51 offen offset:0 sc1 lds
    buffer_load_dwordx4 v1, s[4:7], s51 offen offset:1024 sc1 lds
    buffer_load_dwordx4 v1, s[4:7], s51 offen offset:2048 sc1 lds
    buffer_load_dwordx4 v1, s[4:7], s51 offen offset:3072 sc1 lds
    s_mov_b32 m0, 47104
    s_add_u32 s51, s79, 10240
    buffer_load_dwordx4 v1, s[4:7], s51 offen offset:0 sc1 lds
    buffer_load_dwordx4 v1, s[4:7], s51 offen offset:1024 sc1 lds
    s_waitcnt vmcnt(0)
    ds_read_b128 v[32:35], v1 offset:43008
    ds_read_b128 v[36:39], v1 offset:44032
    ds_read_b128 v[40:43], v1 offset:45056
    ds_read_b128 v[44:47], v1 offset:46080
    ds_read_b128 v[48:51], v1 offset:47104
    ds_read_b128 v[52:55], v1 offset:48128
    s_add_u32 s63, s63, 1
    s_cmp_lt_u32 s63, 20000
    s_cbranch_scc1 tchk_28
    v_mov_b32 v30, 0x110
    s_mov_b32 s63, 16
    buffer_store_dword v30, off, s[24:27], s63
    s_waitcnt vmcnt(0)
tchk_ok_29:
    s_barrier
    s_bfe_u32 s79, s80, 0x40010
    s_lshl_b32 s79, s79, 14
    s_add_u32 s79, s79, s70
    s_add_u32 m0, s58, 6144
    s_add_u32 s51, s79, 6144
    buffer_load_dwordx4 v1, s[4:7], s51 offen offset:0 sc1 lds
    buffer_load_dwordx4 v1, s[4:7], s51 offen offset:1024 sc1 lds
    buffer_load_dwordx4 v1, s[4:7], s51 offen offset:2048 sc1 lds
    buffer_load_dwordx4 v1, s[4:7], s51 offen offset:3072 sc1 lds
    s_add_u32 m0, s58, 10240
    s_add_u32 s51, s79, 10240
    buffer_load_dwordx4 v1, s[4:7], s51 offen offset:0 sc1 lds
    buffer_load_dwordx4 v1, s[4:7], s51 offen offset:1024 sc1 lds
    s_add_u32 s58, s58, 18432
    s_cmp_eq_u32 s58, 55296
    s_cselect_b32 s58, 0, s58
    s_waitcnt vmcnt(14)
    s_mov_b32 s63, 0
    ds_read_b128 v[32:35], v1 offset:6144
    ds_read_b128 v[36:39], v1 offset:7168
    ds_read_b128 v[40:43], v1 offset:8192
    ds_read_b128 v[44:47], v1 offset:9216
    ds_read_b128 v[48:51], v1 offset:10240
    ds_read_b128 v[52:55], v1 offset:11264
    s_bfe_u32 s51, s80, 0x40014
    s_mul_i32 s51, s51, s65
    s_add_u32 m0, s59, 8192
    s_add_u32 s51, s51, s64
    buffer_load_dwordx4 v3, s[8:11], s51 offen  lds
    s_add_u32 m0, s59, 9216
    s_add_u32 s51, s51, s66
    buffer_load_dwordx4 v4, s[8:11], s51 offen  lds
    s_add_u32 m0, s59, 10240
    s_add_u32 s51, s51, s66
    buffer_load_dwordx4 v3, s[8:11], s51 offen  lds
    s_add_u32 m0, s59, 11264
    s_add_u32 s51, s51, s66
    buffer_load_dwordx4 v4, s[8:11], s51 offen  lds
    s_add_u32 m0, s59, 12288
    s_add_u32 s51, s51, s66
    buffer_load_dwordx4 v3, s[8:11], s51 offen  lds
    s_add_u32 m0, s59, 13312
    s_add_u32 s51, s51, s66
    buffer_load_dwordx4 v4, s[8:11], s51 offen  lds
    s_add_u32 m0, s59, 14336
    s_add_u32 s51, s51, s66
    buffer_load_dwordx4 v3, s[8:11], s51 offen  lds
    s_add_u32 m0, s59, 15360
    s_add_u32 s51, s51, s66
    buffer_load_dwordx4 v4, s[8:11], s51 offen  lds
    s_add_u32 s59, s59, 24576
    s_cmp_eq_u32 s59, 153600
    s_cselect_b32 s59, 55296, s59
tchk_30:
    s_waitcnt lgkmcnt(0)
    v_max3_u32 v30, v32, v33, v34
    v_max3_u32 v31, v44, v45, v46
    v_max3_u32 v30, v30, v35, v36
    v_max3_u32 v31, v31, v47, v48
    v_max3_u32 v30, v30, v37, v38
    v_max3_u32 v31, v31, v49, v50
    v_max3_u32 v30, v30, v39, v40
    v_max3_u32 v31, v31, v51, v52
    v_max3_u32 v30, v30, v41, v42
    v_max3_u32 v31, v31, v53, v54
    v_max_u32 v30, v30, v43
    v_max_u32 v31, v31, v55
    v_max_u32 v30, v30, v31
    v_cmp_eq_u32 vcc, -1, v30
    s_cbranch_vccz tchk_ok_31
    s_bfe_u32 s79, s80, 0x4000c
    s_lshl_b32 s79, s79, 14
    s_add_u32 s79, s79, s70
    s_mov_b32 m0, 6144
    s_add_u32 s51, s79, 6144
    buffer_load_dwordx4 v1, s[4:7], s51 offen offset:0 sc1 lds
    buffer_load_dwordx4 v1, s[4:7], s51 offen offset:1024 sc1 lds
    buffer_load_dwordx4 v1, s[4:7], s51 offen offset:2048 sc1 lds
    buffer_load_dwordx4 v1, s[4:7], s51 offen offset:3072 sc1 lds
    s_mov_b32 m0, 10240
    s_add_u32 s51, s79, 10240
    buffer_load_dwordx4 v1, s[4:7], s51 offen offset:0 sc1 lds
    buffer_load_dwordx4 v1, s[4:7], s51 offen offset:1024 sc1 lds
    s_waitcnt vmcnt(0)
    ds_read_b128 v[32:35], v1 offset:6144
    ds_read_b128 v[36:39], v1 offset:7168
    ds_read_b128 v[40:43], v1 offset:8192
    ds_read_b128 v[44:47], v1 offset:9216
    ds_read_b128 v[48:51], v1 offset:10240
    ds_read_b128 v[52:55], v1 offset:11264
    s_add_u32 s63, s63, 1
    s_cmp_lt_u32 s63, 20000
    s_cbranch_scc1 tchk_30
    v_mov_b32 v30, 0x110
    s_mov_b32 s63, 16
    buffer_store_dword v30, off, s[24:27], s63
    s_waitcnt vmcnt(0)
tchk_ok_31:
    s_barrier
    s_bfe_u32 s79, s80, 0x40014
    s_lshl_b32 s79, s79, 14
    s_add_u32 s79, s79, s70
    s_add_u32 m0, s58, 6144
    s_add_u32 s51, s79, 6144
    buffer_load_dwordx4 v1, s[4:7], s51 offen offset:0 sc1 lds
    buffer_load_dwordx4 v1, s[4:7], s51 offen offset:1024 sc1 lds
    buffer_load_dwordx4 v1, s[4:7], s51 offen offset:2048 sc1 lds
    buffer_load_dwordx4 v1, s[4:7], s51 offen offset:3072 sc1 lds
    s_add_u32 m0, s58, 10240
    s_add_u32 s51, s79, 10240
    buffer_load_dwordx4 v1, s[4:7], s51 offen offset:0 sc1 lds
    buffer_load_dwordx4 v1, s[4:7], s51 offen offset:1024 sc1 lds
    s_add_u32 s58, s58, 18432
    s_cmp_eq_u32 s58, 55296
    s_cselect_b32 s58, 0, s58
    s_bfe_u32 s51, s80, 0x40018
    s_mul_i32 s51, s51, s65
    s_add_u32 m0, s59, 8192
    s_add_u32 s51, s51, s64
    buffer_load_dwordx4 v3, s[8:11], s51 offen  lds
    s_add_u32 m0, s59, 9216
    s_add_u32 s51, s51, s66
    buffer_load_dwordx4 v4, s[8:11], s51 offen  lds
    s_add_u32 m0, s59, 10240
    s_add_u32 s51, s51, s66
    buffer_load_dwordx4 v3, s[8:11], s51 offen  lds
    s_add_u32 m0, s59, 11264
    s_add_u32 s51, s51, s66
    buffer_load_dwordx4 v4, s[8:11], s51 offen  lds
    s_add_u32 m0, s59, 12288
    s_add_u32 s51, s51, s66
    buffer_load_dwordx4 v3, s[8:11], s51 offen  lds
    s_add_u32 m0, s59, 13312
    s_add_u32 s51, s51, s66
    buffer_load_dwordx4 v4, s[8:11], s51 offen  lds
    s_add_u32 m0, s59, 14336
    s_add_u32 s51, s51, s66
    buffer_load_dwordx4 v3, s[8:11], s51 offen  lds
    s_add_u32 m0, s59, 15360
    s_add_u32 s51, s51, s66
    buffer_load_dwordx4 v4, s[8:11], s51 offen  lds
    s_add_u32 s59, s59, 24576
    s_cmp_eq_u32 s59, 153600
    s_cselect_b32 s59, 55296, s59
    s_waitcnt vmcnt(22)
    s_barrier
    s_bfe_u32 s79, s80, 0x40018
    s_lshl_b32 s79, s79, 14
    s_add_u32 s79, s79, s70
    s_add_u32 m0, s58, 6144
    s_add_u32 s51, s79, 6144
    buffer_load_dwordx4 v1, s[4:7], s51 offen offset:0 sc1 lds
    buffer_load_dwordx4 v1, s[4:7], s51 offen offset:1024 sc1 lds
    buffer_load_dwordx4 v1, s[4:7], s51 offen offset:2048 sc1 lds
    buffer_load_dwordx4 v1, s[4:7], s51 offen offset:3072 sc1 lds
    s_add_u32 m0, s58, 10240
    s_add_u32 s51, s79, 10240
    buffer_load_dwordx4 v1, s[4:7], s51 offen offset:0 sc1 lds
    buffer_load_dwordx4 v1, s[4:7], s51 offen offset:1024 sc1 lds
    s_add_u32 s58, s58, 18432
    s_cmp_eq_u32 s58, 55296
    s_cselect_b32 s58, 0, s58
    s_bfe_u32 s51, s80, 0x4001c
    s_mul_i32 s51, s51, s65
    s_add_u32 m0, s59, 8192
    s_add_u32 s51, s51, s64
    buffer_load_dwordx4 v3, s[8:11], s51 offen  lds
    s_add_u32 m0, s59, 9216
    s_add_u32 s51, s51, s66
    buffer_load_dwordx4 v4, s[8:11], s51 offen  lds
    s_add_u32 m0, s59, 10240
    s_add_u32 s51, s51, s66
    buffer_load_dwordx4 v3, s[8:11], s51 offen  lds
    s_add_u32 m0, s59, 11264
    s_add_u32 s51, s51, s66
    buffer_load_dwordx4 v4, s[8:11], s51 offen  lds
    s_add_u32 m0, s59, 12288
    s_add_u32 s51, s51, s66
    buffer_load_dwordx4 v3, s[8:11], s51 offen  lds
    s_add_u32 m0, s59, 13312
    s_add_u32 s51, s51, s66
    buffer_load_dwordx4 v4, s[8:11], s51 offen  lds
    s_add_u32 m0, s59, 14336
    s_add_u32 s51, s51, s66
    buffer_load_dwordx4 v3, s[8:11], s51 offen  lds
    s_add_u32 m0, s59, 15360
    s_add_u32 s51, s51, s66
    buffer_load_dwordx4 v4, s[8:11], s51 offen  lds
    s_add_u32 s59, s59, 24576
    s_cmp_eq_u32 s59, 153600
    s_cselect_b32 s59, 55296, s59
    s_waitcnt vmcnt(22)
    s_barrier
    s_bfe_u32 s79, s80, 0x4001c
    s_lshl_b32 s79, s79, 14
    s_add_u32 s79, s79, s70
    s_add_u32 m0, s58, 6144
    s_add_u32 s51, s79, 6144
    buffer_load_dwordx4 v1, s[4:7], s51 offen offset:0 sc1 lds
    buffer_load_dwordx4 v1, s[4:7], s51 offen offset:1024 sc1 lds
    buffer_load_dwordx4 v1, s[4:7], s51 offen offset:2048 sc1 lds
    buffer_load_dwordx4 v1, s[4:7], s51 offen offset:3072 sc1 lds
    s_add_u32 m0, s58, 10240
    s_add_u32 s51, s79, 10240
    buffer_load_dwordx4 v1, s[4:7], s51 offen offset:0 sc1 lds
    buffer_load_dwordx4 v1, s[4:7], s51 offen offset:1024 sc1 lds
    s_add_u32 s58, s58, 18432
    s_cmp_eq_u32 s58, 55296
    s_cselect_b32 s58, 0, s58
    s_bfe_u32 s51, s81, 0x40000
    s_mul_i32 s51, s51, s65
    s_add_u32 m0, s59, 8192
    s_add_u32 s51, s51, s64
    buffer_load_dwordx4 v3, s[8:11], s51 offen  lds
    s_add_u32 m0, s59, 9216
    s_add_u32 s51, s51, s66
    buffer_load_dwordx4 v4, s[8:11], s51 offen  lds
    s_add_u32 m0, s59, 10240
    s_add_u32 s51, s51, s66
    buffer_load_dwordx4 v3, s[8:11], s51 offen  lds
    s_add_u32 m0, s59, 11264
    s_add_u32 s51, s51, s66
    buffer_load_dwordx4 v4, s[8:11], s51 offen  lds
    s_add_u32 m0, s59, 12288
    s_add_u32 s51, s51, s66
    buffer_load_dwordx4 v3, s[8:11], s51 offen  lds
    s_add_u32 m0, s59, 13312
    s_add_u32 s51, s51, s66
    buffer_load_dwordx4 v4, s[8:11], s51 offen  lds
    s_add_u32 m0, s59, 14336
    s_add_u32 s51, s51, s66
    buffer_load_dwordx4 v3, s[8:11], s51 offen  lds
    s_add_u32 m0, s59, 15360
    s_add_u32 s51, s51, s66
    buffer_load_dwordx4 v4, s[8:11], s51 offen  lds
    s_add_u32 s59, s59, 24576
    s_cmp_eq_u32 s59, 153600
    s_cselect_b32 s59, 55296, s59
    s_waitcnt vmcnt(22)
    s_barrier
    s_bfe_u32 s79, s81, 0x40000
    s_lshl_b32 s79, s79, 14
    s_add_u32 s79, s79, s70
    s_add_u32 m0, s58, 6144
    s_add_u32 s51, s79, 6144
    buffer_load_dwordx4 v1, s[4:7], s51 offen offset:0 sc1 lds
    buffer_load_dwordx4 v1, s[4:7], s51 offen offset:1024 sc1 lds
    buffer_load_dwordx4 v1, s[4:7], s51 offen offset:2048 sc1 lds
    buffer_load_dwordx4 v1, s[4:7], s51 offen offset:3072 sc1 lds
    s_add_u32 m0, s58, 10240
    s_add_u32 s51, s79, 10240
    buffer_load_dwordx4 v1, s[4:7], s51 offen offset:0 sc1 lds
    buffer_load_dwordx4 v1, s[4:7], s51 offen offset:1024 sc1 lds
    s_add_u32 s58, s58, 18432
    s_cmp_eq_u32 s58, 55296
    s_cselect_b32 s58, 0, s58
    s_bfe_u32 s51, s81, 0x40004
    s_mul_i32 s51, s51, s65
    s_add_u32 m0, s59, 8192
    s_add_u32 s51, s51, s64
    buffer_load_dwordx4 v3, s[8:11], s51 offen  lds
    s_add_u32 m0, s59, 9216
    s_add_u32 s51, s51, s66
    buffer_load_dwordx4 v4, s[8:11], s51 offen  lds
    s_add_u32 m0, s59, 10240
    s_add_u32 s51, s51, s66
    buffer_load_dwordx4 v3, s[8:11], s51 offen  lds
    s_add_u32 m0, s59, 11264
    s_add_u32 s51, s51, s66
    buffer_load_dwordx4 v4, s[8:11], s51 offen  lds
    s_add_u32 m0, s59, 12288
    s_add_u32 s51, s51, s66
    buffer_load_dwordx4 v3, s[8:11], s51 offen  lds
    s_add_u32 m0, s59, 13312
    s_add_u32 s51, s51, s66
    buffer_load_dwordx4 v4, s[8:11], s51 offen  lds
    s_add_u32 m0, s59, 14336
    s_add_u32 s51, s51, s66
    buffer_load_dwordx4 v3, s[8:11], s51 offen  lds
    s_add_u32 m0, s59, 15360
    s_add_u32 s51, s51, s66
    buffer_load_dwordx4 v4, s[8:11], s51 offen  lds
    s_add_u32 s59, s59, 24576
    s_cmp_eq_u32 s59, 153600
    s_cselect_b32 s59, 55296, s59
    s_waitcnt vmcnt(22)
    s_barrier
    s_bfe_u32 s79, s81, 0x40004
    s_lshl_b32 s79, s79, 14
    s_add_u32 s79, s79, s70
    s_add_u32 m0, s58, 6144
    s_add_u32 s51, s79, 6144
    buffer_load_dwordx4 v1, s[4:7], s51 offen offset:0 sc1 lds
    buffer_load_dwordx4 v1, s[4:7], s51 offen offset:1024 sc1 lds
    buffer_load_dwordx4 v1, s[4:7], s51 offen offset:2048 sc1 lds
    buffer_load_dwordx4 v1, s[4:7], s51 offen offset:3072 sc1 lds
    s_add_u32 m0, s58, 10240
    s_add_u32 s51, s79, 10240
    buffer_load_dwordx4 v1, s[4:7], s51 offen offset:0 sc1 lds
    buffer_load_dwordx4 v1, s[4:7], s51 offen offset:1024 sc1 lds
    s_add_u32 s58, s58, 18432
    s_cmp_eq_u32 s58, 55296
    s_cselect_b32 s58, 0, s58
    s_bfe_u32 s51, s81, 0x40008
    s_mul_i32 s51, s51, s65
    s_add_u32 m0, s59, 8192
    s_add_u32 s51, s51, s64
    buffer_load_dwordx4 v3, s[8:11], s51 offen  lds
    s_add_u32 m0, s59, 9216
    s_add_u32 s51, s51, s66
    buffer_load_dwordx4 v4, s[8:11], s51 offen  lds
    s_add_u32 m0, s59, 10240
    s_add_u32 s51, s51, s66
    buffer_load_dwordx4 v3, s[8:11], s51 offen  lds
    s_add_u32 m0, s59, 11264
    s_add_u32 s51, s51, s66
    buffer_load_dwordx4 v4, s[8:11], s51 offen  lds
    s_add_u32 m0, s59, 12288
    s_add_u32 s51, s51, s66
    buffer_load_dwordx4 v3, s[8:11], s51 offen  lds
    s_add_u32 m0, s59, 13312
    s_add_u32 s51, s51, s66
    buffer_load_dwordx4 v4, s[8:11], s51 offen  lds
    s_add_u32 m0, s59, 14336
    s_add_u32 s51, s51, s66
    buffer_load_dwordx4 v3, s[8:11], s51 offen  lds
    s_add_u32 m0, s59, 15360
    s_add_u32 s51, s51, s66
    buffer_load_dwordx4 v4, s[8:11], s51 offen  lds
    s_add_u32 s59, s59, 24576
    s_cmp_eq_u32 s59, 153600
    s_cselect_b32 s59, 55296, s59
    s_waitcnt vmcnt(22)
    s_barrier
    s_bfe_u32 s79, s81, 0x40008
    s_lshl_b32 s79, s79, 14
    s_add_u32 s79, s79, s70
    s_add_u32 m0, s58, 6144
    s_add_u32 s51, s79, 6144
    buffer_load_dwordx4 v1, s[4:7], s51 offen offset:0 sc1 lds
    buffer_load_dwordx4 v1, s[4:7], s51 offen offset:1024 sc1 lds
    buffer_load_dwordx4 v1, s[4:7], s51 offen offset:2048 sc1 lds
    buffer_load_dwordx4 v1, s[4:7], s51 offen offset:3072 sc1 lds
    s_add_u32 m0, s58, 10240
    s_add_u32 s51, s79, 10240
    buffer_load_dwordx4 v1, s[4:7], s51 offen offset:0 sc1 lds
    buffer_load_dwordx4 v1, s[4:7], s51 offen offset:1024 sc1 lds
    s_add_u32 s58, s58, 18432
    s_cmp_eq_u32 s58, 55296
    s_cselect_b32 s58, 0, s58
    s_bfe_u32 s51, s81, 0x4000c
    s_mul_i32 s51, s51, s65
    s_add_u32 m0, s59, 8192
    s_add_u32 s51, s51, s64
    buffer_load_dwordx4 v3, s[8:11], s51 offen  lds
    s_add_u32 m0, s59, 9216
    s_add_u32 s51, s51, s66
    buffer_load_dwordx4 v4, s[8:11], s51 offen  lds
    s_add_u32 m0, s59, 10240
    s_add_u32 s51, s51, s66
    buffer_load_dwordx4 v3, s[8:11], s51 offen  lds
    s_add_u32 m0, s59, 11264
    s_add_u32 s51, s51, s66
    buffer_load_dwordx4 v4, s[8:11], s51 offen  lds
    s_add_u32 m0, s59, 12288
    s_add_u32 s51, s51, s66
    buffer_load_dwordx4 v3, s[8:11], s51 offen  lds
    s_add_u32 m0, s59, 13312
    s_add_u32 s51, s51, s66
    buffer_load_dwordx4 v4, s[8:11], s51 offen  lds
    s_add_u32 m0, s59, 14336
    s_add_u32 s51, s51, s66
    buffer_load_dwordx4 v3, s[8:11], s51 offen  lds
    s_add_u32 m0, s59, 15360
    s_add_u32 s51, s51, s66
    buffer_load_dwordx4 v4, s[8:11], s51 offen  lds
    s_add_u32 s59, s59, 24576
    s_cmp_eq_u32 s59, 153600
    s_cselect_b32 s59, 55296, s59
    s_waitcnt vmcnt(22)
    s_barrier
    s_bfe_u32 s79, s81, 0x4000c
    s_lshl_b32 s79, s79, 14
    s_add_u32 s79, s79, s70
    s_add_u32 m0, s58, 6144
    s_add_u32 s51, s79, 6144
    buffer_load_dwordx4 v1, s[4:7], s51 offen offset:0 sc1 lds
    buffer_load_dwordx4 v1, s[4:7], s51 offen offset:1024 sc1 lds
    buffer_load_dwordx4 v1, s[4:7], s51 offen offset:2048 sc1 lds
    buffer_load_dwordx4 v1, s[4:7], s51 offen offset:3072 sc1 lds
    s_add_u32 m0, s58, 10240
    s_add_u32 s51, s79, 10240
    buffer_load_dwordx4 v1, s[4:7], s51 offen offset:0 sc1 lds
    buffer_load_dwordx4 v1, s[4:7], s51 offen offset:1024 sc1 lds
    s_add_u32 s58, s58, 18432
    s_cmp_eq_u32 s58, 55296
    s_cselect_b32 s58, 0, s58
    s_bfe_u32 s51, s81, 0x40010
    s_mul_i32 s51, s51, s65
    s_add_u32 m0, s59, 8192
    s_add_u32 s51, s51, s64
    buffer_load_dwordx4 v3, s[8:11], s51 offen  lds
    s_add_u32 m0, s59, 9216
    s_add_u32 s51, s51, s66
    buffer_load_dwordx4 v4, s[8:11], s51 offen  lds
    s_add_u32 m0, s59, 10240
    s_add_u32 s51, s51, s66
    buffer_load_dwordx4 v3, s[8:11], s51 offen  lds
    s_add_u32 m0, s59, 11264
    s_add_u32 s51, s51, s66
    buffer_load_dwordx4 v4, s[8:11], s51 offen  lds
    s_add_u32 m0, s59, 12288
    s_add_u32 s51, s51, s66
    buffer_load_dwordx4 v3, s[8:11], s51 offen  lds
    s_add_u32 m0, s59, 13312
    s_add_u32 s51, s51, s66
    buffer_load_dwordx4 v4, s[8:11], s51 offen  lds
    s_add_u32 m0, s59, 14336
    s_add_u32 s51, s51, s66
    buffer_load_dwordx4 v3, s[8:11], s51 offen  lds
    s_add_u32 m0, s59, 15360
    s_add_u32 s51, s51, s66
    buffer_load_dwordx4 v4, s[8:11], s51 offen  lds
    s_add_u32 s59, s59, 24576
    s_cmp_eq_u32 s59, 153600
    s_cselect_b32 s59, 55296, s59
    s_waitcnt vmcnt(22)
    s_barrier
    s_bfe_u32 s79, s81, 0x40010
    s_lshl_b32 s79, s79, 14
    s_add_u32 s79, s79, s70
    s_add_u32 m0, s58, 6144
    s_add_u32 s51, s79, 6144
    buffer_load_dwordx4 v1, s[4:7], s51 offen offset:0 sc1 lds
    buffer_load_dwordx4 v1, s[4:7], s51 offen offset:1024 sc1 lds
    buffer_load_dwordx4 v1, s[4:7], s51 offen offset:2048 sc1 lds
    buffer_load_dwordx4 v1, s[4:7], s51 offen offset:3072 sc1 lds
    s_add_u32 m0, s58, 10240
    s_add_u32 s51, s79, 10240
    buffer_load_dwordx4 v1, s[4:7], s51 offen offset:0 sc1 lds
    buffer_load_dwordx4 v1, s[4:7], s51 offen offset:1024 sc1 lds
    s_add_u32 s58, s58, 18432
    s_cmp_eq_u32 s58, 55296
    s_cselect_b32 s58, 0, s58
    s_bfe_u32 s51, s81, 0x40014
    s_mul_i32 s51, s51, s65
    s_add_u32 m0, s59, 8192
    s_add_u32 s51, s51, s64
    buffer_load_dwordx4 v3, s[8:11], s51 offen  lds
    s_add_u32 m0, s59, 9216
    s_add_u32 s51, s51, s66
    buffer_load_dwordx4 v4, s[8:11], s51 offen  lds
    s_add_u32 m0, s59, 10240
    s_add_u32 s51, s51, s66
    buffer_load_dwordx4 v3, s[8:11], s51 offen  lds
    s_add_u32 m0, s59, 11264
    s_add_u32 s51, s51, s66
    buffer_load_dwordx4 v4, s[8:11], s51 offen  lds
    s_add_u32 m0, s59, 12288
    s_add_u32 s51, s51, s66
    buffer_load_dwordx4 v3, s[8:11], s51 offen  lds
    s_add_u32 m0, s59, 13312
    s_add_u32 s51, s51, s66
    buffer_load_dwordx4 v4, s[8:11], s51 offen  lds
    s_add_u32 m0, s59, 14336
    s_add_u32 s51, s51, s66
    buffer_load_dwordx4 v3, s[8:11], s51 offen  lds
    s_add_u32 m0, s59, 15360
    s_add_u32 s51, s51, s66
    buffer_load_dwordx4 v4, s[8:11], s51 offen  lds
    s_add_u32 s59, s59, 24576
    s_cmp_eq_u32 s59, 153600
    s_cselect_b32 s59, 55296, s59
    s_waitcnt vmcnt(22)
    s_barrier
    s_bfe_u32 s79, s81, 0x40014
    s_lshl_b32 s79, s79, 14
    s_add_u32 s79, s79, s70
    s_add_u32 m0, s58, 6144
    s_add_u32 s51, s79, 6144
    buffer_load_dwordx4 v1, s[4:7], s51 offen offset:0 sc1 lds
    buffer_load_dwordx4 v1, s[4:7], s51 offen offset:1024 sc1 lds
    buffer_load_dwordx4 v1, s[4:7], s51 offen offset:2048 sc1 lds
    buffer_load_dwordx4 v1, s[4:7], s51 offen offset:3072 sc1 lds
    s_add_u32 m0, s58, 10240
    s_add_u32 s51, s79, 10240
    buffer_load_dwordx4 v1, s[4:7], s51 offen offset:0 sc1 lds
    buffer_load_dwordx4 v1, s[4:7], s51 offen offset:1024 sc1 lds
    s_add_u32 s58, s58, 18432
    s_cmp_eq_u32 s58, 55296
    s_cselect_b32 s58, 0, s58
    s_bfe_u32 s51, s81, 0x40018
    s_mul_i32 s51, s51, s65
    s_add_u32 m0, s59, 8192
    s_add_u32 s51, s51, s64
    buffer_load_dwordx4 v3, s[8:11], s51 offen  lds
    s_add_u32 m0, s59, 9216
    s_add_u32 s51, s51, s66
    buffer_load_dwordx4 v4, s[8:11], s51 offen  lds
    s_add_u32 m0, s59, 10240
    s_add_u32 s51, s51, s66
    buffer_load_dwordx4 v3, s[8:11], s51 offen  lds
    s_add_u32 m0, s59, 11264
    s_add_u32 s51, s51, s66
    buffer_load_dwordx4 v4, s[8:11], s51 offen  lds
    s_add_u32 m0, s59, 12288
    s_add_u32 s51, s51, s66
    buffer_load_dwordx4 v3, s[8:11], s51 offen  lds
    s_add_u32 m0, s59, 13312
    s_add_u32 s51, s51, s66
    buffer_load_dwordx4 v4, s[8:11], s51 offen  lds
    s_add_u32 m0, s59, 14336
    s_add_u32 s51, s51, s66
    buffer_load_dwordx4 v3, s[8:11], s51 offen  lds
    s_add_u32 m0, s59, 15360
    s_add_u32 s51, s51, s66
    buffer_load_dwordx4 v4, s[8:11], s51 offen  lds
    s_add_u32 s59, s59, 24576
    s_cmp_eq_u32 s59, 153600
    s_cselect_b32 s59, 55296, s59
    s_waitcnt vmcnt(22)
    s_barrier
    s_bfe_u32 s79, s81, 0x40018
    s_lshl_b32 s79, s79, 14
    s_add_u32 s79, s79, s70
    s_add_u32 m0, s58, 6144
    s_add_u32 s51, s79, 6144
    buffer_load_dwordx4 v1, s[4:7], s51 offen offset:0 sc1 lds
    buffer_load_dwordx4 v1, s[4:7], s51 offen offset:1024 sc1 lds
    buffer_load_dwordx4 v1, s[4:7], s51 offen offset:2048 sc1 lds
    buffer_load_dwordx4 v1, s[4:7], s51 offen offset:3072 sc1 lds
    s_add_u32 m0, s58, 10240
    s_add_u32 s51, s79, 10240
    buffer_load_dwordx4 v1, s[4:7], s51 offen offset:0 sc1 lds
    buffer_load_dwordx4 v1, s[4:7], s51 offen offset:1024 sc1 lds
    s_add_u32 s58, s58, 18432
    s_cmp_eq_u32 s58, 55296
    s_cselect_b32 s58, 0, s58
    s_bfe_u32 s51, s81, 0x4001c
    s_mul_i32 s51, s51, s65
    s_add_u32 m0, s59, 8192
    s_add_u32 s51, s51, s64
    buffer_load_dwordx4 v3, s[8:11], s51 offen  lds
    s_add_u32 m0, s59, 9216
    s_add_u32 s51, s51, s66
    buffer_load_dwordx4 v4, s[8:11], s51 offen  lds
    s_add_u32 m0, s59, 10240
    s_add_u32 s51, s51, s66
    buffer_load_dwordx4 v3, s[8:11], s51 offen  lds
    s_add_u32 m0, s59, 11264
    s_add_u32 s51, s51, s66
    buffer_load_dwordx4 v4, s[8:11], s51 offen  lds
    s_add_u32 m0, s59, 12288
    s_add_u32 s51, s51, s66
    buffer_load_dwordx4 v3, s[8:11], s51 offen  lds
    s_add_u32 m0, s59, 13312
    s_add_u32 s51, s51, s66
    buffer_load_dwordx4 v4, s[8:11], s51 offen  lds
    s_add_u32 m0, s59, 14336
    s_add_u32 s51, s51, s66
    buffer_load_dwordx4 v3, s[8:11], s51 offen  lds
    s_add_u32 m0, s59, 15360
    s_add_u32 s51, s51, s66
    buffer_load_dwordx4 v4, s[8:11], s51 offen  lds
    s_add_u32 s59, s59, 24576
    s_cmp_eq_u32 s59, 153600
    s_cselect_b32 s59, 55296, s59
    s_waitcnt vmcnt(22)
    s_barrier
    s_bfe_u32 s79, s81, 0x4001c
    s_lshl_b32 s79, s79, 14
    s_add_u32 s79, s79, s70
    s_add_u32 m0, s58, 6144
    s_add_u32 s51, s79, 6144
    buffer_load_dwordx4 v1, s[4:7], s51 offen offset:0 sc1 lds
    buffer_load_dwordx4 v1, s[4:7], s51 offen offset:1024 sc1 lds
    buffer_load_dwordx4 v1, s[4:7], s51 offen offset:2048 sc1 lds
    buffer_load_dwordx4 v1, s[4:7], s51 offen offset:3072 sc1 lds
    s_add_u32 m0, s58, 10240
    s_add_u32 s51, s79, 10240
    buffer_load_dwordx4 v1, s[4:7], s51 offen offset:0 sc1 lds
    buffer_load_dwordx4 v1, s[4:7], s51 offen offset:1024 sc1 lds
    s_add_u32 s58, s58, 18432
    s_cmp_eq_u32 s58, 55296
    s_cselect_b32 s58, 0, s58
    s_mov_b32 m0, 63488
    s_lshl_b32 s51, 62, s77
    buffer_load_dwordx4 v16, s[12:15], s51 offen  lds
    s_mov_b32 m0, 64512
    s_lshl_b32 s51, 63, s77
    buffer_load_dwordx4 v17, s[12:15], s51 offen  lds
    s_mov_b32 m0, 65536
    s_lshl_b32 s51, 64, s77
    buffer_load_dwordx4 v16, s[12:15], s51 offen  lds
    s_mov_b32 m0, 66560
    s_lshl_b32 s51, 65, s77
    buffer_load_dwordx4 v17, s[12:15], s51 offen  lds
    s_mov_b32 m0, 67584
    s_lshl_b32 s51, 66, s77
    buffer_load_dwordx4 v16, s[12:15], s51 offen  lds
    s_mov_b32 m0, 68608
    s_lshl_b32 s51, 67, s77
    buffer_load_dwordx4 v17, s[12:15], s51 offen  lds
    s_mov_b32 m0, 69632
    s_lshl_b32 s51, 68, s77
    buffer_load_dwordx4 v16, s[12:15], s51 offen  lds
    s_mov_b32 m0, 70656
    s_lshl_b32 s51, 69, s77
    buffer_load_dwordx4 v17, s[12:15], s51 offen  lds
    s_waitcnt vmcnt(22)
    s_barrier
    s_mov_b32 m0, 32768
    s_lshl_b32 s51, 32, s77
    buffer_load_dwordx4 v16, s[12:15], s51 offen  lds
    s_mov_b32 m0, 33792
    s_lshl_b32 s51, 33, s77
    buffer_load_dwordx4 v17, s[12:15], s51 offen  lds
    s_mov_b32 m0, 34816
    s_lshl_b32 s51, 34, s77
    buffer_load_dwordx4 v16, s[12:15], s51 offen  lds
    s_mov_b32 m0, 35840
    s_lshl_b32 s51, 35, s77
    buffer_load_dwordx4 v17, s[12:15], s51 offen  lds
    s_mov_b32 m0, 79872
    s_lshl_b32 s51, 78, s77
    buffer_load_dwordx4 v16, s[12:15], s51 offen  lds
    s_mov_b32 m0, 80896
    s_lshl_b32 s51, 79, s77
    buffer_load_dwordx4 v17, s[12:15], s51 offen  lds
    s_mov_b32 m0, 81920
    s_lshl_b32 s51, 80, s77
    buffer_load_dwordx4 v16, s[12:15], s51 offen  lds
    s_mov_b32 m0, 82944
    s_lshl_b32 s51, 81, s77
    buffer_load_dwordx4 v17, s[12:15], s51 offen  lds
    s_mov_b32 m0, 83968
    s_lshl_b32 s51, 82, s77
    buffer_load_dwordx4 v16, s[12:15], s51 offen  lds
    s_mov_b32 m0, 84992
    s_lshl_b32 s51, 83, s77
    buffer_load_dwordx4 v17, s[12:15], s51 offen  lds
    s_mov_b32 m0, 86016
    s_lshl_b32 s51, 84, s77
    buffer_load_dwordx4 v16, s[12:15], s51 offen  lds
    s_mov_b32 m0, 87040
    s_lshl_b32 s51, 85, s77
    buffer_load_dwordx4 v17, s[12:15], s51 offen  lds
    s_mov_b32 m0, 88064
    s_lshl_b32 s51, 86, s77
    buffer_load_dwordx4 v16, s[12:15], s51 offen  lds
    s_mov_b32 m0, 89088
    s_lshl_b32 s51, 87, s77
    buffer_load_dwordx4 v17, s[12:15], s51 offen  lds
    s_waitcnt vmcnt(22)
    s_barrier
    s_mov_b32 m0, 51200
    s_lshl_b32 s51, 50, s77
    buffer_load_dwordx4 v16, s[12:15], s51 offen  lds
    s_mov_b32 m0, 52224
    s_lshl_b32 s51, 51, s77
    buffer_load_dwordx4 v17, s[12:15], s51 offen  lds
    s_mov_b32 m0, 53248
    s_lshl_b32 s51, 52, s77
    buffer_load_dwordx4 v16, s[12:15], s51 offen  lds
    s_mov_b32 m0, 54272
    s_lshl_b32 s51, 53, s77
    buffer_load_dwordx4 v17, s[12:15], s51 offen  lds
    s_mov_b32 m0, 104448
    s_lshl_b32 s51, 102, s77
    buffer_load_dwordx4 v16, s[12:15], s51 offen  lds
    s_mov_b32 m0, 105472
    s_lshl_b32 s51, 103, s77
    buffer_load_dwordx4 v17, s[12:15], s51 offen  lds
    s_mov_b32 m0, 106496
    s_lshl_b32 s51, 104, s77
    buffer_load_dwordx4 v16, s[12:15], s51 offen  lds
    s_mov_b32 m0, 107520
    s_lshl_b32 s51, 105, s77
    buffer_load_dwordx4 v17, s[12:15], s51 offen  lds
    s_mov_b32 m0, 108544
    s_lshl_b32 s51, 106, s77
    buffer_load_dwordx4 v16, s[12:15], s51 offen  lds
    s_mov_b32 m0, 109568
    s_lshl_b32 s51, 107, s77
    buffer_load_dwordx4 v17, s[12:15], s51 offen  lds
    s_mov_b32 m0, 110592
    s_lshl_b32 s51, 108, s77
    buffer_load_dwordx4 v16, s[12:15], s51 offen  lds
    s_mov_b32 m0, 111616
    s_lshl_b32 s51, 109, s77
    buffer_load_dwordx4 v17, s[12:15], s51 offen  lds
    s_mov_b32 m0, 112640
    s_lshl_b32 s51, 110, s77
    buffer_load_dwordx4 v16, s[12:15], s51 offen  lds
    s_mov_b32 m0, 113664
    s_lshl_b32 s51, 111, s77
    buffer_load_dwordx4 v17, s[12:15], s51 offen  lds
    s_barrier
    s_mov_b32 m0, 6144
    s_lshl_b32 s51, 6, s77
    buffer_load_dwordx4 v16, s[12:15], s51 offen  lds
    s_mov_b32 m0, 7168
    s_lshl_b32 s51, 7, s77
    buffer_load_dwordx4 v17, s[12:15], s51 offen  lds
    s_mov_b32 m0, 8192
    s_lshl_b32 s51, 8, s77
    buffer_load_dwordx4 v16, s[12:15], s51 offen  lds
    s_mov_b32 m0, 9216
    s_lshl_b32 s51, 9, s77
    buffer_load_dwordx4 v17, s[12:15], s51 offen  lds
    s_mov_b32 m0, 10240
    s_lshl_b32 s51, 10, s77
    buffer_load_dwordx4 v16, s[12:15], s51 offen  lds
    s_mov_b32 m0, 11264
    s_lshl_b32 s51, 11, s77
    buffer_load_dwordx4 v17, s[12:15], s51 offen  lds
    s_mov_b32 m0, 12288
    s_lshl_b32 s51, 12, s77
    buffer_load_dwordx4 v16, s[12:15], s51 offen  lds
prod_tail_w1:
    s_waitcnt vmcnt(0)
    s_barrier
    s_cmp_eq_u32 s42, 3
    s_cbranch_scc1 prod_end_w1
    s_add_u32 s42, s42, 1
    s_bitcmp1_b32 s42, 0
    s_cselect_b32 s8, s30, s28
    s_cselect_b32 s9, s31, s29
    s_cmp_eq_u32 s67, 0
    s_cbranch_scc1 notslow_32
    s_mov_b32 s8, s4
    s_mov_b32 s9, s5
    s_mov_b32 s10, s6
    s_mov_b32 s65, 24576
    s_mov_b32 s66, 1024
    v_mov_b32 v3, v1
    v_mov_b32 v4, v1
    s_and_b32 s64, s42, 1
    s_mul_i32 s64, s64, 6291456
    s_mul_i32 s49, s37, 393216
    s_add_u32 s64, s64, s49
    s_add_u32 s64, s64, 41951232
notslow_32:
    s_barrier
    s_mov_b32 s59, 55296
    s_bfe_u32 s51, s80, 0x40000
    s_mul_i32 s51, s51, s65
    s_add_u32 m0, s59, 8192
    s_add_u32 s51, s51, s64
    buffer_load_dwordx4 v3, s[8:11], s51 offen  lds
    s_add_u32 m0, s59, 9216
    s_add_u32 s51, s51, s66
    buffer_load_dwordx4 v4, s[8:11], s51 offen  lds
    s_add_u32 m0, s59, 10240
    s_add_u32 s51, s51, s66
    buffer_load_dwordx4 v3, s[8:11], s51 offen  lds
    s_add_u32 m0, s59, 11264
    s_add_u32 s51, s51, s66
    buffer_load_dwordx4 v4, s[8:11], s51 offen  lds
    s_add_u32 m0, s59, 12288
    s_add_u32 s51, s51, s66
    buffer_load_dwordx4 v3, s[8:11], s51 offen  lds
    s_add_u32 m0, s59, 13312
    s_add_u32 s51, s51, s66
    buffer_load_dwordx4 v4, s[8:11], s51 offen  lds
    s_add_u32 m0, s59, 14336
    s_add_u32 s51, s51, s66
    buffer_load_dwordx4 v3, s[8:11], s51 offen  lds
    s_add_u32 m0, s59, 15360
    s_add_u32 s51, s51, s66
    buffer_load_dwordx4 v4, s[8:11], s51 offen  lds
    s_add_u32 s59, s59, 24576
    s_cmp_eq_u32 s59, 153600
    s_cselect_b32 s59, 55296, s59
    s_bfe_u32 s51, s80, 0x40004
    s_mul_i32 s51, s51, s65
    s_add_u32 m0, s59, 8192
    s_add_u32 s51, s51, s64
    buffer_load_dwordx4 v3, s[8:11], s51 offen  lds
    s_add_u32 m0, s59, 9216
    s_add_u32 s51, s51, s66
    buffer_load_dwordx4 v4, s[8:11], s51 offen  lds
    s_add_u32 m0, s59, 10240
    s_add_u32 s51, s51, s66
    buffer_load_dwordx4 v3, s[8:11], s51 offen  lds
    s_add_u32 m0, s59, 11264
    s_add_u32 s51, s51, s66
    buffer_load_dwordx4 v4, s[8:11], s51 offen  lds
    s_add_u32 m0, s59, 12288
    s_add_u32 s51, s51, s66
    buffer_load_dwordx4 v3, s[8:11], s51 offen  lds
    s_add_u32 m0, s59, 13312
    s_add_u32 s51, s51, s66
    buffer_load_dwordx4 v4, s[8:11], s51 offen  lds
    s_add_u32 m0, s59, 14336
    s_add_u32 s51, s51, s66
    buffer_load_dwordx4 v3, s[8:11], s51 offen  lds
    s_add_u32 m0, s59, 15360
    s_add_u32 s51, s51, s66
    buffer_load_dwordx4 v4, s[8:11], s51 offen  lds
    s_add_u32 s59, s59, 24576
    s_cmp_eq_u32 s59, 153600
    s_cselect_b32 s59, 55296, s59
    s_bfe_u32 s51, s80, 0x40008
    s_mul_i32 s51, s51, s65
    s_add_u32 m0, s59, 8192
    s_add_u32 s51, s51, s64
    buffer_load_dwordx4 v3, s[8:11], s51 offen  lds
    s_add_u32 m0, s59, 9216
    s_add_u32 s51, s51, s66
    buffer_load_dwordx4 v4, s[8:11], s51 offen  lds
    s_add_u32 m0, s59, 10240
    s_add_u32 s51, s51, s66
    buffer_load_dwordx4 v3, s[8:11], s51 offen  lds
    s_add_u32 m0, s59, 11264
    s_add_u32 s51, s51, s66
    buffer_load_dwordx4 v4, s[8:11], s51 offen  lds
    s_add_u32 m0, s59, 12288
    s_add_u32 s51, s51, s66
    buffer_load_dwordx4 v3, s[8:11], s51 offen  lds
    s_add_u32 m0, s59, 13312
    s_add_u32 s51, s51, s66
    buffer_load_dwordx4 v4, s[8:11], s51 offen  lds
    s_add_u32 m0, s59, 14336
    s_add_u32 s51, s51, s66
    buffer_load_dwordx4 v3, s[8:11], s51 offen  lds
    s_add_u32 m0, s59, 15360
    s_add_u32 s51, s51, s66
    buffer_load_dwordx4 v4, s[8:11], s51 offen  lds
    s_add_u32 s59, s59, 24576
    s_cmp_eq_u32 s59, 153600
    s_cselect_b32 s59, 55296, s59
    s_bfe_u32 s51, s80, 0x4000c
    s_mul_i32 s51, s51, s65
    s_add_u32 m0, s59, 8192
    s_add_u32 s51, s51, s64
    buffer_load_dwordx4 v3, s[8:11], s51 offen  lds
    s_add_u32 m0, s59, 9216
    s_add_u32 s51, s51, s66
    buffer_load_dwordx4 v4, s[8:11], s51 offen  lds
    s_add_u32 m0, s59, 10240
    s_add_u32 s51, s51, s66
    buffer_load_dwordx4 v3, s[8:11], s51 offen  lds
    s_add_u32 m0, s59, 11264
    s_add_u32 s51, s51, s66
    buffer_load_dwordx4 v4, s[8:11], s51 offen  lds
    s_add_u32 m0, s59, 12288
    s_add_u32 s51, s51, s66
    buffer_load_dwordx4 v3, s[8:11], s51 offen  lds
    s_add_u32 m0, s59, 13312
    s_add_u32 s51, s51, s66
    buffer_load_dwordx4 v4, s[8:11], s51 offen  lds
    s_add_u32 m0, s59, 14336
    s_add_u32 s51, s51, s66
    buffer_load_dwordx4 v3, s[8:11], s51 offen  lds
    s_add_u32 m0, s59, 15360
    s_add_u32 s51, s51, s66
    buffer_load_dwordx4 v4, s[8:11], s51 offen  lds
    s_add_u32 s59, s59, 24576
    s_cmp_eq_u32 s59, 153600
    s_cselect_b32 s59, 55296, s59
    s_branch prod_layer_w1
prod_end_w1:
    s_endpgm
prod_w2:
    v_and_b32 v9, 63, v0
    v_lshrrev_b32 v10, 3, v9
    v_and_b32 v11, 7, v9
    v_lshrrev_b32 v12, 4, v9
    v_and_b32 v13, 15, v9
    v_lshlrev_b32 v1, 4, v9
    v_and_b32 v14, 1, v12
    v_or_b32 v14, 0, v14
    v_lshlrev_b32 v14, 1, v14
    v_xor_b32 v14, v14, v11
    v_lshlrev_b32 v14, 4, v14
    v_mul_u32_u24 v15, 6144, v10
    v_add_u32 v3, v14, v15
    v_and_b32 v14, 1, v12
    v_or_b32 v14, 2, v14
    v_lshlrev_b32 v14, 1, v14
    v_xor_b32 v14, v14, v11
    v_lshlrev_b32 v14, 4, v14
    v_mul_u32_u24 v15, 6144, v10
    v_add_u32 v4, v14, v15
    v_and_b32 v14, 1, v12
    v_or_b32 v14, 0, v14
    v_lshlrev_b32 v14, 1, v14
    v_xor_b32 v14, v14, v11
    v_lshlrev_b32 v14, 4, v14
    v_lshl_add_u32 v16, v10, 11, v14
    v_and_b32 v14, 1, v12
    v_or_b32 v14, 2, v14
    v_lshlrev_b32 v14, 1, v14
    v_xor_b32 v14, v14, v11
    v_lshlrev_b32 v14, 4, v14
    v_lshl_add_u32 v17, v10, 11, v14
    s_lshl_b32 s49, s39, 7
    v_add_u32 v16, s49, v16
    v_add_u32 v17, s49, v17
    s_mov_b32 s77, 14
    v_or_b32 v14, 0, v12
    v_xor_b32 v14, v14, v11
    v_lshlrev_b32 v14, 4, v14
    v_lshl_add_u32 v6, v10, 12, v14
    v_or_b32 v14, 4, v12
    v_xor_b32 v14, v14, v11
    v_lshlrev_b32 v14, 4, v14
    v_lshl_add_u32 v7, v10, 12, v14
    s_lshl_b32 s64, s37, 7
    s_add_u32 s64, s64, 4096
    s_mov_b32 s65, 393216
    s_mov_b32 s66, 49152
    s_and_b32 s67, s37, 7
    s_cmp_eq_u32 s67, 3
    s_cselect_b32 s67, 1, 0
    s_lshl_b32 s70, s36, 18
    s_sub_u32 s48, s36, 1
    s_max_i32 s48, s48, 0
    s_lshl_b32 s71, s48, 18
    s_mov_b32 s59, 55296
    s_mov_b32 s58, 0
    s_mul_i32 s51, s65, 4
    s_add_u32 m0, s59, 16384
    s_add_u32 s51, s51, s64
    buffer_load_dwordx4 v3, s[8:11], s51 offen  lds
    s_add_u32 m0, s59, 17408
    s_add_u32 s51, s51, s66
    buffer_load_dwordx4 v4, s[8:11], s51 offen  lds
    s_add_u32 m0, s59, 18432
    s_add_u32 s51, s51, s66
    buffer_load_dwordx4 v3, s[8:11], s51 offen  lds
    s_add_u32 m0, s59, 19456
    s_add_u32 s51, s51, s66
    buffer_load_dwordx4 v4, s[8:11], s51 offen  lds
    s_add_u32 m0, s59, 20480
    s_add_u32 s51, s51, s66
    buffer_load_dwordx4 v3, s[8:11], s51 offen  lds
    s_add_u32 m0, s59, 21504
    s_add_u32 s51, s51, s66
    buffer_load_dwordx4 v4, s[8:11], s51 offen  lds
    s_add_u32 m0, s59, 22528
    s_add_u32 s51, s51, s66
    buffer_load_dwordx4 v3, s[8:11], s51 offen  lds
    s_add_u32 m0, s59, 23552
    s_add_u32 s51, s51, s66
    buffer_load_dwordx4 v4, s[8:11], s51 offen  lds
    s_add_u32 s59, s59, 24576
    s_cmp_eq_u32 s59, 153600
    s_cselect_b32 s59, 55296, s59
    s_add_u32 m0, s58, 12288
    s_add_u32 s51, s70, 133632
    buffer_load_dwordx4 v6, s[16:19], s51 offen lds
    s_add_u32 m0, s58, 13312
    s_add_u32 s51, s70, 166400
    buffer_load_dwordx4 v7, s[16:19], s51 offen lds
    s_add_u32 m0, s58, 14336
    s_add_u32 s51, s70, 199168
    buffer_load_dwordx4 v6, s[16:19], s51 offen lds
    s_add_u32 m0, s58, 15360
    s_add_u32 s51, s70, 231936
    buffer_load_dwordx4 v7, s[16:19], s51 offen lds
    s_add_u32 s58, s58, 18432
    s_cmp_eq_u32 s58, 55296
    s_cselect_b32 s58, 0, s58
    s_mul_i32 s51, s65, 5
    s_add_u32 m0, s59, 16384
    s_add_u32 s51, s51, s64
    buffer_load_dwordx4 v3, s[8:11], s51 offen  lds
    s_add_u32 m0, s59, 17408
    s_add_u32 s51, s51, s66
    buffer_load_dwordx4 v4, s[8:11], s51 offen  lds
    s_add_u32 m0, s59, 18432
    s_add_u32 s51, s51, s66
    buffer_load_dwordx4 v3, s[8:11], s51 offen  lds
    s_add_u32 m0, s59, 19456
    s_add_u32 s51, s51, s66
    buffer_load_dwordx4 v4, s[8:11], s51 offen  lds
    s_add_u32 m0, s59, 20480
    s_add_u32 s51, s51, s66
    buffer_load_dwordx4 v3, s[8:11], s51 offen  lds
    s_add_u32 m0, s59, 21504
    s_add_u32 s51, s51, s66
    buffer_load_dwordx4 v4, s[8:11], s51 offen  lds
    s_add_u32 m0, s59, 22528
    s_add_u32 s51, s51, s66
    buffer_load_dwordx4 v3, s[8:11], s51 offen  lds
    s_add_u32 m0, s59, 23552
    s_add_u32 s51, s51, s66
    buffer_load_dwordx4 v4, s[8:11], s51 offen  lds
    s_add_u32 s59, s59, 24576
    s_cmp_eq_u32 s59, 153600
    s_cselect_b32 s59, 55296, s59
    s_add_u32 m0, s58, 12288
    s_add_u32 s51, s70, 133760
    buffer_load_dwordx4 v6, s[16:19], s51 offen lds
    s_add_u32 m0, s58, 13312
    s_add_u32 s51, s70, 166528
    buffer_load_dwordx4 v7, s[16:19], s51 offen lds
    s_add_u32 m0, s58, 14336
    s_add_u32 s51, s70, 199296
    buffer_load_dwordx4 v6, s[16:19], s51 offen lds
    s_add_u32 m0, s58, 15360
    s_add_u32 s51, s70, 232064
    buffer_load_dwordx4 v7, s[16:19], s51 offen lds
    s_add_u32 s58, s58, 18432
    s_cmp_eq_u32 s58, 55296
    s_cselect_b32 s58, 0, s58
    s_add_u32 m0, s58, 12288
    s_add_u32 s51, s70, 133888
    buffer_load_dwordx4 v6, s[16:19], s51 offen lds
    s_add_u32 m0, s58, 13312
    s_add_u32 s51, s70, 166656
    buffer_load_dwordx4 v7, s[16:19], s51 offen lds
    s_add_u32 m0, s58, 14336
    s_add_u32 s51, s70, 199424
    buffer_load_dwordx4 v6, s[16:19], s51 offen lds
    s_add_u32 m0, s58, 15360
    s_add_u32 s51, s70, 232192
    buffer_load_dwordx4 v7, s[16:19], s51 offen lds
    s_add_u32 s58, s58, 18432
    s_cmp_eq_u32 s58, 55296
    s_cselect_b32 s58, 0, s58
    s_mul_i32 s51, s65, 6
    s_add_u32 m0, s59, 16384
    s_add_u32 s51, s51, s64
    buffer_load_dwordx4 v3, s[8:11], s51 offen  lds
    s_add_u32 m0, s59, 17408
    s_add_u32 s51, s51, s66
    buffer_load_dwordx4 v4, s[8:11], s51 offen  lds
    s_add_u32 m0, s59, 18432
    s_add_u32 s51, s51, s66
    buffer_load_dwordx4 v3, s[8:11], s51 offen  lds
    s_add_u32 m0, s59, 19456
    s_add_u32 s51, s51, s66
    buffer_load_dwordx4 v4, s[8:11], s51 offen  lds
    s_add_u32 m0, s59, 20480
    s_add_u32 s51, s51, s66
    buffer_load_dwordx4 v3, s[8:11], s51 offen  lds
    s_add_u32 m0, s59, 21504
    s_add_u32 s51, s51, s66
    buffer_load_dwordx4 v4, s[8:11], s51 offen  lds
    s_add_u32 m0, s59, 22528
    s_add_u32 s51, s51, s66
    buffer_load_dwordx4 v3, s[8:11], s51 offen  lds
    s_add_u32 m0, s59, 23552
    s_add_u32 s51, s51, s66
    buffer_load_dwordx4 v4, s[8:11], s51 offen  lds
    s_add_u32 s59, s59, 24576
    s_cmp_eq_u32 s59, 153600
    s_cselect_b32 s59, 55296, s59
    s_mul_i32 s51, s65, 7
    s_add_u32 m0, s59, 16384
    s_add_u32 s51, s51, s64
    buffer_load_dwordx4 v3, s[8:11], s51 offen  lds
    s_add_u32 m0, s59, 17408
    s_add_u32 s51, s51, s66
    buffer_load_dwordx4 v4, s[8:11], s51 offen  lds
    s_add_u32 m0, s59, 18432
    s_add_u32 s51, s51, s66
    buffer_load_dwordx4 v3, s[8:11], s51 offen  lds
    s_add_u32 m0, s59, 19456
    s_add_u32 s51, s51, s66
    buffer_load_dwordx4 v4, s[8:11], s51 offen  lds
    s_add_u32 m0, s59, 20480
    s_add_u32 s51, s51, s66
    buffer_load_dwordx4 v3, s[8:11], s51 offen  lds
    s_add_u32 m0, s59, 21504
    s_add_u32 s51, s51, s66
    buffer_load_dwordx4 v4, s[8:11], s51 offen  lds
    s_add_u32 m0, s59, 22528
    s_add_u32 s51, s51, s66
    buffer_load_dwordx4 v3, s[8:11], s51 offen  lds
    s_add_u32 m0, s59, 23552
    s_add_u32 s51, s51, s66
    buffer_load_dwordx4 v4, s[8:11], s51 offen  lds
    s_add_u32 s59, s59, 24576
    s_cmp_eq_u32 s59, 153600
    s_cselect_b32 s59, 55296, s59
    s_mov_b32 s80, 0xfedc7654
    s_mov_b32 s81, 0xb3a29180
    s_mov_b32 s46, 0x3210eca8
    s_mov_b32 s47, 0x7654fdb9
    s_lshl_b32 s45, s37, 2
    s_lshr_b64 s[46:47], s[46:47], s45
    s_and_b32 s45, s46, 15
    s_lshl_b32 s45, s45, 2
    s_bfm_b64 s[46:47], s45, 0
    s_and_b64 s[46:47], s[46:47], s[80:81]
    s_lshl_b64 s[46:47], s[46:47], 4
    s_lshr_b64 s[48:49], s[80:81], s45
    s_lshr_b64 s[48:49], s[48:49], 4
    s_lshl_b64 s[48:49], s[48:49], 4
    s_lshl_b64 s[48:49], s[48:49], s45
    s_or_b64 s[80:81], s[46:47], s[48:49]
    s_or_b32 s80, s80, s37
    v_lshlrev_b32 v14, 8, v12
    v_or_b32 v15, 8, v13
    v_lshl_add_u32 v14, v15, 4, v14
    v_lshrrev_b32 v15, 3, v13
    v_lshlrev_b32 v15, 13, v15
    v_add_u32 v14, v14, v15
    v_add_u32 v2, 6144, v14
    s_waitcnt vmcnt(32)
    s_barrier
    s_bitcmp1_b32 s42, 0
    s_cselect_b32 s12, s34, s32
    s_cselect_b32 s13, s35, s33
    s_cmp_eq_u32 s67, 0
    s_cbranch_scc1 wo_notslow_33
    s_mov_b32 s12, s4
    s_mov_b32 s13, s5
    s_mov_b32 s14, s6
    s_and_b32 s75, s42, 1
    s_lshl_b32 s75, s75, 21
    s_lshl_b32 s49, s39, 17
    s_add_u32 s75, s75, s49
    s_add_u32 s75, s75, 54525952
    v_add_u32 v16, s75, v1
    v_mov_b32 v17, v16
    s_mov_b32 s77, 10
wo_notslow_33:
    s_waitcnt vmcnt(20)
    s_barrier
    s_add_u32 m0, s58, 12288
    s_add_u32 s51, s70, 134016
    buffer_load_dwordx4 v6, s[16:19], s51 offen lds
    s_add_u32 m0, s58, 13312
    s_add_u32 s51, s70, 166784
    buffer_load_dwordx4 v7, s[16:19], s51 offen lds
    s_add_u32 m0, s58, 14336
    s_add_u32 s51, s70, 199552
    buffer_load_dwordx4 v6, s[16:19], s51 offen lds
    s_add_u32 m0, s58, 15360
    s_add_u32 s51, s70, 232320
    buffer_load_dwordx4 v7, s[16:19], s51 offen lds
    s_add_u32 s58, s58, 18432
    s_cmp_eq_u32 s58, 55296
    s_cselect_b32 s58, 0, s58
    s_mul_i32 s51, s65, 12
    s_add_u32 m0, s59, 16384
    s_add_u32 s51, s51, s64
    buffer_load_dwordx4 v3, s[8:11], s51 offen  lds
    s_add_u32 m0, s59, 17408
    s_add_u32 s51, s51, s66
    buffer_load_dwordx4 v4, s[8:11], s51 offen  lds
    s_add_u32 m0, s59, 18432
    s_add_u32 s51, s51, s66
    buffer_load_dwordx4 v3, s[8:11], s51 offen  lds
    s_add_u32 m0, s59, 19456
    s_add_u32 s51, s51, s66
    buffer_load_dwordx4 v4, s[8:11], s51 offen  lds
    s_add_u32 m0, s59, 20480
    s_add_u32 s51, s51, s66
    buffer_load_dwordx4 v3, s[8:11], s51 offen  lds
    s_add_u32 m0, s59, 21504
    s_add_u32 s51, s51, s66
    buffer_load_dwordx4 v4, s[8:11], s51 offen  lds
    s_add_u32 m0, s59, 22528
    s_add_u32 s51, s51, s66
    buffer_load_dwordx4 v3, s[8:11], s51 offen  lds
    s_add_u32 m0, s59, 23552
    s_add_u32 s51, s51, s66
    buffer_load_dwordx4 v4, s[8:11], s51 offen  lds
    s_add_u32 s59, s59, 24576
    s_cmp_eq_u32 s59, 153600
    s_cselect_b32 s59, 55296, s59
    s_waitcnt vmcnt(20)
    s_barrier
    s_add_u32 m0, s58, 12288
    s_add_u32 s51, s70, 134656
    buffer_load_dwordx4 v6, s[16:19], s51 offen lds
    s_add_u32 m0, s58, 13312
    s_add_u32 s51, s70, 167424
    buffer_load_dwordx4 v7, s[16:19], s51 offen lds
    s_add_u32 m0, s58, 14336
    s_add_u32 s51, s70, 200192
    buffer_load_dwordx4 v6, s[16:19], s51 offen lds
    s_add_u32 m0, s58, 15360
    s_add_u32 s51, s70, 232960
    buffer_load_dwordx4 v7, s[16:19], s51 offen lds
    s_add_u32 s58, s58, 18432
    s_cmp_eq_u32 s58, 55296
    s_cselect_b32 s58, 0, s58
    s_mul_i32 s51, s65, 13
    s_add_u32 m0, s59, 16384
    s_add_u32 s51, s51, s64
    buffer_load_dwordx4 v3, s[8:11], s51 offen  lds
    s_add_u32 m0, s59, 17408
    s_add_u32 s51, s51, s66
    buffer_load_dwordx4 v4, s[8:11], s51 offen  lds
    s_add_u32 m0, s59, 18432
    s_add_u32 s51, s51, s66
    buffer_load_dwordx4 v3, s[8:11], s51 offen  lds
    s_add_u32 m0, s59, 19456
    s_add_u32 s51, s51, s66
    buffer_load_dwordx4 v4, s[8:11], s51 offen  lds
    s_add_u32 m0, s59, 20480
    s_add_u32 s51, s51, s66
    buffer_load_dwordx4 v3, s[8:11], s51 offen  lds
    s_add_u32 m0, s59, 21504
    s_add_u32 s51, s51, s66
    buffer_load_dwordx4 v4, s[8:11], s51 offen  lds
    s_add_u32 m0, s59, 22528
    s_add_u32 s51, s51, s66
    buffer_load_dwordx4 v3, s[8:11], s51 offen  lds
    s_add_u32 m0, s59, 23552
    s_add_u32 s51, s51, s66
    buffer_load_dwordx4 v4, s[8:11], s51 offen  lds
    s_add_u32 s59, s59, 24576
    s_cmp_eq_u32 s59, 153600
    s_cselect_b32 s59, 55296, s59
    s_waitcnt vmcnt(20)
    s_barrier
    s_add_u32 m0, s58, 12288
    s_add_u32 s51, s70, 134784
    buffer_load_dwordx4 v6, s[16:19], s51 offen lds
    s_add_u32 m0, s58, 13312
    s_add_u32 s51, s70, 167552
    buffer_load_dwordx4 v7, s[16:19], s51 offen lds
    s_add_u32 m0, s58, 14336
    s_add_u32 s51, s70, 200320
    buffer_load_dwordx4 v6, s[16:19], s51 offen lds
    s_add_u32 m0, s58, 15360
    s_add_u32 s51, s70, 233088
    buffer_load_dwordx4 v7, s[16:19], s51 offen lds
    s_add_u32 s58, s58, 18432
    s_cmp_eq_u32 s58, 55296
    s_cselect_b32 s58, 0, s58
    s_cmp_eq_u32 s67, 0
    s_cbranch_scc1 notslow_34
    s_mov_b32 s8, s4
    s_mov_b32 s9, s5
    s_mov_b32 s10, s6
    s_mov_b32 s65, 24576
    s_mov_b32 s66, 1024
    v_mov_b32 v3, v1
    v_mov_b32 v4, v1
    s_and_b32 s64, s42, 1
    s_mul_i32 s64, s64, 6291456
    s_mul_i32 s49, s37, 393216
    s_add_u32 s64, s64, s49
    s_add_u32 s64, s64, 41959424
notslow_34:
    s_mul_i32 s51, s65, 14
    s_add_u32 m0, s59, 16384
    s_add_u32 s51, s51, s64
    buffer_load_dwordx4 v3, s[8:11], s51 offen  lds
    s_add_u32 m0, s59, 17408
    s_add_u32 s51, s51, s66
    buffer_load_dwordx4 v4, s[8:11], s51 offen  lds
    s_add_u32 m0, s59, 18432
    s_add_u32 s51, s51, s66
    buffer_load_dwordx4 v3, s[8:11], s51 offen  lds
    s_add_u32 m0, s59, 19456
    s_add_u32 s51, s51, s66
    buffer_load_dwordx4 v4, s[8:11], s51 offen  lds
    s_add_u32 m0, s59, 20480
    s_add_u32 s51, s51, s66
    buffer_load_dwordx4 v3, s[8:11], s51 offen  lds
    s_add_u32 m0, s59, 21504
    s_add_u32 s51, s51, s66
    buffer_load_dwordx4 v4, s[8:11], s51 offen  lds
    s_add_u32 m0, s59, 22528
    s_add_u32 s51, s51, s66
    buffer_load_dwordx4 v3, s[8:11], s51 offen  lds
    s_add_u32 m0, s59, 23552
    s_add_u32 s51, s51, s66
    buffer_load_dwordx4 v4, s[8:11], s51 offen  lds
    s_add_u32 s59, s59, 24576
    s_cmp_eq_u32 s59, 153600
    s_cselect_b32 s59, 55296, s59
    s_waitcnt vmcnt(20)
    s_barrier
    s_add_u32 m0, s58, 12288
    s_add_u32 s51, s70, 134912
    buffer_load_dwordx4 v6, s[16:19], s51 offen lds
    s_add_u32 m0, s58, 13312
    s_add_u32 s51, s70, 167680
    buffer_load_dwordx4 v7, s[16:19], s51 offen lds
    s_add_u32 m0, s58, 14336
    s_add_u32 s51, s70, 200448
    buffer_load_dwordx4 v6, s[16:19], s51 offen lds
    s_add_u32 m0, s58, 15360
    s_add_u32 s51, s70, 233216
    buffer_load_dwordx4 v7, s[16:19], s51 offen lds
    s_add_u32 s58, s58, 18432
    s_cmp_eq_u32 s58, 55296
    s_cselect_b32 s58, 0, s58
    s_mul_i32 s51, s65, 15
    s_add_u32 m0, s59, 16384
    s_add_u32 s51, s51, s64
    buffer_load_dwordx4 v3, s[8:11], s51 offen  lds
    s_add_u32 m0, s59, 17408
    s_add_u32 s51, s51, s66
    buffer_load_dwordx4 v4, s[8:11], s51 offen  lds
    s_add_u32 m0, s59, 18432
    s_add_u32 s51, s51, s66
    buffer_load_dwordx4 v3, s[8:11], s51 offen  lds
    s_add_u32 m0, s59, 19456
    s_add_u32 s51, s51, s66
    buffer_load_dwordx4 v4, s[8:11], s51 offen  lds
    s_add_u32 m0, s59, 20480
    s_add_u32 s51, s51, s66
    buffer_load_dwordx4 v3, s[8:11], s51 offen  lds
    s_add_u32 m0, s59, 21504
    s_add_u32 s51, s51, s66
    buffer_load_dwordx4 v4, s[8:11], s51 offen  lds
    s_add_u32 m0, s59, 22528
    s_add_u32 s51, s51, s66
    buffer_load_dwordx4 v3, s[8:11], s51 offen  lds
    s_add_u32 m0, s59, 23552
    s_add_u32 s51, s51, s66
    buffer_load_dwordx4 v4, s[8:11], s51 offen  lds
    s_add_u32 s59, s59, 24576
    s_cmp_eq_u32 s59, 153600
    s_cselect_b32 s59, 55296, s59
    s_waitcnt vmcnt(20)
    s_barrier
    s_add_u32 m0, s58, 12288
    s_add_u32 s51, s70, 135040
    buffer_load_dwordx4 v6, s[16:19], s51 offen lds
    s_add_u32 m0, s58, 13312
    s_add_u32 s51, s70, 167808
    buffer_load_dwordx4 v7, s[16:19], s51 offen lds
    s_add_u32 m0, s58, 14336
    s_add_u32 s51, s70, 200576
    buffer_load_dwordx4 v6, s[16:19], s51 offen lds
    s_add_u32 m0, s58, 15360
    s_add_u32 s51, s70, 233344
    buffer_load_dwordx4 v7, s[16:19], s51 offen lds
    s_add_u32 s58, s58, 18432
    s_cmp_eq_u32 s58, 55296
    s_cselect_b32 s58, 0, s58
    s_mul_i32 s51, s65, 0
    s_add_u32 m0, s59, 16384
    s_add_u32 s51, s51, s64
    buffer_load_dwordx4 v3, s[8:11], s51 offen  lds
    s_add_u32 m0, s59, 17408
    s_add_u32 s51, s51, s66
    buffer_load_dwordx4 v4, s[8:11], s51 offen  lds
    s_add_u32 m0, s59, 18432
    s_add_u32 s51, s51, s66
    buffer_load_dwordx4 v3, s[8:11], s51 offen  lds
    s_add_u32 m0, s59, 19456
    s_add_u32 s51, s51, s66
    buffer_load_dwordx4 v4, s[8:11], s51 offen  lds
    s_add_u32 m0, s59, 20480
    s_add_u32 s51, s51, s66
    buffer_load_dwordx4 v3, s[8:11], s51 offen  lds
    s_add_u32 m0, s59, 21504
    s_add_u32 s51, s51, s66
    buffer_load_dwordx4 v4, s[8:11], s51 offen  lds
    s_add_u32 m0, s59, 22528
    s_add_u32 s51, s51, s66
    buffer_load_dwordx4 v3, s[8:11], s51 offen  lds
    s_add_u32 m0, s59, 23552
    s_add_u32 s51, s51, s66
    buffer_load_dwordx4 v4, s[8:11], s51 offen  lds
    s_add_u32 s59, s59, 24576
    s_cmp_eq_u32 s59, 153600
    s_cselect_b32 s59, 55296, s59
    s_waitcnt vmcnt(20)
    s_barrier
    s_add_u32 m0, s58, 12288
    s_add_u32 s51, s70, 133120
    buffer_load_dwordx4 v6, s[16:19], s51 offen lds
    s_add_u32 m0, s58, 13312
    s_add_u32 s51, s70, 165888
    buffer_load_dwordx4 v7, s[16:19], s51 offen lds
    s_add_u32 m0, s58, 14336
    s_add_u32 s51, s70, 198656
    buffer_load_dwordx4 v6, s[16:19], s51 offen lds
    s_add_u32 m0, s58, 15360
    s_add_u32 s51, s70, 231424
    buffer_load_dwordx4 v7, s[16:19], s51 offen lds
    s_add_u32 s58, s58, 18432
    s_cmp_eq_u32 s58, 55296
    s_cselect_b32 s58, 0, s58
    s_mul_i32 s51, s65, 8
    s_add_u32 m0, s59, 16384
    s_add_u32 s51, s51, s64
    buffer_load_dwordx4 v3, s[8:11], s51 offen  lds
    s_add_u32 m0, s59, 17408
    s_add_u32 s51, s51, s66
    buffer_load_dwordx4 v4, s[8:11], s51 offen  lds
    s_add_u32 m0, s59, 18432
    s_add_u32 s51, s51, s66
    buffer_load_dwordx4 v3, s[8:11], s51 offen  lds
    s_add_u32 m0, s59, 19456
    s_add_u32 s51, s51, s66
    buffer_load_dwordx4 v4, s[8:11], s51 offen  lds
    s_add_u32 m0, s59, 20480
    s_add_u32 s51, s51, s66
    buffer_load_dwordx4 v3, s[8:11], s51 offen  lds
    s_add_u32 m0, s59, 21504
    s_add_u32 s51, s51, s66
    buffer_load_dwordx4 v4, s[8:11], s51 offen  lds
    s_add_u32 m0, s59, 22528
    s_add_u32 s51, s51, s66
    buffer_load_dwordx4 v3, s[8:11], s51 offen  lds
    s_add_u32 m0, s59, 23552
    s_add_u32 s51, s51, s66
    buffer_load_dwordx4 v4, s[8:11], s51 offen  lds
    s_add_u32 s59, s59, 24576
    s_cmp_eq_u32 s59, 153600
    s_cselect_b32 s59, 55296, s59
    s_waitcnt vmcnt(20)
    s_barrier
    s_add_u32 m0, s58, 12288
    s_add_u32 s51, s70, 134144
    buffer_load_dwordx4 v6, s[16:19], s51 offen lds
    s_add_u32 m0, s58, 13312
    s_add_u32 s51, s70, 166912
    buffer_load_dwordx4 v7, s[16:19], s51 offen lds
    s_add_u32 m0, s58, 14336
    s_add_u32 s51, s70, 199680
    buffer_load_dwordx4 v6, s[16:19], s51 offen lds
    s_add_u32 m0, s58, 15360
    s_add_u32 s51, s70, 232448
    buffer_load_dwordx4 v7, s[16:19], s51 offen lds
    s_add_u32 s58, s58, 18432
    s_cmp_eq_u32 s58, 55296
    s_cselect_b32 s58, 0, s58
    s_mul_i32 s51, s65, 1
    s_add_u32 m0, s59, 16384
    s_add_u32 s51, s51, s64
    buffer_load_dwordx4 v3, s[8:11], s51 offen  lds
    s_add_u32 m0, s59, 17408
    s_add_u32 s51, s51, s66
    buffer_load_dwordx4 v4, s[8:11], s51 offen  lds
    s_add_u32 m0, s59, 18432
    s_add_u32 s51, s51, s66
    buffer_load_dwordx4 v3, s[8:11], s51 offen  lds
    s_add_u32 m0, s59, 19456
    s_add_u32 s51, s51, s66
    buffer_load_dwordx4 v4, s[8:11], s51 offen  lds
    s_add_u32 m0, s59, 20480
    s_add_u32 s51, s51, s66
    buffer_load_dwordx4 v3, s[8:11], s51 offen  lds
    s_add_u32 m0, s59, 21504
    s_add_u32 s51, s51, s66
    buffer_load_dwordx4 v4, s[8:11], s51 offen  lds
    s_add_u32 m0, s59, 22528
    s_add_u32 s51, s51, s66
    buffer_load_dwordx4 v3, s[8:11], s51 offen  lds
    s_add_u32 m0, s59, 23552
    s_add_u32 s51, s51, s66
    buffer_load_dwordx4 v4, s[8:11], s51 offen  lds
    s_add_u32 s59, s59, 24576
    s_cmp_eq_u32 s59, 153600
    s_cselect_b32 s59, 55296, s59
    s_waitcnt vmcnt(20)
    s_barrier
    s_add_u32 m0, s58, 12288
    s_add_u32 s51, s70, 133248
    buffer_load_dwordx4 v6, s[16:19], s51 offen lds
    s_add_u32 m0, s58, 13312
    s_add_u32 s51, s70, 166016
    buffer_load_dwordx4 v7, s[16:19], s51 offen lds
    s_add_u32 m0, s58, 14336
    s_add_u32 s51, s70, 198784
    buffer_load_dwordx4 v6, s[16:19], s51 offen lds
    s_add_u32 m0, s58, 15360
    s_add_u32 s51, s70, 231552
    buffer_load_dwordx4 v7, s[16:19], s51 offen lds
    s_add_u32 s58, s58, 18432
    s_cmp_eq_u32 s58, 55296
    s_cselect_b32 s58, 0, s58
    s_mul_i32 s51, s65, 9
    s_add_u32 m0, s59, 16384
    s_add_u32 s51, s51, s64
    buffer_load_dwordx4 v3, s[8:11], s51 offen  lds
    s_add_u32 m0, s59, 17408
    s_add_u32 s51, s51, s66
    buffer_load_dwordx4 v4, s[8:11], s51 offen  lds
    s_add_u32 m0, s59, 18432
    s_add_u32 s51, s51, s66
    buffer_load_dwordx4 v3, s[8:11], s51 offen  lds
    s_add_u32 m0, s59, 19456
    s_add_u32 s51, s51, s66
    buffer_load_dwordx4 v4, s[8:11], s51 offen  lds
    s_add_u32 m0, s59, 20480
    s_add_u32 s51, s51, s66
    buffer_load_dwordx4 v3, s[8:11], s51 offen  lds
    s_add_u32 m0, s59, 21504
    s_add_u32 s51, s51, s66
    buffer_load_dwordx4 v4, s[8:11], s51 offen  lds
    s_add_u32 m0, s59, 22528
    s_add_u32 s51, s51, s66
    buffer_load_dwordx4 v3, s[8:11], s51 offen  lds
    s_add_u32 m0, s59, 23552
    s_add_u32 s51, s51, s66
    buffer_load_dwordx4 v4, s[8:11], s51 offen  lds
    s_add_u32 s59, s59, 24576
    s_cmp_eq_u32 s59, 153600
    s_cselect_b32 s59, 55296, s59
    s_waitcnt vmcnt(20)
    s_barrier
    s_add_u32 m0, s58, 12288
    s_add_u32 s51, s70, 134272
    buffer_load_dwordx4 v6, s[16:19], s51 offen lds
    s_add_u32 m0, s58, 13312
    s_add_u32 s51, s70, 167040
    buffer_load_dwordx4 v7, s[16:19], s51 offen lds
    s_add_u32 m0, s58, 14336
    s_add_u32 s51, s70, 199808
    buffer_load_dwordx4 v6, s[16:19], s51 offen lds
    s_add_u32 m0, s58, 15360
    s_add_u32 s51, s70, 232576
    buffer_load_dwordx4 v7, s[16:19], s51 offen lds
    s_add_u32 s58, s58, 18432
    s_cmp_eq_u32 s58, 55296
    s_cselect_b32 s58, 0, s58
    s_mul_i32 s51, s65, 2
    s_add_u32 m0, s59, 16384
    s_add_u32 s51, s51, s64
    buffer_load_dwordx4 v3, s[8:11], s51 offen  lds
    s_add_u32 m0, s59, 17408
    s_add_u32 s51, s51, s66
    buffer_load_dwordx4 v4, s[8:11], s51 offen  lds
    s_add_u32 m0, s59, 18432
    s_add_u32 s51, s51, s66
    buffer_load_dwordx4 v3, s[8:11], s51 offen  lds
    s_add_u32 m0, s59, 19456
    s_add_u32 s51, s51, s66
    buffer_load_dwordx4 v4, s[8:11], s51 offen  lds
    s_add_u32 m0, s59, 20480
    s_add_u32 s51, s51, s66
    buffer_load_dwordx4 v3, s[8:11], s51 offen  lds
    s_add_u32 m0, s59, 21504
    s_add_u32 s51, s51, s66
    buffer_load_dwordx4 v4, s[8:11], s51 offen  lds
    s_add_u32 m0, s59, 22528
    s_add_u32 s51, s51, s66
    buffer_load_dwordx4 v3, s[8:11], s51 offen  lds
    s_add_u32 m0, s59, 23552
    s_add_u32 s51, s51, s66
    buffer_load_dwordx4 v4, s[8:11], s51 offen  lds
    s_add_u32 s59, s59, 24576
    s_cmp_eq_u32 s59, 153600
    s_cselect_b32 s59, 55296, s59
    s_waitcnt vmcnt(20)
    s_barrier
    s_add_u32 m0, s58, 12288
    s_add_u32 s51, s70, 133376
    buffer_load_dwordx4 v6, s[16:19], s51 offen lds
    s_add_u32 m0, s58, 13312
    s_add_u32 s51, s70, 166144
    buffer_load_dwordx4 v7, s[16:19], s51 offen lds
    s_add_u32 m0, s58, 14336
    s_add_u32 s51, s70, 198912
    buffer_load_dwordx4 v6, s[16:19], s51 offen lds
    s_add_u32 m0, s58, 15360
    s_add_u32 s51, s70, 231680
    buffer_load_dwordx4 v7, s[16:19], s51 offen lds
    s_add_u32 s58, s58, 18432
    s_cmp_eq_u32 s58, 55296
    s_cselect_b32 s58, 0, s58
    s_mul_i32 s51, s65, 10
    s_add_u32 m0, s59, 16384
    s_add_u32 s51, s51, s64
    buffer_load_dwordx4 v3, s[8:11], s51 offen  lds
    s_add_u32 m0, s59, 17408
    s_add_u32 s51, s51, s66
    buffer_load_dwordx4 v4, s[8:11], s51 offen  lds
    s_add_u32 m0, s59, 18432
    s_add_u32 s51, s51, s66
    buffer_load_dwordx4 v3, s[8:11], s51 offen  lds
    s_add_u32 m0, s59, 19456
    s_add_u32 s51, s51, s66
    buffer_load_dwordx4 v4, s[8:11], s51 offen  lds
    s_add_u32 m0, s59, 20480
    s_add_u32 s51, s51, s66
    buffer_load_dwordx4 v3, s[8:11], s51 offen  lds
    s_add_u32 m0, s59, 21504
    s_add_u32 s51, s51, s66
    buffer_load_dwordx4 v4, s[8:11], s51 offen  lds
    s_add_u32 m0, s59, 22528
    s_add_u32 s51, s51, s66
    buffer_load_dwordx4 v3, s[8:11], s51 offen  lds
    s_add_u32 m0, s59, 23552
    s_add_u32 s51, s51, s66
    buffer_load_dwordx4 v4, s[8:11], s51 offen  lds
    s_add_u32 s59, s59, 24576
    s_cmp_eq_u32 s59, 153600
    s_cselect_b32 s59, 55296, s59
    s_waitcnt vmcnt(20)
    s_barrier
    s_add_u32 m0, s58, 12288
    s_add_u32 s51, s70, 134400
    buffer_load_dwordx4 v6, s[16:19], s51 offen lds
    s_add_u32 m0, s58, 13312
    s_add_u32 s51, s70, 167168
    buffer_load_dwordx4 v7, s[16:19], s51 offen lds
    s_add_u32 m0, s58, 14336
    s_add_u32 s51, s70, 199936
    buffer_load_dwordx4 v6, s[16:19], s51 offen lds
    s_add_u32 m0, s58, 15360
    s_add_u32 s51, s70, 232704
    buffer_load_dwordx4 v7, s[16:19], s51 offen lds
    s_add_u32 s58, s58, 18432
    s_cmp_eq_u32 s58, 55296
    s_cselect_b32 s58, 0, s58
    s_mul_i32 s51, s65, 3
    s_add_u32 m0, s59, 16384
    s_add_u32 s51, s51, s64
    buffer_load_dwordx4 v3, s[8:11], s51 offen  lds
    s_add_u32 m0, s59, 17408
    s_add_u32 s51, s51, s66
    buffer_load_dwordx4 v4, s[8:11], s51 offen  lds
    s_add_u32 m0, s59, 18432
    s_add_u32 s51, s51, s66
    buffer_load_dwordx4 v3, s[8:11], s51 offen  lds
    s_add_u32 m0, s59, 19456
    s_add_u32 s51, s51, s66
    buffer_load_dwordx4 v4, s[8:11], s51 offen  lds
    s_add_u32 m0, s59, 20480
    s_add_u32 s51, s51, s66
    buffer_load_dwordx4 v3, s[8:11], s51 offen  lds
    s_add_u32 m0, s59, 21504
    s_add_u32 s51, s51, s66
    buffer_load_dwordx4 v4, s[8:11], s51 offen  lds
    s_add_u32 m0, s59, 22528
    s_add_u32 s51, s51, s66
    buffer_load_dwordx4 v3, s[8:11], s51 offen  lds
    s_add_u32 m0, s59, 23552
    s_add_u32 s51, s51, s66
    buffer_load_dwordx4 v4, s[8:11], s51 offen  lds
    s_add_u32 s59, s59, 24576
    s_cmp_eq_u32 s59, 153600
    s_cselect_b32 s59, 55296, s59
    s_waitcnt vmcnt(20)
    s_barrier
    s_add_u32 m0, s58, 12288
    s_add_u32 s51, s70, 133504
    buffer_load_dwordx4 v6, s[16:19], s51 offen lds
    s_add_u32 m0, s58, 13312
    s_add_u32 s51, s70, 166272
    buffer_load_dwordx4 v7, s[16:19], s51 offen lds
    s_add_u32 m0, s58, 14336
    s_add_u32 s51, s70, 199040
    buffer_load_dwordx4 v6, s[16:19], s51 offen lds
    s_add_u32 m0, s58, 15360
    s_add_u32 s51, s70, 231808
    buffer_load_dwordx4 v7, s[16:19], s51 offen lds
    s_add_u32 s58, s58, 18432
    s_cmp_eq_u32 s58, 55296
    s_cselect_b32 s58, 0, s58
    s_mul_i32 s51, s65, 11
    s_add_u32 m0, s59, 16384
    s_add_u32 s51, s51, s64
    buffer_load_dwordx4 v3, s[8:11], s51 offen  lds
    s_add_u32 m0, s59, 17408
    s_add_u32 s51, s51, s66
    buffer_load_dwordx4 v4, s[8:11], s51 offen  lds
    s_add_u32 m0, s59, 18432
    s_add_u32 s51, s51, s66
    buffer_load_dwordx4 v3, s[8:11], s51 offen  lds
    s_add_u32 m0, s59, 19456
    s_add_u32 s51, s51, s66
    buffer_load_dwordx4 v4, s[8:11], s51 offen  lds
    s_add_u32 m0, s59, 20480
    s_add_u32 s51, s51, s66
    buffer_load_dwordx4 v3, s[8:11], s51 offen  lds
    s_add_u32 m0, s59, 21504
    s_add_u32 s51, s51, s66
    buffer_load_dwordx4 v4, s[8:11], s51 offen  lds
    s_add_u32 m0, s59, 22528
    s_add_u32 s51, s51, s66
    buffer_load_dwordx4 v3, s[8:11], s51 offen  lds
    s_add_u32 m0, s59, 23552
    s_add_u32 s51, s51, s66
    buffer_load_dwordx4 v4, s[8:11], s51 offen  lds
    s_add_u32 s59, s59, 24576
    s_cmp_eq_u32 s59, 153600
    s_cselect_b32 s59, 55296, s59
    s_waitcnt vmcnt(20)
    s_barrier
    s_add_u32 m0, s58, 12288
    s_add_u32 s51, s70, 134528
    buffer_load_dwordx4 v6, s[16:19], s51 offen lds
    s_add_u32 m0, s58, 13312
    s_add_u32 s51, s70, 167296
    buffer_load_dwordx4 v7, s[16:19], s51 offen lds
    s_add_u32 m0, s58, 14336
    s_add_u32 s51, s70, 200064
    buffer_load_dwordx4 v6, s[16:19], s51 offen lds
    s_add_u32 m0, s58, 15360
    s_add_u32 s51, s70, 232832
    buffer_load_dwordx4 v7, s[16:19], s51 offen lds
    s_add_u32 s58, s58, 18432
    s_cmp_eq_u32 s58, 55296
    s_cselect_b32 s58, 0, s58
    s_mov_b32 m0, 71680
    s_lshl_b32 s51, 70, s77
    buffer_load_dwordx4 v16, s[12:15], s51 offen  lds
    s_mov_b32 m0, 72704
    s_lshl_b32 s51, 71, s77
    buffer_load_dwordx4 v17, s[12:15], s51 offen  lds
    s_mov_b32 m0, 73728
    s_lshl_b32 s51, 72, s77
    buffer_load_dwordx4 v16, s[12:15], s51 offen  lds
    s_mov_b32 m0, 74752
    s_lshl_b32 s51, 73, s77
    buffer_load_dwordx4 v17, s[12:15], s51 offen  lds
    s_mov_b32 m0, 75776
    s_lshl_b32 s51, 74, s77
    buffer_load_dwordx4 v16, s[12:15], s51 offen  lds
    s_mov_b32 m0, 76800
    s_lshl_b32 s51, 75, s77
    buffer_load_dwordx4 v17, s[12:15], s51 offen  lds
    s_mov_b32 m0, 77824
    s_lshl_b32 s51, 76, s77
    buffer_load_dwordx4 v16, s[12:15], s51 offen  lds
    s_mov_b32 m0, 78848
    s_lshl_b32 s51, 77, s77
    buffer_load_dwordx4 v17, s[12:15], s51 offen  lds
    s_waitcnt vmcnt(20)
    s_barrier
    s_mov_b32 m0, 90112
    s_lshl_b32 s51, 88, s77
    buffer_load_dwordx4 v16, s[12:15], s51 offen  lds
    s_mov_b32 m0, 91136
    s_lshl_b32 s51, 89, s77
    buffer_load_dwordx4 v17, s[12:15], s51 offen  lds
    s_mov_b32 m0, 92160
    s_lshl_b32 s51, 90, s77
    buffer_load_dwordx4 v16, s[12:15], s51 offen  lds
    s_mov_b32 m0, 93184
    s_lshl_b32 s51, 91, s77
    buffer_load_dwordx4 v17, s[12:15], s51 offen  lds
    s_mov_b32 m0, 94208
    s_lshl_b32 s51, 92, s77
    buffer_load_dwordx4 v16, s[12:15], s51 offen  lds
    s_mov_b32 m0, 95232
    s_lshl_b32 s51, 93, s77
    buffer_load_dwordx4 v17, s[12:15], s51 offen  lds
    s_mov_b32 m0, 96256
    s_lshl_b32 s51, 94, s77
    buffer_load_dwordx4 v16, s[12:15], s51 offen  lds
    s_mov_b32 m0, 97280
    s_lshl_b32 s51, 95, s77
    buffer_load_dwordx4 v17, s[12:15], s51 offen  lds
    s_mov_b32 m0, 98304
    s_lshl_b32 s51, 96, s77
    buffer_load_dwordx4 v16, s[12:15], s51 offen  lds
    s_mov_b32 m0, 99328
    s_lshl_b32 s51, 97, s77
    buffer_load_dwordx4 v17, s[12:15], s51 offen  lds
    s_mov_b32 m0, 100352
    s_lshl_b32 s51, 98, s77
    buffer_load_dwordx4 v16, s[12:15], s51 offen  lds
    s_mov_b32 m0, 101376
    s_lshl_b32 s51, 99, s77
    buffer_load_dwordx4 v17, s[12:15], s51 offen  lds
    s_mov_b32 m0, 102400
    s_lshl_b32 s51, 100, s77
    buffer_load_dwordx4 v16, s[12:15], s51 offen  lds
    s_mov_b32 m0, 103424
    s_lshl_b32 s51, 101, s77
    buffer_load_dwordx4 v17, s[12:15], s51 offen  lds
    s_waitcnt vmcnt(22)
    s_barrier
    s_mov_b32 m0, 114688
    s_lshl_b32 s51, 112, s77
    buffer_load_dwordx4 v16, s[12:15], s51 offen  lds
    s_mov_b32 m0, 115712
    s_lshl_b32 s51, 113, s77
    buffer_load_dwordx4 v17, s[12:15], s51 offen  lds
    s_mov_b32 m0, 116736
    s_lshl_b32 s51, 114, s77
    buffer_load_dwordx4 v16, s[12:15], s51 offen  lds
    s_mov_b32 m0, 117760
    s_lshl_b32 s51, 115, s77
    buffer_load_dwordx4 v17, s[12:15], s51 offen  lds
    s_mov_b32 m0, 118784
    s_lshl_b32 s51, 116, s77
    buffer_load_dwordx4 v16, s[12:15], s51 offen  lds
    s_mov_b32 m0, 119808
    s_lshl_b32 s51, 117, s77
    buffer_load_dwordx4 v17, s[12:15], s51 offen  lds
    s_mov_b32 m0, 120832
    s_lshl_b32 s51, 118, s77
    buffer_load_dwordx4 v16, s[12:15], s51 offen  lds
    s_mov_b32 m0, 121856
    s_lshl_b32 s51, 119, s77
    buffer_load_dwordx4 v17, s[12:15], s51 offen  lds
    s_mov_b32 m0, 122880
    s_lshl_b32 s51, 120, s77
    buffer_load_dwordx4 v16, s[12:15], s51 offen  lds
    s_mov_b32 m0, 123904
    s_lshl_b32 s51, 121, s77
    buffer_load_dwordx4 v17, s[12:15], s51 offen  lds
    s_mov_b32 m0, 124928
    s_lshl_b32 s51, 122, s77
    buffer_load_dwordx4 v16, s[12:15], s51 offen  lds
    s_mov_b32 m0, 125952
    s_lshl_b32 s51, 123, s77
    buffer_load_dwordx4 v17, s[12:15], s51 offen  lds
    s_mov_b32 m0, 126976
    s_lshl_b32 s51, 124, s77
    buffer_load_dwordx4 v16, s[12:15], s51 offen  lds
    s_mov_b32 m0, 128000
    s_lshl_b32 s51, 125, s77
    buffer_load_dwordx4 v17, s[12:15], s51 offen  lds
    s_barrier
    s_mov_b32 m0, 13312
    s_lshl_b32 s51, 13, s77
    buffer_load_dwordx4 v17, s[12:15], s51 offen  lds
    s_mov_b32 m0, 14336
    s_lshl_b32 s51, 14, s77
    buffer_load_dwordx4 v16, s[12:15], s51 offen  lds
    s_mov_b32 m0, 15360
    s_lshl_b32 s51, 15, s77
    buffer_load_dwordx4 v17, s[12:15], s51 offen  lds
    s_mov_b32 m0, 16384
    s_lshl_b32 s51, 16, s77
    buffer_load_dwordx4 v16, s[12:15], s51 offen  lds
    s_mov_b32 m0, 17408
    s_lshl_b32 s51, 17, s77
    buffer_load_dwordx4 v17, s[12:15], s51 offen  lds
    s_mov_b32 m0, 129024
    s_lshl_b32 s51, 126, s77
    buffer_load_dwordx4 v16, s[12:15], s51 offen  lds
    s_mov_b32 m0, 130048
    s_lshl_b32 s51, 127, s77
    buffer_load_dwordx4 v17, s[12:15], s51 offen  lds
    s_branch prod_tail_w2
prod_layer_w2:
    s_lshl_b32 s45, s42, 22
    s_lshl_b32 s49, s36, 18
    s_add_u32 s70, s45, s49
    s_sub_u32 s48, s36, 1
    s_max_i32 s48, s48, 0
    s_lshl_b32 s49, s48, 18
    s_add_u32 s71, s45, s49
    s_mov_b32 s58, 0
    s_barrier
    s_mov_b32 s58, 18432
    s_bfe_u32 s79, s80, 0x40004
    s_lshl_b32 s79, s79, 14
    s_add_u32 s79, s79, s70
    s_add_u32 m0, s58, 12288
    s_add_u32 s51, s79, 12288
    buffer_load_dwordx4 v1, s[4:7], s51 offen offset:0 sc1 lds
    buffer_load_dwordx4 v1, s[4:7], s51 offen offset:1024 sc1 lds
    buffer_load_dwordx4 v1, s[4:7], s51 offen offset:2048 sc1 lds
    buffer_load_dwordx4 v1, s[4:7], s51 offen offset:3072 sc1 lds
    s_add_u32 s58, s58, 18432
    s_cmp_eq_u32 s58, 55296
    s_cselect_b32 s58, 0, s58
    s_bfe_u32 s79, s80, 0x40008
    s_lshl_b32 s79, s79, 14
    s_add_u32 s79, s79, s70
    s_add_u32 m0, s58, 12288
    s_add_u32 s51, s79, 12288
    buffer_load_dwordx4 v1, s[4:7], s51 offen offset:0 sc1 lds
    buffer_load_dwordx4 v1, s[4:7], s51 offen offset:1024 sc1 lds
    buffer_load_dwordx4 v1, s[4:7], s51 offen offset:2048 sc1 lds
    buffer_load_dwordx4 v1, s[4:7], s51 offen offset:3072 sc1 lds
    s_add_u32 s58, s58, 18432
    s_cmp_eq_u32 s58, 55296
    s_cselect_b32 s58, 0, s58
    s_waitcnt vmcnt(32)
    s_barrier
    s_bitcmp1_b32 s42, 0
    s_cselect_b32 s12, s34, s32
    s_cselect_b32 s13, s35, s33
    s_cmp_eq_u32 s67, 0
    s_cbranch_scc1 wo_notslow_35
    s_mov_b32 s12, s4
    s_mov_b32 s13, s5
    s_mov_b32 s14, s6
    s_and_b32 s75, s42, 1
    s_lshl_b32 s75, s75, 21
    s_lshl_b32 s49, s39, 17
    s_add_u32 s75, s75, s49
    s_add_u32 s75, s75, 54525952
    v_add_u32 v16, s75, v1
    v_mov_b32 v17, v16
    s_mov_b32 s77, 10
wo_notslow_35:
    s_waitcnt vmcnt(4)
    s_mov_b32 s63, 0
tchk_36:
    ds_read_b128 v[32:35], v1 offset:30720
    ds_read_b128 v[36:39], v1 offset:31744
    ds_read_b128 v[40:43], v1 offset:32768
    ds_read_b128 v[44:47], v1 offset:33792
    s_waitcnt lgkmcnt(0)
    v_max3_u32 v30, v32, v33, v34
    v_max3_u32 v31, v40, v41, v42
    v_max3_u32 v30, v30, v35, v36
    v_max3_u32 v31, v31, v43, v44
    v_max3_u32 v30, v30, v37, v38
    v_max3_u32 v31, v31, v45, v46
    v_max_u32 v30, v30, v39
    v_max_u32 v31, v31, v47
    v_max_u32 v30, v30, v31
    v_cmp_eq_u32 vcc, -1, v30
    s_cbranch_vccz tchk_ok_37
    s_bfe_u32 s79, s80, 0x40004
    s_lshl_b32 s79, s79, 14
    s_add_u32 s79, s79, s70
    s_mov_b32 m0, 30720
    s_add_u32 s51, s79, 12288
    buffer_load_dwordx4 v1, s[4:7], s51 offen offset:0 sc1 lds
    buffer_load_dwordx4 v1, s[4:7], s51 offen offset:1024 sc1 lds
    buffer_load_dwordx4 v1, s[4:7], s51 offen offset:2048 sc1 lds
    buffer_load_dwordx4 v1, s[4:7], s51 offen offset:3072 sc1 lds
    s_waitcnt vmcnt(0)
    s_add_u32 s63, s63, 1
    s_cmp_lt_u32 s63, 20000
    s_cbranch_scc1 tchk_36
    v_mov_b32 v30, 0x110
    s_mov_b32 s63, 16
    buffer_store_dword v30, off, s[24:27], s63
    s_waitcnt vmcnt(0)
tchk_ok_37:
    s_barrier
    s_bfe_u32 s79, s80, 0x4000c
    s_lshl_b32 s79, s79, 14
    s_add_u32 s79, s79, s70
    s_add_u32 m0, s58, 12288
    s_add_u32 s51, s79, 12288
    buffer_load_dwordx4 v1, s[4:7], s51 offen offset:0 sc1 lds
    buffer_load_dwordx4 v1, s[4:7], s51 offen offset:1024 sc1 lds
    buffer_load_dwordx4 v1, s[4:7], s51 offen offset:2048 sc1 lds
    buffer_load_dwordx4 v1, s[4:7], s51 offen offset:3072 sc1 lds
    s_add_u32 s58, s58, 18432
    s_cmp_eq_u32 s58, 55296
    s_cselect_b32 s58, 0, s58
    s_waitcnt vmcnt(4)
    s_mov_b32 s63, 0
    ds_read_b128 v[32:35], v1 offset:49152
    ds_read_b128 v[36:39], v1 offset:50176
    ds_read_b128 v[40:43], v1 offset:51200
    ds_read_b128 v[44:47], v1 offset:52224
    s_bfe_u32 s51, s80, 0x40010
    s_mul_i32 s51, s51, s65
    s_add_u32 m0, s59, 16384
    s_add_u32 s51, s51, s64
    buffer_load_dwordx4 v3, s[8:11], s51 offen  lds
    s_add_u32 m0, s59, 17408
    s_add_u32 s51, s51, s66
    buffer_load_dwordx4 v4, s[8:11], s51 offen  lds
    s_add_u32 m0, s59, 18432
    s_add_u32 s51, s51, s66
    buffer_load_dwordx4 v3, s[8:11], s51 offen  lds
    s_add_u32 m0, s59, 19456
    s_add_u32 s51, s51, s66
    buffer_load_dwordx4 v4, s[8:11], s51 offen  lds
    s_add_u32 m0, s59, 20480
    s_add_u32 s51, s51, s66
    buffer_load_dwordx4 v3, s[8:11], s51 offen  lds
    s_add_u32 m0, s59, 21504
    s_add_u32 s51, s51, s66
    buffer_load_dwordx4 v4, s[8:11], s51 offen  lds
    s_add_u32 m0, s59, 22528
    s_add_u32 s51, s51, s66
    buffer_load_dwordx4 v3, s[8:11], s51 offen  lds
    s_add_u32 m0, s59, 23552
    s_add_u32 s51, s51, s66
    buffer_load_dwordx4 v4, s[8:11], s51 offen  lds
    s_add_u32 s59, s59, 24576
    s_cmp_eq_u32 s59, 153600
    s_cselect_b32 s59, 55296, s59
tchk_38:
    s_waitcnt lgkmcnt(0)
    v_max3_u32 v30, v32, v33, v34
    v_max3_u32 v31, v40, v41, v42
    v_max3_u32 v30, v30, v35, v36
    v_max3_u32 v31, v31, v43, v44
    v_max3_u32 v30, v30, v37, v38
    v_max3_u32 v31, v31, v45, v46
    v_max_u32 v30, v30, v39
    v_max_u32 v31, v31, v47
    v_max_u32 v30, v30, v31
    v_cmp_eq_u32 vcc, -1, v30
    s_cbranch_vccz tchk_ok_39
    s_bfe_u32 s79, s80, 0x40008
    s_lshl_b32 s79, s79, 14
    s_add_u32 s79, s79, s70
    s_mov_b32 m0, 49152
    s_add_u32 s51, s79, 12288
    buffer_load_dwordx4 v1, s[4:7], s51 offen offset:0 sc1 lds
    buffer_load_dwordx4 v1, s[4:7], s51 offen offset:1024 sc1 lds
    buffer_load_dwordx4 v1, s[4:7], s51 offen offset:2048 sc1 lds
    buffer_load_dwordx4 v1, s[4:7], s51 offen offset:3072 sc1 lds
    s_waitcnt vmcnt(0)
    ds_read_b128 v[32:35], v1 offset:49152
    ds_read_b128 v[36:39], v1 offset:50176
    ds_read_b128 v[40:43], v1 offset:51200
    ds_read_b128 v[44:47], v1 offset:52224
    s_add_u32 s63, s63, 1
    s_cmp_lt_u32 s63, 20000
    s_cbranch_scc1 tchk_38
    v_mov_b32 v30, 0x110
    s_mov_b32 s63, 16
    buffer_store_dword v30, off, s[24:27], s63
    s_waitcnt vmcnt(0)
tchk_ok_39:
    s_barrier
    s_bfe_u32 s79, s80, 0x40010
    s_lshl_b32 s79, s79, 14
    s_add_u32 s79, s79, s70
    s_add_u32 m0, s58, 12288
    s_add_u32 s51, s79, 12288
    buffer_load_dwordx4 v1, s[4:7], s51 offen offset:0 sc1 lds
    buffer_load_dwordx4 v1, s[4:7], s51 offen offset:1024 sc1 lds
    buffer_load_dwordx4 v1, s[4:7], s51 offen offset:2048 sc1 lds
    buffer_load_dwordx4 v1, s[4:7], s51 offen offset:3072 sc1 lds
    s_add_u32 s58, s58, 18432
    s_cmp_eq_u32 s58, 55296
    s_cselect_b32 s58, 0, s58
    s_waitcnt vmcnt(12)
    s_mov_b32 s63, 0
    ds_read_b128 v[32:35], v1 offset:12288
    ds_read_b128 v[36:39], v1 offset:13312
    ds_read_b128 v[40:43], v1 offset:14336
    ds_read_b128 v[44:47], v1 offset:15360
    s_bfe_u32 s51, s80, 0x40014
    s_mul_i32 s51, s51, s65
    s_add_u32 m0, s59, 16384
    s_add_u32 s51, s51, s64
    buffer_load_dwordx4 v3, s[8:11], s51 offen  lds
    s_add_u32 m0, s59, 17408
    s_add_u32 s51, s51, s66
    buffer_load_dwordx4 v4, s[8:11], s51 offen  lds
    s_add_u32 m0, s59, 18432
    s_add_u32 s51, s51, s66
    buffer_load_dwordx4 v3, s[8:11], s51 offen  lds
    s_add_u32 m0, s59, 19456
    s_add_u32 s51, s51, s66
    buffer_load_dwordx4 v4, s[8:11], s51 offen  lds
    s_add_u32 m0, s59, 20480
    s_add_u32 s51, s51, s66
    buffer_load_dwordx4 v3, s[8:11], s51 offen  lds
    s_add_u32 m0, s59, 21504
    s_add_u32 s51, s51, s66
    buffer_load_dwordx4 v4, s[8:11], s51 offen  lds
    s_add_u32 m0, s59, 22528
    s_add_u32 s51, s51, s66
    buffer_load_dwordx4 v3, s[8:11], s51 offen  lds
    s_add_u32 m0, s59, 23552
    s_add_u32 s51, s51, s66
    buffer_load_dwordx4 v4, s[8:11], s51 offen  lds
    s_add_u32 s59, s59, 24576
    s_cmp_eq_u32 s59, 153600
    s_cselect_b32 s59, 55296, s59
tchk_40:
    s_waitcnt lgkmcnt(0)
    v_max3_u32 v30, v32, v33, v34
    v_max3_u32 v31, v40, v41, v42
    v_max3_u32 v30, v30, v35, v36
    v_max3_u32 v31, v31, v43, v44
    v_max3_u32 v30, v30, v37, v38
    v_max3_u32 v31, v31, v45, v46
    v_max_u32 v30, v30, v39
    v_max_u32 v31, v31, v47
    v_max_u32 v30, v30, v31
    v_cmp_eq_u32 vcc, -1, v30
    s_cbranch_vccz tchk_ok_41
    s_bfe_u32 s79, s80, 0x4000c
    s_lshl_b32 s79, s79, 14
    s_add_u32 s79, s79, s70
    s_mov_b32 m0, 12288
    s_add_u32 s51, s79, 12288
    buffer_load_dwordx4 v1, s[4:7], s51 offen offset:0 sc1 lds
    buffer_load_dwordx4 v1, s[4:7], s51 offen offset:1024 sc1 lds
    buffer_load_dwordx4 v1, s[4:7], s51 offen offset:2048 sc1 lds
    buffer_load_dwordx4 v1, s[4:7], s51 offen offset:3072 sc1 lds
    s_waitcnt vmcnt(0)
    ds_read_b128 v[32:35], v1 offset:12288
    ds_read_b128 v[36:39], v1 offset:13312
    ds_read_b128 v[40:43], v1 offset:14336
    ds_read_b128 v[44:47], v1 offset:15360
    s_add_u32 s63, s63, 1
    s_cmp_lt_u32 s63, 20000
    s_cbranch_scc1 tchk_40
    v_mov_b32 v30, 0x110
    s_mov_b32 s63, 16
    buffer_store_dword v30, off, s[24:27], s63
    s_waitcnt vmcnt(0)
tchk_ok_41:
    s_barrier
    s_bfe_u32 s79, s80, 0x40014
    s_lshl_b32 s79, s79, 14
    s_add_u32 s79, s79, s70
    s_add_u32 m0, s58, 12288
    s_add_u32 s51, s79, 12288
    buffer_load_dwordx4 v1, s[4:7], s51 offen offset:0 sc1 lds
    buffer_load_dwordx4 v1, s[4:7], s51 offen offset:1024 sc1 lds
    buffer_load_dwordx4 v1, s[4:7], s51 offen offset:2048 sc1 lds
    buffer_load_dwordx4 v1, s[4:7], s51 offen offset:3072 sc1 lds
    s_add_u32 s58, s58, 18432
    s_cmp_eq_u32 s58, 55296
    s_cselect_b32 s58, 0, s58
    s_bfe_u32 s51, s80, 0x40018
    s_mul_i32 s51, s51, s65
    s_add_u32 m0, s59, 16384
    s_add_u32 s51, s51, s64
    buffer_load_dwordx4 v3, s[8:11], s51 offen  lds
    s_add_u32 m0, s59, 17408
    s_add_u32 s51, s51, s66
    buffer_load_dwordx4 v4, s[8:11], s51 offen  lds
    s_add_u32 m0, s59, 18432
    s_add_u32 s51, s51, s66
    buffer_load_dwordx4 v3, s[8:11], s51 offen  lds
    s_add_u32 m0, s59, 19456
    s_add_u32 s51, s51, s66
    buffer_load_dwordx4 v4, s[8:11], s51 offen  lds
    s_add_u32 m0, s59, 20480
    s_add_u32 s51, s51, s66
    buffer_load_dwordx4 v3, s[8:11], s51 offen  lds
    s_add_u32 m0, s59, 21504
    s_add_u32 s51, s51, s66
    buffer_load_dwordx4 v4, s[8:11], s51 offen  lds
    s_add_u32 m0, s59, 22528
    s_add_u32 s51, s51, s66
    buffer_load_dwordx4 v3, s[8:11], s51 offen  lds
    s_add_u32 m0, s59, 23552
    s_add_u32 s51, s51, s66
    buffer_load_dwordx4 v4, s[8:11], s51 offen  lds
    s_add_u32 s59, s59, 24576
    s_cmp_eq_u32 s59, 153600
    s_cselect_b32 s59, 55296, s59
    s_waitcnt vmcnt(20)
    s_barrier
    s_bfe_u32 s79, s80, 0x40018
    s_lshl_b32 s79, s79, 14
    s_add_u32 s79, s79, s70
    s_add_u32 m0, s58, 12288
    s_add_u32 s51, s79, 12288
    buffer_load_dwordx4 v1, s[4:7], s51 offen offset:0 sc1 lds
    buffer_load_dwordx4 v1, s[4:7], s51 offen offset:1024 sc1 lds
    buffer_load_dwordx4 v1, s[4:7], s51 offen offset:2048 sc1 lds
    buffer_load_dwordx4 v1, s[4:7], s51 offen offset:3072 sc1 lds
    s_add_u32 s58, s58, 18432
    s_cmp_eq_u32 s58, 55296
    s_cselect_b32 s58, 0, s58
    s_bfe_u32 s51, s80, 0x4001c
    s_mul_i32 s51, s51, s65
    s_add_u32 m0, s59, 16384
    s_add_u32 s51, s51, s64
    buffer_load_dwordx4 v3, s[8:11], s51 offen  lds
    s_add_u32 m0, s59, 17408
    s_add_u32 s51, s51, s66
    buffer_load_dwordx4 v4, s[8:11], s51 offen  lds
    s_add_u32 m0, s59, 18432
    s_add_u32 s51, s51, s66
    buffer_load_dwordx4 v3, s[8:11], s51 offen  lds
    s_add_u32 m0, s59, 19456
    s_add_u32 s51, s51, s66
    buffer_load_dwordx4 v4, s[8:11], s51 offen  lds
    s_add_u32 m0, s59, 20480
    s_add_u32 s51, s51, s66
    buffer_load_dwordx4 v3, s[8:11], s51 offen  lds
    s_add_u32 m0, s59, 21504
    s_add_u32 s51, s51, s66
    buffer_load_dwordx4 v4, s[8:11], s51 offen  lds
    s_add_u32 m0, s59, 22528
    s_add_u32 s51, s51, s66
    buffer_load_dwordx4 v3, s[8:11], s51 offen  lds
    s_add_u32 m0, s59, 23552
    s_add_u32 s51, s51, s66
    buffer_load_dwordx4 v4, s[8:11], s51 offen  lds
    s_add_u32 s59, s59, 24576
    s_cmp_eq_u32 s59, 153600
    s_cselect_b32 s59, 55296, s59
    s_waitcnt vmcnt(20)
    s_barrier
    s_bfe_u32 s79, s80, 0x4001c
    s_lshl_b32 s79, s79, 14
    s_add_u32 s79, s79, s70
    s_add_u32 m0, s58, 12288
    s_add_u32 s51, s79, 12288
    buffer_load_dwordx4 v1, s[4:7], s51 offen offset:0 sc1 lds
    buffer_load_dwordx4 v1, s[4:7], s51 offen offset:1024 sc1 lds
    buffer_load_dwordx4 v1, s[4:7], s51 offen offset:2048 sc1 lds
    buffer_load_dwordx4 v1, s[4:7], s51 offen offset:3072 sc1 lds
    s_add_u32 s58, s58, 18432
    s_cmp_eq_u32 s58, 55296
    s_cselect_b32 s58, 0, s58
    s_bfe_u32 s51, s81, 0x40000
    s_mul_i32 s51, s51, s65
    s_add_u32 m0, s59, 16384
    s_add_u32 s51, s51, s64
    buffer_load_dwordx4 v3, s[8:11], s51 offen  lds
    s_add_u32 m0, s59, 17408
    s_add_u32 s51, s51, s66
    buffer_load_dwordx4 v4, s[8:11], s51 offen  lds
    s_add_u32 m0, s59, 18432
    s_add_u32 s51, s51, s66
    buffer_load_dwordx4 v3, s[8:11], s51 offen  lds
    s_add_u32 m0, s59, 19456
    s_add_u32 s51, s51, s66
    buffer_load_dwordx4 v4, s[8:11], s51 offen  lds
    s_add_u32 m0, s59, 20480
    s_add_u32 s51, s51, s66
    buffer_load_dwordx4 v3, s[8:11], s51 offen  lds
    s_add_u32 m0, s59, 21504
    s_add_u32 s51, s51, s66
    buffer_load_dwordx4 v4, s[8:11], s51 offen  lds
    s_add_u32 m0, s59, 22528
    s_add_u32 s51, s51, s66
    buffer_load_dwordx4 v3, s[8:11], s51 offen  lds
    s_add_u32 m0, s59, 23552
    s_add_u32 s51, s51, s66
    buffer_load_dwordx4 v4, s[8:11], s51 offen  lds
    s_add_u32 s59, s59, 24576
    s_cmp_eq_u32 s59, 153600
    s_cselect_b32 s59, 55296, s59
    s_waitcnt vmcnt(20)
    s_barrier
    s_bfe_u32 s79, s81, 0x40000
    s_lshl_b32 s79, s79, 14
    s_add_u32 s79, s79, s70
    s_add_u32 m0, s58, 12288
    s_add_u32 s51, s79, 12288
    buffer_load_dwordx4 v1, s[4:7], s51 offen offset:0 sc1 lds
    buffer_load_dwordx4 v1, s[4:7], s51 offen offset:1024 sc1 lds
    buffer_load_dwordx4 v1, s[4:7], s51 offen offset:2048 sc1 lds
    buffer_load_dwordx4 v1, s[4:7], s51 offen offset:3072 sc1 lds
    s_add_u32 s58, s58, 18432
    s_cmp_eq_u32 s58, 55296
    s_cselect_b32 s58, 0, s58
    s_bfe_u32 s51, s81, 0x40004
    s_mul_i32 s51, s51, s65
    s_add_u32 m0, s59, 16384
    s_add_u32 s51, s51, s64
    buffer_load_dwordx4 v3, s[8:11], s51 offen  lds
    s_add_u32 m0, s59, 17408
    s_add_u32 s51, s51, s66
    buffer_load_dwordx4 v4, s[8:11], s51 offen  lds
    s_add_u32 m0, s59, 18432
    s_add_u32 s51, s51, s66
    buffer_load_dwordx4 v3, s[8:11], s51 offen  lds
    s_add_u32 m0, s59, 19456
    s_add_u32 s51, s51, s66
    buffer_load_dwordx4 v4, s[8:11], s51 offen  lds
    s_add_u32 m0, s59, 20480
    s_add_u32 s51, s51, s66
    buffer_load_dwordx4 v3, s[8:11], s51 offen  lds
    s_add_u32 m0, s59, 21504
    s_add_u32 s51, s51, s66
    buffer_load_dwordx4 v4, s[8:11], s51 offen  lds
    s_add_u32 m0, s59, 22528
    s_add_u32 s51, s51, s66
    buffer_load_dwordx4 v3, s[8:11], s51 offen  lds
    s_add_u32 m0, s59, 23552
    s_add_u32 s51, s51, s66
    buffer_load_dwordx4 v4, s[8:11], s51 offen  lds
    s_add_u32 s59, s59, 24576
    s_cmp_eq_u32 s59, 153600
    s_cselect_b32 s59, 55296, s59
    s_waitcnt vmcnt(20)
    s_barrier
    s_bfe_u32 s79, s81, 0x40004
    s_lshl_b32 s79, s79, 14
    s_add_u32 s79, s79, s70
    s_add_u32 m0, s58, 12288
    s_add_u32 s51, s79, 12288
    buffer_load_dwordx4 v1, s[4:7], s51 offen offset:0 sc1 lds
    buffer_load_dwordx4 v1, s[4:7], s51 offen offset:1024 sc1 lds
    buffer_load_dwordx4 v1, s[4:7], s51 offen offset:2048 sc1 lds
    buffer_load_dwordx4 v1, s[4:7], s51 offen offset:3072 sc1 lds
    s_add_u32 s58, s58, 18432
    s_cmp_eq_u32 s58, 55296
    s_cselect_b32 s58, 0, s58
    s_bfe_u32 s51, s81, 0x40008
    s_mul_i32 s51, s51, s65
    s_add_u32 m0, s59, 16384
    s_add_u32 s51, s51, s64
    buffer_load_dwordx4 v3, s[8:11], s51 offen  lds
    s_add_u32 m0, s59, 17408
    s_add_u32 s51, s51, s66
    buffer_load_dwordx4 v4, s[8:11], s51 offen  lds
    s_add_u32 m0, s59, 18432
    s_add_u32 s51, s51, s66
    buffer_load_dwordx4 v3, s[8:11], s51 offen  lds
    s_add_u32 m0, s59, 19456
    s_add_u32 s51, s51, s66
    buffer_load_dwordx4 v4, s[8:11], s51 offen  lds
    s_add_u32 m0, s59, 20480
    s_add_u32 s51, s51, s66
    buffer_load_dwordx4 v3, s[8:11], s51 offen  lds
    s_add_u32 m0, s59, 21504
    s_add_u32 s51, s51, s66
    buffer_load_dwordx4 v4, s[8:11], s51 offen  lds
    s_add_u32 m0, s59, 22528
    s_add_u32 s51, s51, s66
    buffer_load_dwordx4 v3, s[8:11], s51 offen  lds
    s_add_u32 m0, s59, 23552
    s_add_u32 s51, s51, s66
    buffer_load_dwordx4 v4, s[8:11], s51 offen  lds
    s_add_u32 s59, s59, 24576
    s_cmp_eq_u32 s59, 153600
    s_cselect_b32 s59, 55296, s59
    s_waitcnt vmcnt(20)
    s_barrier
    s_bfe_u32 s79, s81, 0x40008
    s_lshl_b32 s79, s79, 14
    s_add_u32 s79, s79, s70
    s_add_u32 m0, s58, 12288
    s_add_u32 s51, s79, 12288
    buffer_load_dwordx4 v1, s[4:7], s51 offen offset:0 sc1 lds
    buffer_load_dwordx4 v1, s[4:7], s51 offen offset:1024 sc1 lds
    buffer_load_dwordx4 v1, s[4:7], s51 offen offset:2048 sc1 lds
    buffer_load_dwordx4 v1, s[4:7], s51 offen offset:3072 sc1 lds
    s_add_u32 s58, s58, 18432
    s_cmp_eq_u32 s58, 55296
    s_cselect_b32 s58, 0, s58
    s_bfe_u32 s51, s81, 0x4000c
    s_mul_i32 s51, s51, s65
    s_add_u32 m0, s59, 16384
    s_add_u32 s51, s51, s64
    buffer_load_dwordx4 v3, s[8:11], s51 offen  lds
    s_add_u32 m0, s59, 17408
    s_add_u32 s51, s51, s66
    buffer_load_dwordx4 v4, s[8:11], s51 offen  lds
    s_add_u32 m0, s59, 18432
    s_add_u32 s51, s51, s66
    buffer_load_dwordx4 v3, s[8:11], s51 offen  lds
    s_add_u32 m0, s59, 19456
    s_add_u32 s51, s51, s66
    buffer_load_dwordx4 v4, s[8:11], s51 offen  lds
    s_add_u32 m0, s59, 20480
    s_add_u32 s51, s51, s66
    buffer_load_dwordx4 v3, s[8:11], s51 offen  lds
    s_add_u32 m0, s59, 21504
    s_add_u32 s51, s51, s66
    buffer_load_dwordx4 v4, s[8:11], s51 offen  lds
    s_add_u32 m0, s59, 22528
    s_add_u32 s51, s51, s66
    buffer_load_dwordx4 v3, s[8:11], s51 offen  lds
    s_add_u32 m0, s59, 23552
    s_add_u32 s51, s51, s66
    buffer_load_dwordx4 v4, s[8:11], s51 offen  lds
    s_add_u32 s59, s59, 24576
    s_cmp_eq_u32 s59, 153600
    s_cselect_b32 s59, 55296, s59
    s_waitcnt vmcnt(20)
    s_barrier
    s_bfe_u32 s79, s81, 0x4000c
    s_lshl_b32 s79, s79, 14
    s_add_u32 s79, s79, s70
    s_add_u32 m0, s58, 12288
    s_add_u32 s51, s79, 12288
    buffer_load_dwordx4 v1, s[4:7], s51 offen offset:0 sc1 lds
    buffer_load_dwordx4 v1, s[4:7], s51 offen offset:1024 sc1 lds
    buffer_load_dwordx4 v1, s[4:7], s51 offen offset:2048 sc1 lds
    buffer_load_dwordx4 v1, s[4:7], s51 offen offset:3072 sc1 lds
    s_add_u32 s58, s58, 18432
    s_cmp_eq_u32 s58, 55296
    s_cselect_b32 s58, 0, s58
    s_bfe_u32 s51, s81, 0x40010
    s_mul_i32 s51, s51, s65
    s_add_u32 m0, s59, 16384
    s_add_u32 s51, s51, s64
    buffer_load_dwordx4 v3, s[8:11], s51 offen  lds
    s_add_u32 m0, s59, 17408
    s_add_u32 s51, s51, s66
    buffer_load_dwordx4 v4, s[8:11], s51 offen  lds
    s_add_u32 m0, s59, 18432
    s_add_u32 s51, s51, s66
    buffer_load_dwordx4 v3, s[8:11], s51 offen  lds
    s_add_u32 m0, s59, 19456
    s_add_u32 s51, s51, s66
    buffer_load_dwordx4 v4, s[8:11], s51 offen  lds
    s_add_u32 m0, s59, 20480
    s_add_u32 s51, s51, s66
    buffer_load_dwordx4 v3, s[8:11], s51 offen  lds
    s_add_u32 m0, s59, 21504
    s_add_u32 s51, s51, s66
    buffer_load_dwordx4 v4, s[8:11], s51 offen  lds
    s_add_u32 m0, s59, 22528
    s_add_u32 s51, s51, s66
    buffer_load_dwordx4 v3, s[8:11], s51 offen  lds
    s_add_u32 m0, s59, 23552
    s_add_u32 s51, s51, s66
    buffer_load_dwordx4 v4, s[8:11], s51 offen  lds
    s_add_u32 s59, s59, 24576
    s_cmp_eq_u32 s59, 153600
    s_cselect_b32 s59, 55296, s59
    s_waitcnt vmcnt(20)
    s_barrier
    s_bfe_u32 s79, s81, 0x40010
    s_lshl_b32 s79, s79, 14
    s_add_u32 s79, s79, s70
    s_add_u32 m0, s58, 12288
    s_add_u32 s51, s79, 12288
    buffer_load_dwordx4 v1, s[4:7], s51 offen offset:0 sc1 lds
    buffer_load_dwordx4 v1, s[4:7], s51 offen offset:1024 sc1 lds
    buffer_load_dwordx4 v1, s[4:7], s51 offen offset:2048 sc1 lds
    buffer_load_dwordx4 v1, s[4:7], s51 offen offset:3072 sc1 lds
    s_add_u32 s58, s58, 18432
    s_cmp_eq_u32 s58, 55296
    s_cselect_b32 s58, 0, s58
    s_bfe_u32 s51, s81, 0x40014
    s_mul_i32 s51, s51, s65
    s_add_u32 m0, s59, 16384
    s_add_u32 s51, s51, s64
    buffer_load_dwordx4 v3, s[8:11], s51 offen  lds
    s_add_u32 m0, s59, 17408
    s_add_u32 s51, s51, s66
    buffer_load_dwordx4 v4, s[8:11], s51 offen  lds
    s_add_u32 m0, s59, 18432
    s_add_u32 s51, s51, s66
    buffer_load_dwordx4 v3, s[8:11], s51 offen  lds
    s_add_u32 m0, s59, 19456
    s_add_u32 s51, s51, s66
    buffer_load_dwordx4 v4, s[8:11], s51 offen  lds
    s_add_u32 m0, s59, 20480
    s_add_u32 s51, s51, s66
    buffer_load_dwordx4 v3, s[8:11], s51 offen  lds
    s_add_u32 m0, s59, 21504
    s_add_u32 s51, s51, s66
    buffer_load_dwordx4 v4, s[8:11], s51 offen  lds
    s_add_u32 m0, s59, 22528
    s_add_u32 s51, s51, s66
    buffer_load_dwordx4 v3, s[8:11], s51 offen  lds
    s_add_u32 m0, s59, 23552
    s_add_u32 s51, s51, s66
    buffer_load_dwordx4 v4, s[8:11], s51 offen  lds
    s_add_u32 s59, s59, 24576
    s_cmp_eq_u32 s59, 153600
    s_cselect_b32 s59, 55296, s59
    s_waitcnt vmcnt(20)
    s_barrier
    s_bfe_u32 s79, s81, 0x40014
    s_lshl_b32 s79, s79, 14
    s_add_u32 s79, s79, s70
    s_add_u32 m0, s58, 12288
    s_add_u32 s51, s79, 12288
    buffer_load_dwordx4 v1, s[4:7], s51 offen offset:0 sc1 lds
    buffer_load_dwordx4 v1, s[4:7], s51 offen offset:1024 sc1 lds
    buffer_load_dwordx4 v1, s[4:7], s51 offen offset:2048 sc1 lds
    buffer_load_dwordx4 v1, s[4:7], s51 offen offset:3072 sc1 lds
    s_add_u32 s58, s58, 18432
    s_cmp_eq_u32 s58, 55296
    s_cselect_b32 s58, 0, s58
    s_bfe_u32 s51, s81, 0x40018
    s_mul_i32 s51, s51, s65
    s_add_u32 m0, s59, 16384
    s_add_u32 s51, s51, s64
    buffer_load_dwordx4 v3, s[8:11], s51 offen  lds
    s_add_u32 m0, s59, 17408
    s_add_u32 s51, s51, s66
    buffer_load_dwordx4 v4, s[8:11], s51 offen  lds
    s_add_u32 m0, s59, 18432
    s_add_u32 s51, s51, s66
    buffer_load_dwordx4 v3, s[8:11], s51 offen  lds
    s_add_u32 m0, s59, 19456
    s_add_u32 s51, s51, s66
    buffer_load_dwordx4 v4, s[8:11], s51 offen  lds
    s_add_u32 m0, s59, 20480
    s_add_u32 s51, s51, s66
    buffer_load_dwordx4 v3, s[8:11], s51 offen  lds
    s_add_u32 m0, s59, 21504
    s_add_u32 s51, s51, s66
    buffer_load_dwordx4 v4, s[8:11], s51 offen  lds
    s_add_u32 m0, s59, 22528
    s_add_u32 s51, s51, s66
    buffer_load_dwordx4 v3, s[8:11], s51 offen  lds
    s_add_u32 m0, s59, 23552
    s_add_u32 s51, s51, s66
    buffer_load_dwordx4 v4, s[8:11], s51 offen  lds
    s_add_u32 s59, s59, 24576
    s_cmp_eq_u32 s59, 153600
    s_cselect_b32 s59, 55296, s59
    s_waitcnt vmcnt(20)
    s_barrier
    s_bfe_u32 s79, s81, 0x40018
    s_lshl_b32 s79, s79, 14
    s_add_u32 s79, s79, s70
    s_add_u32 m0, s58, 12288
    s_add_u32 s51, s79, 12288
    buffer_load_dwordx4 v1, s[4:7], s51 offen offset:0 sc1 lds
    buffer_load_dwordx4 v1, s[4:7], s51 offen offset:1024 sc1 lds
    buffer_load_dwordx4 v1, s[4:7], s51 offen offset:2048 sc1 lds
    buffer_load_dwordx4 v1, s[4:7], s51 offen offset:3072 sc1 lds
    s_add_u32 s58, s58, 18432
    s_cmp_eq_u32 s58, 55296
    s_cselect_b32 s58, 0, s58
    s_bfe_u32 s51, s81, 0x4001c
    s_mul_i32 s51, s51, s65
    s_add_u32 m0, s59, 16384
    s_add_u32 s51, s51, s64
    buffer_load_dwordx4 v3, s[8:11], s51 offen  lds
    s_add_u32 m0, s59, 17408
    s_add_u32 s51, s51, s66
    buffer_load_dwordx4 v4, s[8:11], s51 offen  lds
    s_add_u32 m0, s59, 18432
    s_add_u32 s51, s51, s66
    buffer_load_dwordx4 v3, s[8:11], s51 offen  lds
    s_add_u32 m0, s59, 19456
    s_add_u32 s51, s51, s66
    buffer_load_dwordx4 v4, s[8:11], s51 offen  lds
    s_add_u32 m0, s59, 20480
    s_add_u32 s51, s51, s66
    buffer_load_dwordx4 v3, s[8:11], s51 offen  lds
    s_add_u32 m0, s59, 21504
    s_add_u32 s51, s51, s66
    buffer_load_dwordx4 v4, s[8:11], s51 offen  lds
    s_add_u32 m0, s59, 22528
    s_add_u32 s51, s51, s66
    buffer_load_dwordx4 v3, s[8:11], s51 offen  lds
    s_add_u32 m0, s59, 23552
    s_add_u32 s51, s51, s66
    buffer_load_dwordx4 v4, s[8:11], s51 offen  lds
    s_add_u32 s59, s59, 24576
    s_cmp_eq_u32 s59, 153600
    s_cselect_b32 s59, 55296, s59
    s_waitcnt vmcnt(20)
    s_barrier
    s_bfe_u32 s79, s81, 0x4001c
    s_lshl_b32 s79, s79, 14
    s_add_u32 s79, s79, s70
    s_add_u32 m0, s58, 12288
    s_add_u32 s51, s79, 12288
    buffer_load_dwordx4 v1, s[4:7], s51 offen offset:0 sc1 lds
    buffer_load_dwordx4 v1, s[4:7], s51 offen offset:1024 sc1 lds
    buffer_load_dwordx4 v1, s[4:7], s51 offen offset:2048 sc1 lds
    buffer_load_dwordx4 v1, s[4:7], s51 offen offset:3072 sc1 lds
    s_add_u32 s58, s58, 18432
    s_cmp_eq_u32 s58, 55296
    s_cselect_b32 s58, 0, s58
    s_mov_b32 m0, 71680
    s_lshl_b32 s51, 70, s77
    buffer_load_dwordx4 v16, s[12:15], s51 offen  lds
    s_mov_b32 m0, 72704
    s_lshl_b32 s51, 71, s77
    buffer_load_dwordx4 v17, s[12:15], s51 offen  lds
    s_mov_b32 m0, 73728
    s_lshl_b32 s51, 72, s77
    buffer_load_dwordx4 v16, s[12:15], s51 offen  lds
    s_mov_b32 m0, 74752
    s_lshl_b32 s51, 73, s77
    buffer_load_dwordx4 v17, s[12:15], s51 offen  lds
    s_mov_b32 m0, 75776
    s_lshl_b32 s51, 74, s77
    buffer_load_dwordx4 v16, s[12:15], s51 offen  lds
    s_mov_b32 m0, 76800
    s_lshl_b32 s51, 75, s77
    buffer_load_dwordx4 v17, s[12:15], s51 offen  lds
    s_mov_b32 m0, 77824
    s_lshl_b32 s51, 76, s77
    buffer_load_dwordx4 v16, s[12:15], s51 offen  lds
    s_mov_b32 m0, 78848
    s_lshl_b32 s51, 77, s77
    buffer_load_dwordx4 v17, s[12:15], s51 offen  lds
    s_waitcnt vmcnt(20)
    s_barrier
    s_mov_b32 m0, 90112
    s_lshl_b32 s51, 88, s77
    buffer_load_dwordx4 v16, s[12:15], s51 offen  lds
    s_mov_b32 m0, 91136
    s_lshl_b32 s51, 89, s77
    buffer_load_dwordx4 v17, s[12:15], s51 offen  lds
    s_mov_b32 m0, 92160
    s_lshl_b32 s51, 90, s77
    buffer_load_dwordx4 v16, s[12:15], s51 offen  lds
    s_mov_b32 m0, 93184
    s_lshl_b32 s51, 91, s77
    buffer_load_dwordx4 v17, s[12:15], s51 offen  lds
    s_mov_b32 m0, 94208
    s_lshl_b32 s51, 92, s77
    buffer_load_dwordx4 v16, s[12:15], s51 offen  lds
    s_mov_b32 m0, 95232
    s_lshl_b32 s51, 93, s77
    buffer_load_dwordx4 v17, s[12:15], s51 offen  lds
    s_mov_b32 m0, 96256
    s_lshl_b32 s51, 94, s77
    buffer_load_dwordx4 v16, s[12:15], s51 offen  lds
    s_mov_b32 m0, 97280
    s_lshl_b32 s51, 95, s77
    buffer_load_dwordx4 v17, s[12:15], s51 offen  lds
    s_mov_b32 m0, 98304
    s_lshl_b32 s51, 96, s77
    buffer_load_dwordx4 v16, s[12:15], s51 offen  lds
    s_mov_b32 m0, 99328
    s_lshl_b32 s51, 97, s77
    buffer_load_dwordx4 v17, s[12:15], s51 offen  lds
    s_mov_b32 m0, 100352
    s_lshl_b32 s51, 98, s77
    buffer_load_dwordx4 v16, s[12:15], s51 offen  lds
    s_mov_b32 m0, 101376
    s_lshl_b32 s51, 99, s77
    buffer_load_dwordx4 v17, s[12:15], s51 offen  lds
    s_mov_b32 m0, 102400
    s_lshl_b32 s51, 100, s77
    buffer_load_dwordx4 v16, s[12:15], s51 offen  lds
    s_mov_b32 m0, 103424
    s_lshl_b32 s51, 101, s77
    buffer_load_dwordx4 v17, s[12:15], s51 offen  lds
    s_waitcnt vmcnt(22)
    s_barrier
    s_mov_b32 m0, 114688
    s_lshl_b32 s51, 112, s77
    buffer_load_dwordx4 v16, s[12:15], s51 offen  lds
    s_mov_b32 m0, 115712
    s_lshl_b32 s51, 113, s77
    buffer_load_dwordx4 v17, s[12:15], s51 offen  lds
    s_mov_b32 m0, 116736
    s_lshl_b32 s51, 114, s77
    buffer_load_dwordx4 v16, s[12:15], s51 offen  lds
    s_mov_b32 m0, 117760
    s_lshl_b32 s51, 115, s77
    buffer_load_dwordx4 v17, s[12:15], s51 offen  lds
    s_mov_b32 m0, 118784
    s_lshl_b32 s51, 116, s77
    buffer_load_dwordx4 v16, s[12:15], s51 offen  lds
    s_mov_b32 m0, 119808
    s_lshl_b32 s51, 117, s77
    buffer_load_dwordx4 v17, s[12:15], s51 offen  lds
    s_mov_b32 m0, 120832
    s_lshl_b32 s51, 118, s77
    buffer_load_dwordx4 v16, s[12:15], s51 offen  lds
    s_mov_b32 m0, 121856
    s_lshl_b32 s51, 119, s77
    buffer_load_dwordx4 v17, s[12:15], s51 offen  lds
    s_mov_b32 m0, 122880
    s_lshl_b32 s51, 120, s77
    buffer_load_dwordx4 v16, s[12:15], s51 offen  lds
    s_mov_b32 m0, 123904
    s_lshl_b32 s51, 121, s77
    buffer_load_dwordx4 v17, s[12:15], s51 offen  lds
    s_mov_b32 m0, 124928
    s_lshl_b32 s51, 122, s77
    buffer_load_dwordx4 v16, s[12:15], s51 offen  lds
    s_mov_b32 m0, 125952
    s_lshl_b32 s51, 123, s77
    buffer_load_dwordx4 v17, s[12:15], s51 offen  lds
    s_mov_b32 m0, 126976
    s_lshl_b32 s51, 124, s77
    buffer_load_dwordx4 v16, s[12:15], s51 offen  lds
    s_mov_b32 m0, 128000
    s_lshl_b32 s51, 125, s77
    buffer_load_dwordx4 v17, s[12:15], s51 offen  lds
    s_barrier
    s_mov_b32 m0, 13312
    s_lshl_b32 s51, 13, s77
    buffer_load_dwordx4 v17, s[12:15], s51 offen  lds
    s_mov_b32 m0, 14336
    s_lshl_b32 s51, 14, s77
    buffer_load_dwordx4 v16, s[12:15], s51 offen  lds
    s_mov_b32 m0, 15360
    s_lshl_b32 s51, 15, s77
    buffer_load_dwordx4 v17, s[12:15], s51 offen  lds
    s_mov_b32 m0, 16384
    s_lshl_b32 s51, 16, s77
    buffer_load_dwordx4 v16, s[12:15], s51 offen  lds
    s_mov_b32 m0, 17408
    s_lshl_b32 s51, 17, s77
    buffer_load_dwordx4 v17, s[12:15], s51 offen  lds
    s_mov_b32 m0, 129024
    s_lshl_b32 s51, 126, s77
    buffer_load_dwordx4 v16, s[12:15], s51 offen  lds
    s_mov_b32 m0, 130048
    s_lshl_b32 s51, 127, s77
    buffer_load_dwordx4 v17, s[12:15], s51 offen  lds
prod_tail_w2:
    s_waitcnt vmcnt(0)
    s_barrier
    s_cmp_eq_u32 s42, 3
    s_cbranch_scc1 prod_end_w2
    s_add_u32 s42, s42, 1
    s_bitcmp1_b32 s42, 0
    s_cselect_b32 s8, s30, s28
    s_cselect_b32 s9, s31, s29
    s_cmp_eq_u32 s67, 0
    s_cbranch_scc1 notslow_42
    s_mov_b32 s8, s4
    s_mov_b32 s9, s5
    s_mov_b32 s10, s6
    s_mov_b32 s65, 24576
    s_mov_b32 s66, 1024
    v_mov_b32 v3, v1
    v_mov_b32 v4, v1
    s_and_b32 s64, s42, 1
    s_mul_i32 s64, s64, 6291456
    s_mul_i32 s49, s37, 393216
    s_add_u32 s64, s64, s49
    s_add_u32 s64, s64, 41959424
notslow_42:
    s_barrier
    s_mov_b32 s59, 55296
    s_bfe_u32 s51, s80, 0x40000
    s_mul_i32 s51, s51, s65
    s_add_u32 m0, s59, 16384
    s_add_u32 s51, s51, s64
    buffer_load_dwordx4 v3, s[8:11], s51 offen  lds
    s_add_u32 m0, s59, 17408
    s_add_u32 s51, s51, s66
    buffer_load_dwordx4 v4, s[8:11], s51 offen  lds
    s_add_u32 m0, s59, 18432
    s_add_u32 s51, s51, s66
    buffer_load_dwordx4 v3, s[8:11], s51 offen  lds
    s_add_u32 m0, s59, 19456
    s_add_u32 s51, s51, s66
    buffer_load_dwordx4 v4, s[8:11], s51 offen  lds
    s_add_u32 m0, s59, 20480
    s_add_u32 s51, s51, s66
    buffer_load_dwordx4 v3, s[8:11], s51 offen  lds
    s_add_u32 m0, s59, 21504
    s_add_u32 s51, s51, s66
    buffer_load_dwordx4 v4, s[8:11], s51 offen  lds
    s_add_u32 m0, s59, 22528
    s_add_u32 s51, s51, s66
    buffer_load_dwordx4 v3, s[8:11], s51 offen  lds
    s_add_u32 m0, s59, 23552
    s_add_u32 s51, s51, s66
    buffer_load_dwordx4 v4, s[8:11], s51 offen  lds
    s_add_u32 s59, s59, 24576
    s_cmp_eq_u32 s59, 153600
    s_cselect_b32 s59, 55296, s59
    s_bfe_u32 s51, s80, 0x40004
    s_mul_i32 s51, s51, s65
    s_add_u32 m0, s59, 16384
    s_add_u32 s51, s51, s64
    buffer_load_dwordx4 v3, s[8:11], s51 offen  lds
    s_add_u32 m0, s59, 17408
    s_add_u32 s51, s51, s66
    buffer_load_dwordx4 v4, s[8:11], s51 offen  lds
    s_add_u32 m0, s59, 18432
    s_add_u32 s51, s51, s66
    buffer_load_dwordx4 v3, s[8:11], s51 offen  lds
    s_add_u32 m0, s59, 19456
    s_add_u32 s51, s51, s66
    buffer_load_dwordx4 v4, s[8:11], s51 offen  lds
    s_add_u32 m0, s59, 20480
    s_add_u32 s51, s51, s66
    buffer_load_dwordx4 v3, s[8:11], s51 offen  lds
    s_add_u32 m0, s59, 21504
    s_add_u32 s51, s51, s66
    buffer_load_dwordx4 v4, s[8:11], s51 offen  lds
    s_add_u32 m0, s59, 22528
    s_add_u32 s51, s51, s66
    buffer_load_dwordx4 v3, s[8:11], s51 offen  lds
    s_add_u32 m0, s59, 23552
    s_add_u32 s51, s51, s66
    buffer_load_dwordx4 v4, s[8:11], s51 offen  lds
    s_add_u32 s59, s59, 24576
    s_cmp_eq_u32 s59, 153600
    s_cselect_b32 s59, 55296, s59
    s_bfe_u32 s51, s80, 0x40008
    s_mul_i32 s51, s51, s65
    s_add_u32 m0, s59, 16384
    s_add_u32 s51, s51, s64
    buffer_load_dwordx4 v3, s[8:11], s51 offen  lds
    s_add_u32 m0, s59, 17408
    s_add_u32 s51, s51, s66
    buffer_load_dwordx4 v4, s[8:11], s51 offen  lds
    s_add_u32 m0, s59, 18432
    s_add_u32 s51, s51, s66
    buffer_load_dwordx4 v3, s[8:11], s51 offen  lds
    s_add_u32 m0, s59, 19456
    s_add_u32 s51, s51, s66
    buffer_load_dwordx4 v4, s[8:11], s51 offen  lds
    s_add_u32 m0, s59, 20480
    s_add_u32 s51, s51, s66
    buffer_load_dwordx4 v3, s[8:11], s51 offen  lds
    s_add_u32 m0, s59, 21504
    s_add_u32 s51, s51, s66
    buffer_load_dwordx4 v4, s[8:11], s51 offen  lds
    s_add_u32 m0, s59, 22528
    s_add_u32 s51, s51, s66
    buffer_load_dwordx4 v3, s[8:11], s51 offen  lds
    s_add_u32 m0, s59, 23552
    s_add_u32 s51, s51, s66
    buffer_load_dwordx4 v4, s[8:11], s51 offen  lds
    s_add_u32 s59, s59, 24576
    s_cmp_eq_u32 s59, 153600
    s_cselect_b32 s59, 55296, s59
    s_bfe_u32 s51, s80, 0x4000c
    s_mul_i32 s51, s51, s65
    s_add_u32 m0, s59, 16384
    s_add_u32 s51, s51, s64
    buffer_load_dwordx4 v3, s[8:11], s51 offen  lds
    s_add_u32 m0, s59, 17408
    s_add_u32 s51, s51, s66
    buffer_load_dwordx4 v4, s[8:11], s51 offen  lds
    s_add_u32 m0, s59, 18432
    s_add_u32 s51, s51, s66
    buffer_load_dwordx4 v3, s[8:11], s51 offen  lds
    s_add_u32 m0, s59, 19456
    s_add_u32 s51, s51, s66
    buffer_load_dwordx4 v4, s[8:11], s51 offen  lds
    s_add_u32 m0, s59, 20480
    s_add_u32 s51, s51, s66
    buffer_load_dwordx4 v3, s[8:11], s51 offen  lds
    s_add_u32 m0, s59, 21504
    s_add_u32 s51, s51, s66
    buffer_load_dwordx4 v4, s[8:11], s51 offen  lds
    s_add_u32 m0, s59, 22528
    s_add_u32 s51, s51, s66
    buffer_load_dwordx4 v3, s[8:11], s51 offen  lds
    s_add_u32 m0, s59, 23552
    s_add_u32 s51, s51, s66
    buffer_load_dwordx4 v4, s[8:11], s51 offen  lds
    s_add_u32 s59, s59, 24576
    s_cmp_eq_u32 s59, 153600
    s_cselect_b32 s59, 55296, s59
    s_branch prod_layer_w2
prod_end_w2:
    s_endpgm
prod_w3:
    v_and_b32 v9, 63, v0
    v_lshrrev_b32 v10, 3, v9
    v_and_b32 v11, 7, v9
    v_lshrrev_b32 v12, 4, v9
    v_and_b32 v13, 15, v9
    v_lshlrev_b32 v1, 4, v9
    v_mul_u32_u24 v15, 6144, v10
    v_lshl_add_u32 v18, v11, 4, v15
    v_lshlrev_b32 v15, 11, v10
    v_lshl_add_u32 v19, v11, 4, v15
    s_lshl_b32 s45, s36, 3
    s_and_b32 s49, s37, 7
    s_add_u32 s45, s45, s49
    s_mul_i32 s45, s45, 49152
    s_and_b32 s49, s37, 8
    s_lshl_b32 s49, s49, 7
    s_add_u32 s45, s45, s49
    s_add_u32 s51, s45, 384
    buffer_load_dwordx4 v[104:107], v18, s[8:11], s51 offen
    s_add_u32 s51, s45, 2432
    buffer_load_dwordx4 v[108:111], v18, s[8:11], s51 offen
    s_add_u32 s51, s45, 4480
    buffer_load_dwordx4 v[112:115], v18, s[8:11], s51 offen
    s_mov_b32 s12, s32
    s_mov_b32 s13, s33
    s_lshl_b32 s45, s36, 3
    s_and_b32 s49, s37, 7
    s_add_u32 s45, s45, s49
    s_lshl_b32 s45, s45, 14
    s_and_b32 s49, s37, 8
    s_lshl_b32 s49, s49, 7
    s_add_u32 s45, s45, s49
    s_add_u32 s51, s45, 384
    buffer_load_dwordx4 v[116:119], v19, s[12:15], s51 offen
    s_and_b32 s67, s37, 7
    s_cmp_eq_u32 s67, 3
    s_cselect_b32 s67, 1, 0
    s_mov_b32 s20, s30
    s_mov_b32 s21, s31
    s_mov_b32 s22, 6291456
    v_and_b32 v14, 1, v12
    v_or_b32 v14, 0, v14
    v_lshlrev_b32 v14, 1, v14
    v_xor_b32 v14, v14, v11
    v_lshlrev_b32 v14, 4, v14
    v_lshl_add_u32 v6, v10, 7, v14
    v_and_b32 v14, 1, v12
    v_or_b32 v14, 2, v14
    v_lshlrev_b32 v14, 1, v14
    v_xor_b32 v14, v14, v11
    v_lshlrev_b32 v14, 4, v14
    v_lshl_add_u32 v7, v10, 7, v14
    s_bitcmp1_b32 s37, 0
    s_cselect_b64 vcc, -1, 0
    v_cndmask_b32 v16, v6, v7, vcc
    v_lshlrev_b32 v14, 9, v12
    v_lshl_add_u32 v17, v13, 2, v14
    v_lshlrev_b32 v14, 7, v12
    v_lshl_add_u32 v5, v13, 2, v14
    v_lshlrev_b32 v14, 10, v12
    v_lshl_add_u32 v2, v13, 4, v14
    v_and_b32 v14, 3, v11
    v_lshlrev_b32 v14, 4, v14
    v_lshrrev_b32 v15, 2, v11
    v_lshlrev_b32 v15, 9, v15
    v_add_u32 v14, v14, v15
    v_lshl_add_u32 v14, v10, 10, v14
    v_add_u32 v3, 448, v14
    s_lshl_b32 s74, s37, 9
    s_lshl_b32 s49, s36, 2
    s_add_u32 s74, s74, s49
    s_add_u32 s74, s74, 35667968
    s_waitcnt lgkmcnt(0)
    s_add_u32 s43, s43, 256
    s_add_u32 s44, s43, 1
    v_mov_b32 v240, -1
    v_mov_b32 v241, -1
    v_mov_b32 v242, -1
    v_mov_b32 v243, -1
    s_lshl_b32 s79, s36, 7
    s_sub_u32 s48, s36, 1
    s_max_i32 s48, s48, 0
    s_sub_u32 s48, s36, s48
    s_lshl_b32 s48, s48, 7
    s_mov_b32 s48, 0
    v_and_b32 v14, 1, v12
    v_mul_u32_u24 v14, s48, v14
    v_lshlrev_b32 v15, 2, v13
    v_add_u32 v15, s79, v15
    v_sub_u32 v29, v15, v14
    s_lshl_b32 s49, s37, 2
    s_add_u32 s79, s79, s49
    s_add_u32 s79, s79, 35676160
    v_and_b32 v14, 1, v11
    v_lshlrev_b32 v14, 4, v14
    v_mov_b32 v15, 0x3f80
    v_lshlrev_b32 v14, v14, v15
    v_lshrrev_b32 v15, 1, v11
    v_cmp_eq_u32 vcc, 0, v15
    s_nop 1
    v_cndmask_b32 v244, 0, v14, vcc
    v_cmp_eq_u32 vcc, 1, v15
    s_nop 1
    v_cndmask_b32 v245, 0, v14, vcc
    v_cmp_eq_u32 vcc, 2, v15
    s_nop 1
    v_cndmask_b32 v246, 0, v14, vcc
    v_cmp_eq_u32 vcc, 3, v15
    s_nop 1
    v_cndmask_b32 v247, 0, v14, vcc
    v_and_b32 v14, 1, v12
    v_lshlrev_b32 v14, 4, v14
    v_lshl_add_u32 v28, v11, 5, v14
    v_lshlrev_b32 v26, 3, v9
    v_add_u32 v26, 157696, v26
    v_lshrrev_b32 v14, 5, v9
    v_lshlrev_b32 v14, 2, v14
    v_lshl_add_u32 v14, v11, 3, v14
    v_add_u32 v27, 158208, v14
    s_and_b32 s45, s37, 8
    s_mul_i32 s45, s45, 393216
    s_mul_i32 s49, s36, 24576
    s_add_u32 s45, s45, s49
    s_and_b32 s49, s37, 7
    s_lshl_b32 s49, s49, 10
    s_add_u32 s45, s45, s49
    s_waitcnt vmcnt(0)
    s_add_u32 s51, s45, 43122688
    buffer_store_dwordx4 v[104:107], v16, s[4:7], s51 offen sc1
    s_add_u32 s51, s45, 43130880
    buffer_store_dwordx4 v[108:111], v16, s[4:7], s51 offen sc1
    s_add_u32 s51, s45, 43139072
    buffer_store_dwordx4 v[112:115], v16, s[4:7], s51 offen sc1
    s_and_b32 s45, s37, 8
    s_lshl_b32 s45, s45, 17
    s_lshl_b32 s49, s36, 13
    s_add_u32 s45, s45, s49
    s_and_b32 s49, s37, 7
    s_lshl_b32 s49, s49, 10
    s_add_u32 s45, s45, s49
    s_add_u32 s51, s45, 54919168
    buffer_store_dwordx4 v[116:119], v16, s[4:7], s51 offen sc1
    s_barrier
    s_lshl_b32 s45, s36, 18
    s_lshl_b32 s49, s37, 11
    s_add_u32 s77, s45, s49
    s_add_u32 s77, s77, 16777216
    s_and_b32 s49, s37, 12
    s_lshr_b32 s49, 30292, s49
    s_and_b32 s49, s49, 15
    s_lshl_b32 s49, s49, 14
    s_add_u32 s78, s45, s49
    s_and_b32 s49, s37, 3
    s_lshl_b32 s49, s49, 12
    s_add_u32 s78, s78, s49
    s_add_u32 s78, s78, 4194304
    s_waitcnt vmcnt(0)
    s_add_u32 s46, s43, 1
    v_mov_b32 v20, s46
    s_mov_b64 exec, 1
    buffer_store_dword v20, off, s[4:7], s74 sc1
    s_mov_b64 exec, -1
    s_mul_i32 s45, s36, 393216
    s_lshl_b32 s49, s37, 7
    s_add_u32 s45, s45, s49
    s_add_u32 s51, s45, 0
    buffer_load_dwordx4 v[128:131], v18, s[8:11], s51 offen
    s_add_u32 s51, s45, 49152
    buffer_load_dwordx4 v[132:135], v18, s[8:11], s51 offen
    s_add_u32 s51, s45, 98304
    buffer_load_dwordx4 v[136:139], v18, s[8:11], s51 offen
    s_add_u32 s51, s45, 147456
    buffer_load_dwordx4 v[140:143], v18, s[8:11], s51 offen
    s_add_u32 s51, s45, 196608
    buffer_load_dwordx4 v[144:147], v18, s[8:11], s51 offen
    s_add_u32 s51, s45, 245760
    buffer_load_dwordx4 v[148:151], v18, s[8:11], s51 offen
    s_add_u32 s51, s45, 294912
    buffer_load_dwordx4 v[152:155], v18, s[8:11], s51 offen
    s_add_u32 s51, s45, 344064
    buffer_load_dwordx4 v[156:159], v18, s[8:11], s51 offen
    s_barrier
    s_mul_i32 s45, s36, 393216
    s_lshl_b32 s49, s37, 7
    s_add_u32 s45, s45, s49
    s_add_u32 s51, s45, 2048
    buffer_load_dwordx4 v[160:163], v18, s[8:11], s51 offen
    s_add_u32 s51, s45, 51200
    buffer_load_dwordx4 v[164:167], v18, s[8:11], s51 offen
    s_add_u32 s51, s45, 100352
    buffer_load_dwordx4 v[168:171], v18, s[8:11], s51 offen
    s_add_u32 s51, s45, 149504
    buffer_load_dwordx4 v[172:175], v18, s[8:11], s51 offen
    s_add_u32 s51, s45, 198656
    buffer_load_dwordx4 v[176:179], v18, s[8:11], s51 offen
    s_add_u32 s51, s45, 247808
    buffer_load_dwordx4 v[180:183], v18, s[8:11], s51 offen
    s_add_u32 s51, s45, 296960
    buffer_load_dwordx4 v[184:187], v18, s[8:11], s51 offen
    s_add_u32 s51, s45, 346112
    buffer_load_dwordx4 v[188:191], v18, s[8:11], s51 offen
    s_barrier
    s_waitcnt vmcnt(8)
    v_mfma_f32_16x16x32_bf16 v[224:227], v[244:247], v[128:131], 0
    v_mfma_f32_16x16x32_bf16 v[224:227], v[244:247], v[132:135], v[224:227]
    v_mfma_f32_16x16x32_bf16 v[224:227], v[244:247], v[136:139], v[224:227]
    v_mfma_f32_16x16x32_bf16 v[224:227], v[244:247], v[140:143], v[224:227]
    v_mfma_f32_16x16x32_bf16 v[224:227], v[244:247], v[144:147], v[224:227]
    v_mfma_f32_16x16x32_bf16 v[224:227], v[244:247], v[148:151], v[224:227]
    v_mfma_f32_16x16x32_bf16 v[224:227], v[244:247], v[152:155], v[224:227]
    v_mfma_f32_16x16x32_bf16 v[224:227], v[244:247], v[156:159], v[224:227]
    s_lshl_b32 s45, s37, 14
    s_lshl_b32 s49, s36, 10
    s_add_u32 s45, s45, s49
    s_add_u32 s45, s45, 34603008
    s_nop 3
    v_add_f32_dpp v224, v224, v224 row_ror:8 row_mask:0xf bank_mask:0xf
    v_add_f32_dpp v225, v225, v225 row_ror:8 row_mask:0xf bank_mask:0xf
    v_add_f32_dpp v226, v226, v226 row_ror:8 row_mask:0xf bank_mask:0xf
    v_add_f32_dpp v227, v227, v227 row_ror:8 row_mask:0xf bank_mask:0xf
    buffer_store_dwordx4 v[224:227], v28, s[4:7], s45 offen sc1
    s_mul_i32 s45, s36, 393216
    s_lshl_b32 s49, s37, 7
    s_add_u32 s45, s45, s49
    s_add_u32 s51, s45, 4096
    buffer_load_dwordx4 v[192:195], v18, s[8:11], s51 offen
    s_add_u32 s51, s45, 53248
    buffer_load_dwordx4 v[196:199], v18, s[8:11], s51 offen
    s_add_u32 s51, s45, 102400
    buffer_load_dwordx4 v[200:203], v18, s[8:11], s51 offen
    s_add_u32 s51, s45, 151552
    buffer_load_dwordx4 v[204:207], v18, s[8:11], s51 offen
    s_add_u32 s51, s45, 200704
    buffer_load_dwordx4 v[208:211], v18, s[8:11], s51 offen
    s_add_u32 s51, s45, 249856
    buffer_load_dwordx4 v[212:215], v18, s[8:11], s51 offen
    s_add_u32 s51, s45, 299008
    buffer_load_dwordx4 v[216:219], v18, s[8:11], s51 offen
    s_add_u32 s51, s45, 348160
    buffer_load_dwordx4 v[220:223], v18, s[8:11], s51 offen
    s_cmp_eq_u32 s67, 0
    s_cbranch_scc1 wide_skip_43
    s_add_u32 s46, s43, 1
    s_and_b32 s45, s37, 8
    s_lshl_b32 s45, s45, 9
    s_add_u32 s45, s45, 35667968
    s_add_u32 s47, s45, 2048
    s_mov_b32 s63, 0
poll_44:
    buffer_load_dword v22, v17, s[4:7], s45 offen sc1
    buffer_load_dword v23, v17, s[4:7], s47 offen sc1
    s_waitcnt vmcnt(0)
    v_subrev_u32 v22, s46, v22
    v_subrev_u32 v23, s46, v23
    v_max_u32 v22, v22, v23
    v_cmp_gt_u32 vcc, 8, v22
    s_nop 0
    s_cmp_eq_u64 vcc, -1
    s_cbranch_scc1 polled_45
    s_add_u32 s63, s63, 1
    s_cmp_lt_u32 s63, 20000
    s_cbranch_scc1 poll_44
    v_mov_b32 v22, 771
    s_mov_b32 s63, 16
    buffer_store_dword v22, off, s[24:27], s63
polled_45:
wide_skip_43:
    s_barrier
    s_waitcnt vmcnt(9)
    v_mfma_f32_16x16x32_bf16 v[224:227], v[244:247], v[160:163], 0
    v_mfma_f32_16x16x32_bf16 v[224:227], v[244:247], v[164:167], v[224:227]
    v_mfma_f32_16x16x32_bf16 v[224:227], v[244:247], v[168:171], v[224:227]
    v_mfma_f32_16x16x32_bf16 v[224:227], v[244:247], v[172:175], v[224:227]
    v_mfma_f32_16x16x32_bf16 v[224:227], v[244:247], v[176:179], v[224:227]
    v_mfma_f32_16x16x32_bf16 v[224:227], v[244:247], v[180:183], v[224:227]
    v_mfma_f32_16x16x32_bf16 v[224:227], v[244:247], v[184:187], v[224:227]
    v_mfma_f32_16x16x32_bf16 v[224:227], v[244:247], v[188:191], v[224:227]
    s_lshl_b32 s45, s37, 14
    s_lshl_b32 s49, s36, 10
    s_add_u32 s45, s45, s49
    s_add_u32 s45, s45, 34603264
    s_nop 3
    v_add_f32_dpp v224, v224, v224 row_ror:8 row_mask:0xf bank_mask:0xf
    v_add_f32_dpp v225, v225, v225 row_ror:8 row_mask:0xf bank_mask:0xf
    v_add_f32_dpp v226, v226, v226 row_ror:8 row_mask:0xf bank_mask:0xf
    v_add_f32_dpp v227, v227, v227 row_ror:8 row_mask:0xf bank_mask:0xf
    buffer_store_dwordx4 v[224:227], v28, s[4:7], s45 offen sc1
    s_add_u32 s51, s77, 0
    buffer_store_dwordx4 v[240:243], v1, s[4:7], s51 offen offset:0 sc1
    buffer_store_dwordx4 v[240:243], v1, s[4:7], s51 offen offset:1024 sc1
    s_add_u32 s51, s77, 32768
    buffer_store_dwordx4 v[240:243], v1, s[4:7], s51 offen offset:0 sc1
    buffer_store_dwordx4 v[240:243], v1, s[4:7], s51 offen offset:1024 sc1
    s_mul_i32 s45, s36, 393216
    s_lshl_b32 s49, s37, 7
    s_add_u32 s45, s45, s49
    s_add_u32 s51, s45, 0
    buffer_load_dwordx4 v[128:131], v18, s[20:23], s51 offen
    s_add_u32 s51, s45, 49152
    buffer_load_dwordx4 v[132:135], v18, s[20:23], s51 offen
    s_add_u32 s51, s45, 98304
    buffer_load_dwordx4 v[136:139], v18, s[20:23], s51 offen
    s_lshl_b32 s49, s36, 17
    s_max_u32 s49, s49, 131072
    s_sub_u32 s49, s49, 131072
    s_lshl_b32 s45, s37, 13
    s_add_u32 s45, s45, s49
    s_add_u32 s45, s45, 58720256
    v_lshlrev_b32 v20, 7, v9
    buffer_load_dword v31, v20, s[4:7], s45 offen sc1
    s_barrier
    s_waitcnt vmcnt(9)
    v_mfma_f32_16x16x32_bf16 v[224:227], v[244:247], v[192:195], 0
    v_mfma_f32_16x16x32_bf16 v[224:227], v[244:247], v[196:199], v[224:227]
    v_mfma_f32_16x16x32_bf16 v[224:227], v[244:247], v[200:203], v[224:227]
    v_mfma_f32_16x16x32_bf16 v[224:227], v[244:247], v[204:207], v[224:227]
    v_mfma_f32_16x16x32_bf16 v[224:227], v[244:247], v[208:211], v[224:227]
    v_mfma_f32_16x16x32_bf16 v[224:227], v[244:247], v[212:215], v[224:227]
    v_mfma_f32_16x16x32_bf16 v[224:227], v[244:247], v[216:219], v[224:227]
    v_mfma_f32_16x16x32_bf16 v[224:227], v[244:247], v[220:223], v[224:227]
    s_lshl_b32 s45, s37, 14
    s_lshl_b32 s49, s36, 10
    s_add_u32 s45, s45, s49
    s_add_u32 s45, s45, 34603520
    s_nop 3
    v_add_f32_dpp v224, v224, v224 row_ror:8 row_mask:0xf bank_mask:0xf
    v_add_f32_dpp v225, v225, v225 row_ror:8 row_mask:0xf bank_mask:0xf
    v_add_f32_dpp v226, v226, v226 row_ror:8 row_mask:0xf bank_mask:0xf
    v_add_f32_dpp v227, v227, v227 row_ror:8 row_mask:0xf bank_mask:0xf
    buffer_store_dwordx4 v[224:227], v28, s[4:7], s45 offen sc1
    s_add_u32 s51, s77, 65536
    buffer_store_dwordx4 v[240:243], v1, s[4:7], s51 offen offset:0 sc1
    buffer_store_dwordx4 v[240:243], v1, s[4:7], s51 offen offset:1024 sc1
    s_add_u32 s51, s77, 98304
    buffer_store_dwordx4 v[240:243], v1, s[4:7], s51 offen offset:0 sc1
    buffer_store_dwordx4 v[240:243], v1, s[4:7], s51 offen offset:1024 sc1
    s_mul_i32 s45, s36, 393216
    s_lshl_b32 s49, s37, 7
    s_add_u32 s45, s45, s49
    s_add_u32 s51, s45, 147456
    buffer_load_dwordx4 v[140:143], v18, s[20:23], s51 offen
    s_add_u32 s51, s45, 196608
    buffer_load_dwordx4 v[144:147], v18, s[20:23], s51 offen
    s_add_u32 s51, s45, 245760
    buffer_load_dwordx4 v[148:151], v18, s[20:23], s51 offen
    s_barrier
    s_waitcnt vmcnt(7)
    s_add_u32 s46, s43, 2
    v_mov_b32 v20, s46
    s_mov_b64 exec, 1
    buffer_store_dword v20, off, s[4:7], s74 sc1
    s_mov_b64 exec, -1
    s_add_u32 s51, s77, 131072
    buffer_store_dwordx4 v[240:243], v1, s[4:7], s51 offen offset:0 sc1
    buffer_store_dwordx4 v[240:243], v1, s[4:7], s51 offen offset:1024 sc1
    s_add_u32 s51, s77, 163840
    buffer_store_dwordx4 v[240:243], v1, s[4:7], s51 offen offset:0 sc1
    buffer_store_dwordx4 v[240:243], v1, s[4:7], s51 offen offset:1024 sc1
    s_mul_i32 s45, s36, 393216
    s_lshl_b32 s49, s37, 7
    s_add_u32 s45, s45, s49
    s_add_u32 s51, s45, 294912
    buffer_load_dwordx4 v[152:155], v18, s[20:23], s51 offen
    s_add_u32 s51, s45, 344064
    buffer_load_dwordx4 v[156:159], v18, s[20:23], s51 offen
    s_mul_i32 s45, s36, 393216
    s_lshl_b32 s49, s37, 7
    s_add_u32 s45, s45, s49
    s_add_u32 s51, s45, 2048
    buffer_load_dwordx4 v[160:163], v18, s[20:23], s51 offen
    s_barrier
    s_lshl_b32 s45, s37, 9
    s_add_u32 s45, s45, 35667968
    buffer_load_dword v25, v5, s[4:7], s45 offen sc1
    s_add_u32 s51, s77, 196608
    buffer_store_dwordx4 v[240:243], v1, s[4:7], s51 offen offset:0 sc1
    buffer_store_dwordx4 v[240:243], v1, s[4:7], s51 offen offset:1024 sc1
    s_add_u32 s51, s77, 229376
    buffer_store_dwordx4 v[240:243], v1, s[4:7], s51 offen offset:0 sc1
    buffer_store_dwordx4 v[240:243], v1, s[4:7], s51 offen offset:1024 sc1
    s_lshl_b32 s45, s36, 9
    s_add_u32 s45, s45, 35651584
    s_sub_u32 s48, s36, 1
    s_max_i32 s48, s48, 0
    s_lshl_b32 s46, s48, 9
    s_add_u32 s46, s46, 35651584
    buffer_load_dword v22, v5, s[4:7], s45 offen sc1
    s_mul_i32 s45, s36, 393216
    s_lshl_b32 s49, s37, 7
    s_add_u32 s45, s45, s49
    s_add_u32 s51, s45, 51200
    buffer_load_dwordx4 v[164:167], v18, s[20:23], s51 offen
    s_add_u32 s51, s45, 100352
    buffer_load_dwordx4 v[168:171], v18, s[20:23], s51 offen
    s_barrier
    s_waitcnt vmcnt(7)
    s_add_u32 s46, s43, 2
    s_mov_b32 s98, 65535
    s_mov_b32 s99, 0
    v_subrev_u32 v25, s46, v25
    v_cmp_gt_u32 vcc, 8, v25
    s_nop 0
    s_and_b64 s[100:101], vcc, s[98:99]
    s_cmp_eq_u64 s[100:101], s[98:99]
    s_cbranch_scc1 cs_ok_46
    s_lshl_b32 s45, s37, 9
    s_add_u32 s45, s45, 35667968
    s_mov_b32 s98, 65535
    s_mov_b32 s99, 0
    s_mov_b32 s63, 0
poll_47:
    buffer_load_dword v25, v5, s[4:7], s45 offen sc1
    s_waitcnt vmcnt(0)
    v_subrev_u32 v25, s46, v25
    v_cmp_gt_u32 vcc, 8, v25
    s_nop 0
    s_and_b64 s[100:101], vcc, s[98:99]
    s_cmp_eq_u64 s[100:101], s[98:99]
    s_cbranch_scc1 polled_48
    s_add_u32 s63, s63, 1
    s_cmp_lt_u32 s63, 20000
    s_cbranch_scc1 poll_47
    v_mov_b32 v25, 768
    s_mov_b32 s63, 16
    buffer_store_dword v25, off, s[24:27], s63
polled_48:
cs_ok_46:
    s_and_b32 s45, s42, 1
    s_lshl_b32 s45, s45, 18
    s_lshl_b32 s49, s37, 14
    s_add_u32 s45, s45, s49
    s_add_u32 s45, s45, 34603008
    s_add_u32 s51, s45, 0
    buffer_load_dwordx4 v[64:67], v1, s[4:7], s51 offen offset:0 sc1
    buffer_load_dwordx4 v[68:71], v1, s[4:7], s51 offen offset:1024 sc1
    buffer_load_dwordx4 v[72:75], v1, s[4:7], s51 offen offset:2048 sc1
    buffer_load_dwordx4 v[76:79], v1, s[4:7], s51 offen offset:3072 sc1
    s_add_u32 s51, s45, 4096
    buffer_load_dwordx4 v[80:83], v1, s[4:7], s51 offen offset:0 sc1
    buffer_load_dwordx4 v[84:87], v1, s[4:7], s51 offen offset:1024 sc1
    buffer_load_dwordx4 v[88:91], v1, s[4:7], s51 offen offset:2048 sc1
    buffer_load_dwordx4 v[92:95], v1, s[4:7], s51 offen offset:3072 sc1
    s_mul_i32 s45, s36, 393216
    s_lshl_b32 s49, s37, 7
    s_add_u32 s45, s45, s49
    s_add_u32 s51, s45, 149504
    buffer_load_dwordx4 v[172:175], v18, s[20:23], s51 offen
    s_add_u32 s51, s45, 198656
    buffer_load_dwordx4 v[176:179], v18, s[20:23], s51 offen
    s_waitcnt vmcnt(12)
    s_mov_b32 s98, 4294967295
    s_mov_b32 s99, 4294967295
    v_subrev_u32 v22, s44, v22
    v_cmp_gt_u32 vcc, 8, v22
    s_nop 0
    s_and_b64 s[100:101], vcc, s[98:99]
    s_cmp_eq_u64 s[100:101], s[98:99]
    s_cbranch_scc1 x_ok_49
    s_lshl_b32 s45, s36, 9
    s_add_u32 s45, s45, 35651584
    s_sub_u32 s48, s36, 1
    s_max_i32 s48, s48, 0
    s_lshl_b32 s46, s48, 9
    s_add_u32 s46, s46, 35651584
    s_mov_b32 s98, 4294967295
    s_mov_b32 s99, 4294967295
    s_mov_b32 s63, 0
poll_50:
    buffer_load_dword v22, v5, s[4:7], s45 offen sc1
    s_waitcnt vmcnt(0)
    v_subrev_u32 v22, s44, v22
    v_cmp_gt_u32 vcc, 8, v22
    s_nop 0
    s_and_b64 s[100:101], vcc, s[98:99]
    s_cmp_eq_u64 s[100:101], s[98:99]
    s_cbranch_scc1 polled_51
    s_add_u32 s63, s63, 1
    s_cmp_lt_u32 s63, 20000
    s_cbranch_scc1 poll_50
    v_mov_b32 v22, 258
    s_mov_b32 s63, 16
    buffer_store_dword v22, off, s[24:27], s63
polled_51:
x_ok_49:
    s_barrier
    v_mfma_f32_16x16x32_bf16 v[224:227], v[244:247], v[128:131], 0
    v_mfma_f32_16x16x32_bf16 v[224:227], v[244:247], v[132:135], v[224:227]
    v_mfma_f32_16x16x32_bf16 v[224:227], v[244:247], v[136:139], v[224:227]
    v_mfma_f32_16x16x32_bf16 v[224:227], v[244:247], v[140:143], v[224:227]
    v_mfma_f32_16x16x32_bf16 v[224:227], v[244:247], v[144:147], v[224:227]
    v_mfma_f32_16x16x32_bf16 v[224:227], v[244:247], v[148:151], v[224:227]
    v_mfma_f32_16x16x32_bf16 v[224:227], v[244:247], v[152:155], v[224:227]
    v_mfma_f32_16x16x32_bf16 v[224:227], v[244:247], v[156:159], v[224:227]
    s_lshl_b32 s45, s37, 14
    s_lshl_b32 s49, s36, 10
    s_add_u32 s45, s45, s49
    s_add_u32 s45, s45, 34865152
    s_nop 3
    v_add_f32_dpp v224, v224, v224 row_ror:8 row_mask:0xf bank_mask:0xf
    v_add_f32_dpp v225, v225, v225 row_ror:8 row_mask:0xf bank_mask:0xf
    v_add_f32_dpp v226, v226, v226 row_ror:8 row_mask:0xf bank_mask:0xf
    v_add_f32_dpp v227, v227, v227 row_ror:8 row_mask:0xf bank_mask:0xf
    buffer_store_dwordx4 v[224:227], v28, s[4:7], s45 offen sc1
    s_and_b32 s45, s42, 1
    s_lshl_b32 s45, s45, 18
    s_lshl_b32 s49, s37, 14
    s_add_u32 s45, s45, s49
    s_add_u32 s45, s45, 34603008
    s_add_u32 s51, s45, 8192
    buffer_load_dwordx4 v[96:99], v1, s[4:7], s51 offen offset:0 sc1
    buffer_load_dwordx4 v[100:103], v1, s[4:7], s51 offen offset:1024 sc1
    buffer_load_dwordx4 v[104:107], v1, s[4:7], s51 offen offset:2048 sc1
    buffer_load_dwordx4 v[108:111], v1, s[4:7], s51 offen offset:3072 sc1
    s_add_u32 s51, s45, 12288
    buffer_load_dwordx4 v[112:115], v1, s[4:7], s51 offen offset:0 sc1
    buffer_load_dwordx4 v[116:119], v1, s[4:7], s51 offen offset:1024 sc1
    buffer_load_dwordx4 v[120:123], v1, s[4:7], s51 offen offset:2048 sc1
    buffer_load_dwordx4 v[124:127], v1, s[4:7], s51 offen offset:3072 sc1
    s_barrier
    s_waitcnt vmcnt(11)
    v_add_f32 v64, v64, v68
    v_add_f32 v65, v65, v69
    v_add_f32 v66, v66, v70
    v_add_f32 v67, v67, v71
    v_add_f32 v64, v64, v72
    v_add_f32 v65, v65, v73
    v_add_f32 v66, v66, v74
    v_add_f32 v67, v67, v75
    v_add_f32 v64, v64, v76
    v_add_f32 v65, v65, v77
    v_add_f32 v66, v66, v78
    v_add_f32 v67, v67, v79
    v_add_f32 v64, v64, v80
    v_add_f32 v65, v65, v81
    v_add_f32 v66, v66, v82
    v_add_f32 v67, v67, v83
    v_add_f32 v64, v64, v84
    v_add_f32 v65, v65, v85
    v_add_f32 v66, v66, v86
    v_add_f32 v67, v67, v87
    v_add_f32 v64, v64, v88
    v_add_f32 v65, v65, v89
    v_add_f32 v66, v66, v90
    v_add_f32 v67, v67, v91
    v_add_f32 v64, v64, v92
    v_add_f32 v65, v65, v93
    v_add_f32 v66, v66, v94
    v_add_f32 v67, v67, v95
    s_lshl_b32 s45, s42, 18
    s_lshl_b32 s49, s36, 14
    s_add_u32 s46, s45, s49
    s_add_u32 s46, s46, 33554432
    s_add_u32 s51, s46, 0
    buffer_load_dwordx4 v[32:35], v2, s[4:7], s51 offen offset:0 sc1
    buffer_load_dwordx4 v[48:51], v2, s[4:7], s51 offen offset:256 sc1
    s_add_u32 s51, s46, 4096
    buffer_load_dwordx4 v[36:39], v2, s[4:7], s51 offen offset:0 sc1
    buffer_load_dwordx4 v[52:55], v2, s[4:7], s51 offen offset:256 sc1
    s_add_u32 s51, s46, 8192
    buffer_load_dwordx4 v[40:43], v2, s[4:7], s51 offen offset:0 sc1
    buffer_load_dwordx4 v[56:59], v2, s[4:7], s51 offen offset:256 sc1
    s_add_u32 s51, s46, 12288
    buffer_load_dwordx4 v[44:47], v2, s[4:7], s51 offen offset:0 sc1
    buffer_load_dwordx4 v[60:63], v2, s[4:7], s51 offen offset:256 sc1
    s_mul_i32 s45, s36, 393216
    s_lshl_b32 s49, s37, 7
    s_add_u32 s45, s45, s49
    s_add_u32 s51, s45, 247808
    buffer_load_dwordx4 v[180:183], v18, s[20:23], s51 offen
    s_add_u32 s51, s45, 296960
    buffer_load_dwordx4 v[184:187], v18, s[20:23], s51 offen
    s_barrier
    s_waitcnt vmcnt(10)
    v_add_f32 v64, v64, v96
    v_add_f32 v65, v65, v97
    v_add_f32 v66, v66, v98
    v_add_f32 v67, v67, v99
    v_add_f32 v64, v64, v100
    v_add_f32 v65, v65, v101
    v_add_f32 v66, v66, v102
    v_add_f32 v67, v67, v103
    v_add_f32 v64, v64, v104
    v_add_f32 v65, v65, v105
    v_add_f32 v66, v66, v106
    v_add_f32 v67, v67, v107
    v_add_f32 v64, v64, v108
    v_add_f32 v65, v65, v109
    v_add_f32 v66, v66, v110
    v_add_f32 v67, v67, v111
    v_add_f32 v64, v64, v112
    v_add_f32 v65, v65, v113
    v_add_f32 v66, v66, v114
    v_add_f32 v67, v67, v115
    v_add_f32 v64, v64, v116
    v_add_f32 v65, v65, v117
    v_add_f32 v66, v66, v118
    v_add_f32 v67, v67, v119
    v_add_f32 v64, v64, v120
    v_add_f32 v65, v65, v121
    v_add_f32 v66, v66, v122
    v_add_f32 v67, v67, v123
    v_add_f32 v64, v64, v124
    v_add_f32 v65, v65, v125
    v_add_f32 v66, v66, v126
    v_add_f32 v67, v67, v127
    s_and_b32 s45, s42, 1
    s_lshl_b32 s45, s45, 10
    s_add_u32 s45, s45, 159744
    v_add_u32 v20, s45, v1
    ds_write_b128 v20, v[64:67]
    s_waitcnt lgkmcnt(0)
    s_lshl_b32 s45, s42, 18
    s_lshl_b32 s49, s36, 14
    s_add_u32 s46, s45, s49
    s_add_u32 s46, s46, 33554432
    s_add_u32 s51, s46, 0
    buffer_load_dwordx4 v[64:67], v2, s[4:7], s51 offen offset:512 sc1
    buffer_load_dwordx4 v[80:83], v2, s[4:7], s51 offen offset:768 sc1
    s_add_u32 s51, s46, 4096
    buffer_load_dwordx4 v[68:71], v2, s[4:7], s51 offen offset:512 sc1
    buffer_load_dwordx4 v[84:87], v2, s[4:7], s51 offen offset:768 sc1
    s_add_u32 s51, s46, 8192
    buffer_load_dwordx4 v[72:75], v2, s[4:7], s51 offen offset:512 sc1
    buffer_load_dwordx4 v[88:91], v2, s[4:7], s51 offen offset:768 sc1
    s_add_u32 s51, s46, 12288
    buffer_load_dwordx4 v[76:79], v2, s[4:7], s51 offen offset:512 sc1
    buffer_load_dwordx4 v[92:95], v2, s[4:7], s51 offen offset:768 sc1
    s_barrier
    s_add_u32 s51, s78, 0
    buffer_store_dwordx4 v[240:243], v1, s[4:7], s51 offen offset:0 sc1
    buffer_store_dwordx4 v[240:243], v1, s[4:7], s51 offen offset:1024 sc1
    buffer_store_dwordx4 v[240:243], v1, s[4:7], s51 offen offset:2048 sc1
    buffer_store_dwordx4 v[240:243], v1, s[4:7], s51 offen offset:3072 sc1
    s_waitcnt vmcnt(14)
    v_add_f32 v32, v32, v36
    v_add_f32 v33, v33, v37
    v_add_f32 v34, v34, v38
    v_add_f32 v35, v35, v39
    v_add_f32 v48, v48, v52
    v_add_f32 v49, v49, v53
    v_add_f32 v50, v50, v54
    v_add_f32 v51, v51, v55
    v_add_f32 v32, v32, v40
    v_add_f32 v33, v33, v41
    v_add_f32 v34, v34, v42
    v_add_f32 v35, v35, v43
    v_add_f32 v48, v48, v56
    v_add_f32 v49, v49, v57
    v_add_f32 v50, v50, v58
    v_add_f32 v51, v51, v59
    v_add_f32 v32, v32, v44
    v_add_f32 v33, v33, v45
    v_add_f32 v34, v34, v46
    v_add_f32 v35, v35, v47
    v_add_f32 v48, v48, v60
    v_add_f32 v49, v49, v61
    v_add_f32 v50, v50, v62
    v_add_f32 v51, v51, v63
    s_mul_i32 s45, s36, 393216
    s_lshl_b32 s49, s37, 7
    s_add_u32 s45, s45, s49
    s_add_u32 s51, s45, 346112
    buffer_load_dwordx4 v[188:191], v18, s[20:23], s51 offen
    s_mul_i32 s45, s36, 393216
    s_lshl_b32 s49, s37, 7
    s_add_u32 s45, s45, s49
    s_add_u32 s51, s45, 4096
    buffer_load_dwordx4 v[192:195], v18, s[20:23], s51 offen
    s_add_u32 s51, s45, 53248
    buffer_load_dwordx4 v[196:199], v18, s[20:23], s51 offen
    s_barrier
    s_waitcnt vmcnt(7)
    v_add_f32 v64, v64, v68
    v_add_f32 v65, v65, v69
    v_add_f32 v66, v66, v70
    v_add_f32 v67, v67, v71
    v_add_f32 v80, v80, v84
    v_add_f32 v81, v81, v85
    v_add_f32 v82, v82, v86
    v_add_f32 v83, v83, v87
    v_add_f32 v64, v64, v72
    v_add_f32 v65, v65, v73
    v_add_f32 v66, v66, v74
    v_add_f32 v67, v67, v75
    v_add_f32 v80, v80, v88
    v_add_f32 v81, v81, v89
    v_add_f32 v82, v82, v90
    v_add_f32 v83, v83, v91
    v_add_f32 v64, v64, v76
    v_add_f32 v65, v65, v77
    v_add_f32 v66, v66, v78
    v_add_f32 v67, v67, v79
    v_add_f32 v80, v80, v92
    v_add_f32 v81, v81, v93
    v_add_f32 v82, v82, v94
    v_add_f32 v83, v83, v95
    s_mul_i32 s45, s36, 393216
    s_lshl_b32 s49, s37, 7
    s_add_u32 s45, s45, s49
    s_add_u32 s51, s45, 102400
    buffer_load_dwordx4 v[200:203], v18, s[20:23], s51 offen
    s_add_u32 s51, s45, 151552
    buffer_load_dwordx4 v[204:207], v18, s[20:23], s51 offen
    s_add_u32 s51, s45, 200704
    buffer_load_dwordx4 v[208:211], v18, s[20:23], s51 offen
    s_lshl_b32 s45, s36, 3
    s_and_b32 s49, s37, 7
    s_add_u32 s45, s45, s49
    s_mul_i32 s45, s45, 49152
    s_and_b32 s49, s37, 8
    s_lshl_b32 s49, s49, 7
    s_add_u32 s45, s45, s49
    s_add_u32 s51, s45, 384
    buffer_load_dwordx4 v[104:107], v18, s[20:23], s51 offen
    s_add_u32 s51, s45, 2432
    buffer_load_dwordx4 v[108:111], v18, s[20:23], s51 offen
    s_add_u32 s51, s45, 4480
    buffer_load_dwordx4 v[112:115], v18, s[20:23], s51 offen
    s_mov_b32 s12, s34
    s_mov_b32 s13, s35
    s_lshl_b32 s45, s36, 3
    s_and_b32 s49, s37, 7
    s_add_u32 s45, s45, s49
    s_lshl_b32 s45, s45, 14
    s_and_b32 s49, s37, 8
    s_lshl_b32 s49, s49, 7
    s_add_u32 s45, s45, s49
    s_add_u32 s51, s45, 384
    buffer_load_dwordx4 v[116:119], v19, s[12:15], s51 offen
    s_barrier
    s_waitcnt vmcnt(9)
    v_mfma_f32_16x16x32_bf16 v[224:227], v[244:247], v[160:163], 0
    v_mfma_f32_16x16x32_bf16 v[224:227], v[244:247], v[164:167], v[224:227]
    v_mfma_f32_16x16x32_bf16 v[224:227], v[244:247], v[168:171], v[224:227]
    v_mfma_f32_16x16x32_bf16 v[224:227], v[244:247], v[172:175], v[224:227]
    v_mfma_f32_16x16x32_bf16 v[224:227], v[244:247], v[176:179], v[224:227]
    v_mfma_f32_16x16x32_bf16 v[224:227], v[244:247], v[180:183], v[224:227]
    v_mfma_f32_16x16x32_bf16 v[224:227], v[244:247], v[184:187], v[224:227]
    v_mfma_f32_16x16x32_bf16 v[224:227], v[244:247], v[188:191], v[224:227]
    s_lshl_b32 s45, s37, 14
    s_lshl_b32 s49, s36, 10
    s_add_u32 s45, s45, s49
    s_add_u32 s45, s45, 34865408
    s_nop 3
    v_add_f32_dpp v224, v224, v224 row_ror:8 row_mask:0xf bank_mask:0xf
    v_add_f32_dpp v225, v225, v225 row_ror:8 row_mask:0xf bank_mask:0xf
    v_add_f32_dpp v226, v226, v226 row_ror:8 row_mask:0xf bank_mask:0xf
    v_add_f32_dpp v227, v227, v227 row_ror:8 row_mask:0xf bank_mask:0xf
    buffer_store_dwordx4 v[224:227], v28, s[4:7], s45 offen sc1
    v_mov_b32 v20, s44
    s_mov_b64 exec, 1
    buffer_store_dword v20, off, s[4:7], s79 sc1
    s_mov_b64 exec, -1
    v_permlane32_swap_b32 v32, v64
    v_permlane32_swap_b32 v33, v65
    v_permlane32_swap_b32 v34, v66
    v_permlane32_swap_b32 v35, v67
    v_permlane32_swap_b32 v48, v80
    v_permlane32_swap_b32 v49, v81
    v_permlane32_swap_b32 v50, v82
    v_permlane32_swap_b32 v51, v83
    v_add_f32 v32, v32, v64
    v_add_f32 v33, v33, v65
    v_add_f32 v34, v34, v66
    v_add_f32 v35, v35, v67
    v_add_f32 v48, v48, v80
    v_add_f32 v49, v49, v81
    v_add_f32 v50, v50, v82
    v_add_f32 v51, v51, v83
    v_permlane16_swap_b32 v32, v48
    v_permlane16_swap_b32 v33, v49
    v_permlane16_swap_b32 v34, v50
    v_permlane16_swap_b32 v35, v51
    v_add_f32 v32, v32, v48
    v_add_f32 v33, v33, v49
    v_add_f32 v34, v34, v50
    v_add_f32 v35, v35, v51
    s_mul_i32 s45, s36, 393216
    s_lshl_b32 s49, s37, 7
    s_add_u32 s45, s45, s49
    s_add_u32 s51, s45, 249856
    buffer_load_dwordx4 v[212:215], v18, s[20:23], s51 offen
    s_add_u32 s51, s45, 299008
    buffer_load_dwordx4 v[216:219], v18, s[20:23], s51 offen
    s_add_u32 s51, s45, 348160
    buffer_load_dwordx4 v[220:223], v18, s[20:23], s51 offen
    s_barrier
    s_mov_b32 s45, 0x3a800000
    v_mul_f32 v32, s45, v32
    v_mul_f32 v34, s45, v34
    v_mul_f32 v33, s45, v33
    v_mul_f32 v35, s45, v35
    v_fma_f32 v33, -v32, v32, v33
    v_fma_f32 v35, -v34, v34, v35
    v_max_f32 v33, 0, v33
    v_max_f32 v35, 0, v35
    v_add_f32 v33, 0x3727c5ac, v33
    v_add_f32 v35, 0x3727c5ac, v35
    v_rsq_f32 v36, v33
    v_rsq_f32 v37, v35
    v_sub_f32 v38, 0, v32
    v_sub_f32 v39, 0, v34
    ds_write_b64 v26, v[38:39]
    ds_write_b64 v26, v[36:37] offset:1024
    s_waitcnt lgkmcnt(0)
    s_and_b32 s45, s37, 8
    s_mul_i32 s45, s45, 393216
    s_mul_i32 s49, s36, 24576
    s_add_u32 s45, s45, s49
    s_and_b32 s49, s37, 7
    s_lshl_b32 s49, s49, 10
    s_add_u32 s45, s45, s49
    s_waitcnt vmcnt(5)
    s_add_u32 s51, s45, 49414144
    buffer_store_dwordx4 v[104:107], v16, s[4:7], s51 offen sc1
    s_add_u32 s51, s45, 49422336
    buffer_store_dwordx4 v[108:111], v16, s[4:7], s51 offen sc1
    s_add_u32 s51, s45, 49430528
    buffer_store_dwordx4 v[112:115], v16, s[4:7], s51 offen sc1
    s_and_b32 s45, s37, 8
    s_lshl_b32 s45, s45, 17
    s_lshl_b32 s49, s36, 13
    s_add_u32 s45, s45, s49
    s_and_b32 s49, s37, 7
    s_lshl_b32 s49, s49, 10
    s_add_u32 s45, s45, s49
    s_add_u32 s51, s45, 57016320
    buffer_store_dwordx4 v[116:119], v16, s[4:7], s51 offen sc1
    s_barrier
    s_mov_b32 s45, 35676160
    buffer_load_dword v30, v29, s[4:7], s45 offen sc1
    s_barrier
    s_waitcnt vmcnt(5)
    v_mfma_f32_16x16x32_bf16 v[224:227], v[244:247], v[192:195], 0
    v_mfma_f32_16x16x32_bf16 v[224:227], v[244:247], v[196:199], v[224:227]
    v_mfma_f32_16x16x32_bf16 v[224:227], v[244:247], v[200:203], v[224:227]
    v_mfma_f32_16x16x32_bf16 v[224:227], v[244:247], v[204:207], v[224:227]
    v_mfma_f32_16x16x32_bf16 v[224:227], v[244:247], v[208:211], v[224:227]
    v_mfma_f32_16x16x32_bf16 v[224:227], v[244:247], v[212:215], v[224:227]
    v_mfma_f32_16x16x32_bf16 v[224:227], v[244:247], v[216:219], v[224:227]
    v_mfma_f32_16x16x32_bf16 v[224:227], v[244:247], v[220:223], v[224:227]
    s_lshl_b32 s45, s37, 14
    s_lshl_b32 s49, s36, 10
    s_add_u32 s45, s45, s49
    s_add_u32 s45, s45, 34865664
    s_nop 3
    v_add_f32_dpp v224, v224, v224 row_ror:8 row_mask:0xf bank_mask:0xf
    v_add_f32_dpp v225, v225, v225 row_ror:8 row_mask:0xf bank_mask:0xf
    v_add_f32_dpp v226, v226, v226 row_ror:8 row_mask:0xf bank_mask:0xf
    v_add_f32_dpp v227, v227, v227 row_ror:8 row_mask:0xf bank_mask:0xf
    buffer_store_dwordx4 v[224:227], v28, s[4:7], s45 offen sc1
    s_waitcnt vmcnt(0)
    s_add_u32 s46, s43, 4
    v_mov_b32 v20, s46
    s_mov_b64 exec, 1
    buffer_store_dword v20, off, s[4:7], s74 sc1
    s_mov_b64 exec, -1
    v_subrev_u32 v30, s44, v30
    v_cmp_gt_u32 vcc, 8, v30
    s_nop 0
    s_cmp_eq_u64 vcc, -1
    s_cbranch_scc1 cl_ok_52
    s_mov_b32 s45, 35676160
    s_mov_b32 s63, 0
poll_53:
    buffer_load_dword v30, v29, s[4:7], s45 offen sc1
    s_waitcnt vmcnt(0)
    v_subrev_u32 v30, s44, v30
    v_cmp_gt_u32 vcc, 8, v30
    s_nop 0
    s_cmp_eq_u64 vcc, -1
    s_cbranch_scc1 polled_54
    s_add_u32 s63, s63, 1
    s_cmp_lt_u32 s63, 20000
    s_cbranch_scc1 poll_53
    v_mov_b32 v30, 784
    s_mov_b32 s63, 16
    buffer_store_dword v30, off, s[24:27], s63
polled_54:
cl_ok_52:
    s_barrier
    s_add_u32 s42, s42, 1
    s_waitcnt vmcnt(0)
    s_add_u32 s46, s43, 4
    s_lshl_b32 s45, s37, 9
    s_add_u32 s45, s45, 35667968
    s_mov_b32 s98, 65535
    s_mov_b32 s99, 0
    s_mov_b32 s63, 0
poll_55:
    buffer_load_dword v25, v5, s[4:7], s45 offen sc1
    s_waitcnt vmcnt(0)
    v_subrev_u32 v25, s46, v25
    v_cmp_gt_u32 vcc, 8, v25
    s_nop 0
    s_and_b64 s[100:101], vcc, s[98:99]
    s_cmp_eq_u64 s[100:101], s[98:99]
    s_cbranch_scc1 polled_56
    s_add_u32 s63, s63, 1
    s_cmp_lt_u32 s63, 20000
    s_cbranch_scc1 poll_55
    v_mov_b32 v25, 769
    s_mov_b32 s63, 16
    buffer_store_dword v25, off, s[24:27], s63
polled_56:
    s_cmp_eq_u32 s67, 0
    s_cbranch_scc1 wide_skip_57
    s_add_u32 s46, s43, 4
    s_and_b32 s45, s37, 8
    s_lshl_b32 s45, s45, 9
    s_add_u32 s45, s45, 35667968
    s_add_u32 s47, s45, 2048
    s_mov_b32 s63, 0
poll_58:
    buffer_load_dword v22, v17, s[4:7], s45 offen sc1
    buffer_load_dword v23, v17, s[4:7], s47 offen sc1
    s_waitcnt vmcnt(0)
    v_subrev_u32 v22, s46, v22
    v_subrev_u32 v23, s46, v23
    v_max_u32 v22, v22, v23
    v_cmp_gt_u32 vcc, 8, v22
    s_nop 0
    s_cmp_eq_u64 vcc, -1
    s_cbranch_scc1 polled_59
    s_add_u32 s63, s63, 1
    s_cmp_lt_u32 s63, 20000
    s_cbranch_scc1 poll_58
    v_mov_b32 v22, 772
    s_mov_b32 s63, 16
    buffer_store_dword v22, off, s[24:27], s63
polled_59:
wide_skip_57:
    s_add_u32 s44, s44, 1
    s_barrier
    s_barrier
    s_barrier
    s_lshl_b32 s45, s36, 18
    s_lshl_b32 s49, s37, 11
    s_add_u32 s77, s45, s49
    s_add_u32 s77, s77, 20971520
    s_and_b32 s49, s37, 12
    s_lshr_b32 s49, 30292, s49
    s_and_b32 s49, s49, 15
    s_lshl_b32 s49, s49, 14
    s_add_u32 s78, s45, s49
    s_and_b32 s49, s37, 3
    s_lshl_b32 s49, s49, 12
    s_add_u32 s78, s78, s49
    s_add_u32 s78, s78, 8388608
    s_and_b32 s45, s42, 1
    s_lshl_b32 s45, s45, 18
    s_lshl_b32 s49, s37, 14
    s_add_u32 s45, s45, s49
    s_add_u32 s45, s45, 34603008
    s_add_u32 s51, s45, 0
    buffer_load_dwordx4 v[128:131], v1, s[4:7], s51 offen offset:0 sc1
    buffer_load_dwordx4 v[132:135], v1, s[4:7], s51 offen offset:1024 sc1
    buffer_load_dwordx4 v[136:139], v1, s[4:7], s51 offen offset:2048 sc1
    buffer_load_dwordx4 v[140:143], v1, s[4:7], s51 offen offset:3072 sc1
    s_add_u32 s51, s45, 4096
    buffer_load_dwordx4 v[144:147], v1, s[4:7], s51 offen offset:0 sc1
    buffer_load_dwordx4 v[148:151], v1, s[4:7], s51 offen offset:1024 sc1
    buffer_load_dwordx4 v[152:155], v1, s[4:7], s51 offen offset:2048 sc1
    buffer_load_dwordx4 v[156:159], v1, s[4:7], s51 offen offset:3072 sc1
    s_add_u32 s51, s77, 0
    buffer_store_dwordx4 v[240:243], v1, s[4:7], s51 offen offset:0 sc1
    buffer_store_dwordx4 v[240:243], v1, s[4:7], s51 offen offset:1024 sc1
    s_add_u32 s51, s77, 32768
    buffer_store_dwordx4 v[240:243], v1, s[4:7], s51 offen offset:0 sc1
    buffer_store_dwordx4 v[240:243], v1, s[4:7], s51 offen offset:1024 sc1
    s_barrier
    s_and_b32 s45, s42, 1
    s_lshl_b32 s45, s45, 18
    s_lshl_b32 s49, s37, 14
    s_add_u32 s45, s45, s49
    s_add_u32 s45, s45, 34603008
    s_add_u32 s51, s45, 8192
    buffer_load_dwordx4 v[160:163], v1, s[4:7], s51 offen offset:0 sc1
    buffer_load_dwordx4 v[164:167], v1, s[4:7], s51 offen offset:1024 sc1
    buffer_load_dwordx4 v[168:171], v1, s[4:7], s51 offen offset:2048 sc1
    buffer_load_dwordx4 v[172:175], v1, s[4:7], s51 offen offset:3072 sc1
    s_add_u32 s51, s45, 12288
    buffer_load_dwordx4 v[176:179], v1, s[4:7], s51 offen offset:0 sc1
    buffer_load_dwordx4 v[180:183], v1, s[4:7], s51 offen offset:1024 sc1
    buffer_load_dwordx4 v[184:187], v1, s[4:7], s51 offen offset:2048 sc1
    buffer_load_dwordx4 v[188:191], v1, s[4:7], s51 offen offset:3072 sc1
    s_lshl_b32 s45, s36, 9
    s_add_u32 s45, s45, 35651584
    s_sub_u32 s48, s36, 1
    s_max_i32 s48, s48, 0
    s_lshl_b32 s46, s48, 9
    s_add_u32 s46, s46, 35651584
    buffer_load_dword v22, v5, s[4:7], s45 offen sc1
    s_add_u32 s51, s77, 65536
    buffer_store_dwordx4 v[240:243], v1, s[4:7], s51 offen offset:0 sc1
    buffer_store_dwordx4 v[240:243], v1, s[4:7], s51 offen offset:1024 sc1
    s_add_u32 s51, s77, 98304
    buffer_store_dwordx4 v[240:243], v1, s[4:7], s51 offen offset:0 sc1
    buffer_store_dwordx4 v[240:243], v1, s[4:7], s51 offen offset:1024 sc1
    s_waitcnt vmcnt(4)
    s_mov_b32 s98, 4059165169
    s_mov_b32 s99, 4059165169
    v_subrev_u32 v22, s44, v22
    v_cmp_gt_u32 vcc, 8, v22
    s_nop 0
    s_and_b64 s[100:101], vcc, s[98:99]
    s_cmp_eq_u64 s[100:101], s[98:99]
    s_cbranch_scc1 x_ok_60
    s_lshl_b32 s45, s36, 9
    s_add_u32 s45, s45, 35651584
    s_sub_u32 s48, s36, 1
    s_max_i32 s48, s48, 0
    s_lshl_b32 s46, s48, 9
    s_add_u32 s46, s46, 35651584
    s_mov_b32 s98, 4059165169
    s_mov_b32 s99, 4059165169
    s_mov_b32 s63, 0
poll_61:
    buffer_load_dword v22, v5, s[4:7], s45 offen sc1
    s_waitcnt vmcnt(0)
    v_subrev_u32 v22, s44, v22
    v_cmp_gt_u32 vcc, 8, v22
    s_nop 0
    s_and_b64 s[100:101], vcc, s[98:99]
    s_cmp_eq_u64 s[100:101], s[98:99]
    s_cbranch_scc1 polled_62
    s_add_u32 s63, s63, 1
    s_cmp_lt_u32 s63, 20000
    s_cbranch_scc1 poll_61
    v_mov_b32 v22, 258
    s_mov_b32 s63, 16
    buffer_store_dword v22, off, s[24:27], s63
polled_62:
x_ok_60:
    s_barrier
    v_add_f32 v128, v128, v132
    v_add_f32 v129, v129, v133
    v_add_f32 v130, v130, v134
    v_add_f32 v131, v131, v135
    v_add_f32 v128, v128, v136
    v_add_f32 v129, v129, v137
    v_add_f32 v130, v130, v138
    v_add_f32 v131, v131, v139
    v_add_f32 v128, v128, v140
    v_add_f32 v129, v129, v141
    v_add_f32 v130, v130, v142
    v_add_f32 v131, v131, v143
    v_add_f32 v128, v128, v144
    v_add_f32 v129, v129, v145
    v_add_f32 v130, v130, v146
    v_add_f32 v131, v131, v147
    v_add_f32 v128, v128, v148
    v_add_f32 v129, v129, v149
    v_add_f32 v130, v130, v150
    v_add_f32 v131, v131, v151
    v_add_f32 v128, v128, v152
    v_add_f32 v129, v129, v153
    v_add_f32 v130, v130, v154
    v_add_f32 v131, v131, v155
    v_add_f32 v128, v128, v156
    v_add_f32 v129, v129, v157
    v_add_f32 v130, v130, v158
    v_add_f32 v131, v131, v159
    s_add_u32 s51, s77, 131072
    buffer_store_dwordx4 v[240:243], v1, s[4:7], s51 offen offset:0 sc1
    buffer_store_dwordx4 v[240:243], v1, s[4:7], s51 offen offset:1024 sc1
    s_add_u32 s51, s77, 163840
    buffer_store_dwordx4 v[240:243], v1, s[4:7], s51 offen offset:0 sc1
    buffer_store_dwordx4 v[240:243], v1, s[4:7], s51 offen offset:1024 sc1
    s_barrier
    v_add_f32 v128, v128, v160
    v_add_f32 v129, v129, v161
    v_add_f32 v130, v130, v162
    v_add_f32 v131, v131, v163
    v_add_f32 v128, v128, v164
    v_add_f32 v129, v129, v165
    v_add_f32 v130, v130, v166
    v_add_f32 v131, v131, v167
    v_add_f32 v128, v128, v168
    v_add_f32 v129, v129, v169
    v_add_f32 v130, v130, v170
    v_add_f32 v131, v131, v171
    v_add_f32 v128, v128, v172
    v_add_f32 v129, v129, v173
    v_add_f32 v130, v130, v174
    v_add_f32 v131, v131, v175
    v_add_f32 v128, v128, v176
    v_add_f32 v129, v129, v177
    v_add_f32 v130, v130, v178
    v_add_f32 v131, v131, v179
    v_add_f32 v128, v128, v180
    v_add_f32 v129, v129, v181
    v_add_f32 v130, v130, v182
    v_add_f32 v131, v131, v183
    v_add_f32 v128, v128, v184
    v_add_f32 v129, v129, v185
    v_add_f32 v130, v130, v186
    v_add_f32 v131, v131, v187
    v_add_f32 v128, v128, v188
    v_add_f32 v129, v129, v189
    v_add_f32 v130, v130, v190
    v_add_f32 v131, v131, v191
    s_and_b32 s45, s42, 1
    s_lshl_b32 s45, s45, 10
    s_add_u32 s45, s45, 159744
    v_add_u32 v20, s45, v1
    ds_write_b128 v20, v[128:131]
    s_waitcnt lgkmcnt(0)
    s_lshl_b32 s45, s36, 9
    s_add_u32 s45, s45, 35651584
    s_sub_u32 s48, s36, 1
    s_max_i32 s48, s48, 0
    s_lshl_b32 s46, s48, 9
    s_add_u32 s46, s46, 35651584
    buffer_load_dword v22, v5, s[4:7], s45 offen sc1
    s_add_u32 s51, s77, 196608
    buffer_store_dwordx4 v[240:243], v1, s[4:7], s51 offen offset:0 sc1
    buffer_store_dwordx4 v[240:243], v1, s[4:7], s51 offen offset:1024 sc1
    s_add_u32 s51, s77, 229376
    buffer_store_dwordx4 v[240:243], v1, s[4:7], s51 offen offset:0 sc1
    buffer_store_dwordx4 v[240:243], v1, s[4:7], s51 offen offset:1024 sc1
    s_barrier
    s_add_u32 s51, s78, 0
    buffer_store_dwordx4 v[240:243], v1, s[4:7], s51 offen offset:0 sc1
    buffer_store_dwordx4 v[240:243], v1, s[4:7], s51 offen offset:1024 sc1
    buffer_store_dwordx4 v[240:243], v1, s[4:7], s51 offen offset:2048 sc1
    buffer_store_dwordx4 v[240:243], v1, s[4:7], s51 offen offset:3072 sc1
    s_waitcnt vmcnt(8)
    s_mov_b32 s98, 4294967295
    s_mov_b32 s99, 4294967295
    v_subrev_u32 v22, s44, v22
    v_cmp_gt_u32 vcc, 8, v22
    s_nop 0
    s_and_b64 s[100:101], vcc, s[98:99]
    s_cmp_eq_u64 s[100:101], s[98:99]
    s_cbranch_scc1 x_ok_63
    s_lshl_b32 s45, s36, 9
    s_add_u32 s45, s45, 35651584
    s_sub_u32 s48, s36, 1
    s_max_i32 s48, s48, 0
    s_lshl_b32 s46, s48, 9
    s_add_u32 s46, s46, 35651584
    s_mov_b32 s98, 4294967295
    s_mov_b32 s99, 4294967295
    s_mov_b32 s63, 0
poll_64:
    buffer_load_dword v22, v5, s[4:7], s45 offen sc1
    s_waitcnt vmcnt(0)
    v_subrev_u32 v22, s44, v22
    v_cmp_gt_u32 vcc, 8, v22
    s_nop 0
    s_and_b64 s[100:101], vcc, s[98:99]
    s_cmp_eq_u64 s[100:101], s[98:99]
    s_cbranch_scc1 polled_65
    s_add_u32 s63, s63, 1
    s_cmp_lt_u32 s63, 20000
    s_cbranch_scc1 poll_64
    v_mov_b32 v22, 258
    s_mov_b32 s63, 16
    buffer_store_dword v22, off, s[24:27], s63
polled_65:
x_ok_63:
    s_barrier
    s_lshl_b32 s45, s42, 18
    s_lshl_b32 s49, s36, 14
    s_add_u32 s46, s45, s49
    s_add_u32 s46, s46, 33554432
    s_add_u32 s51, s46, 0
    buffer_load_dwordx4 v[32:35], v2, s[4:7], s51 offen offset:0 sc1
    buffer_load_dwordx4 v[48:51], v2, s[4:7], s51 offen offset:256 sc1
    s_add_u32 s51, s46, 4096
    buffer_load_dwordx4 v[36:39], v2, s[4:7], s51 offen offset:0 sc1
    buffer_load_dwordx4 v[52:55], v2, s[4:7], s51 offen offset:256 sc1
    s_barrier
    s_lshl_b32 s45, s42, 18
    s_lshl_b32 s49, s36, 14
    s_add_u32 s46, s45, s49
    s_add_u32 s46, s46, 33554432
    s_add_u32 s51, s46, 8192
    buffer_load_dwordx4 v[40:43], v2, s[4:7], s51 offen offset:0 sc1
    buffer_load_dwordx4 v[56:59], v2, s[4:7], s51 offen offset:256 sc1
    s_add_u32 s51, s46, 12288
    buffer_load_dwordx4 v[44:47], v2, s[4:7], s51 offen offset:0 sc1
    buffer_load_dwordx4 v[60:63], v2, s[4:7], s51 offen offset:256 sc1
    s_barrier
    s_lshl_b32 s45, s42, 18
    s_lshl_b32 s49, s36, 14
    s_add_u32 s46, s45, s49
    s_add_u32 s46, s46, 33554432
    s_add_u32 s51, s46, 0
    buffer_load_dwordx4 v[64:67], v2, s[4:7], s51 offen offset:512 sc1
    buffer_load_dwordx4 v[80:83], v2, s[4:7], s51 offen offset:768 sc1
    s_add_u32 s51, s46, 4096
    buffer_load_dwordx4 v[68:71], v2, s[4:7], s51 offen offset:512 sc1
    buffer_load_dwordx4 v[84:87], v2, s[4:7], s51 offen offset:768 sc1
    s_barrier
    s_waitcnt vmcnt(12)
    v_mov_b32 v20, s44
    s_mov_b64 exec, 1
    buffer_store_dword v20, off, s[4:7], s79 sc1
    s_mov_b64 exec, -1
    s_lshl_b32 s45, s42, 18
    s_lshl_b32 s49, s36, 14
    s_add_u32 s46, s45, s49
    s_add_u32 s46, s46, 33554432
    s_add_u32 s51, s46, 8192
    buffer_load_dwordx4 v[72:75], v2, s[4:7], s51 offen offset:512 sc1
    buffer_load_dwordx4 v[88:91], v2, s[4:7], s51 offen offset:768 sc1
    s_add_u32 s51, s46, 12288
    buffer_load_dwordx4 v[76:79], v2, s[4:7], s51 offen offset:512 sc1
    buffer_load_dwordx4 v[92:95], v2, s[4:7], s51 offen offset:768 sc1
    s_barrier
    s_lshl_b32 s49, s36, 17
    s_max_u32 s49, s49, 131072
    s_sub_u32 s49, s49, 131072
    s_lshl_b32 s45, s37, 13
    s_add_u32 s45, s45, s49
    s_add_u32 s45, s45, 60817408
    v_lshlrev_b32 v20, 7, v9
    buffer_load_dword v31, v20, s[4:7], s45 offen sc1
    s_barrier
    s_barrier
    s_waitcnt vmcnt(10)
    v_add_f32 v32, v32, v36
    v_add_f32 v33, v33, v37
    v_add_f32 v34, v34, v38
    v_add_f32 v35, v35, v39
    v_add_f32 v48, v48, v52
    v_add_f32 v49, v49, v53
    v_add_f32 v50, v50, v54
    v_add_f32 v51, v51, v55
    v_add_f32 v32, v32, v40
    v_add_f32 v33, v33, v41
    v_add_f32 v34, v34, v42
    v_add_f32 v35, v35, v43
    v_add_f32 v48, v48, v56
    v_add_f32 v49, v49, v57
    v_add_f32 v50, v50, v58
    v_add_f32 v51, v51, v59
    v_add_f32 v32, v32, v44
    v_add_f32 v33, v33, v45
    v_add_f32 v34, v34, v46
    v_add_f32 v35, v35, v47
    v_add_f32 v48, v48, v60
    v_add_f32 v49, v49, v61
    v_add_f32 v50, v50, v62
    v_add_f32 v51, v51, v63
    s_barrier
    s_waitcnt vmcnt(1)
    v_add_f32 v64, v64, v68
    v_add_f32 v65, v65, v69
    v_add_f32 v66, v66, v70
    v_add_f32 v67, v67, v71
    v_add_f32 v80, v80, v84
    v_add_f32 v81, v81, v85
    v_add_f32 v82, v82, v86
    v_add_f32 v83, v83, v87
    v_add_f32 v64, v64, v72
    v_add_f32 v65, v65, v73
    v_add_f32 v66, v66, v74
    v_add_f32 v67, v67, v75
    v_add_f32 v80, v80, v88
    v_add_f32 v81, v81, v89
    v_add_f32 v82, v82, v90
    v_add_f32 v83, v83, v91
    v_add_f32 v64, v64, v76
    v_add_f32 v65, v65, v77
    v_add_f32 v66, v66, v78
    v_add_f32 v67, v67, v79
    v_add_f32 v80, v80, v92
    v_add_f32 v81, v81, v93
    v_add_f32 v82, v82, v94
    v_add_f32 v83, v83, v95
    s_barrier
    v_permlane32_swap_b32 v32, v64
    v_permlane32_swap_b32 v33, v65
    v_permlane32_swap_b32 v34, v66
    v_permlane32_swap_b32 v35, v67
    v_permlane32_swap_b32 v48, v80
    v_permlane32_swap_b32 v49, v81
    v_permlane32_swap_b32 v50, v82
    v_permlane32_swap_b32 v51, v83
    v_add_f32 v32, v32, v64
    v_add_f32 v33, v33, v65
    v_add_f32 v34, v34, v66
    v_add_f32 v35, v35, v67
    v_add_f32 v48, v48, v80
    v_add_f32 v49, v49, v81
    v_add_f32 v50, v50, v82
    v_add_f32 v51, v51, v83
    v_permlane16_swap_b32 v32, v48
    v_permlane16_swap_b32 v33, v49
    v_permlane16_swap_b32 v34, v50
    v_permlane16_swap_b32 v35, v51
    v_add_f32 v32, v32, v48
    v_add_f32 v33, v33, v49
    v_add_f32 v34, v34, v50
    v_add_f32 v35, v35, v51
    s_barrier
    s_mov_b32 s45, 0x3a800000
    v_mul_f32 v32, s45, v32
    v_mul_f32 v34, s45, v34
    v_mul_f32 v33, s45, v33
    v_mul_f32 v35, s45, v35
    v_fma_f32 v33, -v32, v32, v33
    v_fma_f32 v35, -v34, v34, v35
    v_max_f32 v33, 0, v33
    v_max_f32 v35, 0, v35
    v_add_f32 v33, 0x3727c5ac, v33
    v_add_f32 v35, 0x3727c5ac, v35
    v_rsq_f32 v36, v33
    v_rsq_f32 v37, v35
    v_sub_f32 v38, 0, v32
    v_sub_f32 v39, 0, v34
    ds_write_b64 v26, v[38:39]
    ds_write_b64 v26, v[36:37] offset:1024
    s_waitcnt lgkmcnt(0)
    s_mov_b32 s45, 35676160
    buffer_load_dword v30, v29, s[4:7], s45 offen sc1
    s_barrier
    s_barrier
    s_waitcnt vmcnt(0)
    v_subrev_u32 v30, s44, v30
    v_cmp_gt_u32 vcc, 8, v30
    s_nop 0
    s_cmp_eq_u64 vcc, -1
    s_cbranch_scc1 cl_ok_66
    s_mov_b32 s45, 35676160
    s_mov_b32 s63, 0
poll_67:
    buffer_load_dword v30, v29, s[4:7], s45 offen sc1
    s_waitcnt vmcnt(0)
    v_subrev_u32 v30, s44, v30
    v_cmp_gt_u32 vcc, 8, v30
    s_nop 0
    s_cmp_eq_u64 vcc, -1
    s_cbranch_scc1 polled_68
    s_add_u32 s63, s63, 1
    s_cmp_lt_u32 s63, 20000
    s_cbranch_scc1 poll_67
    v_mov_b32 v30, 784
    s_mov_b32 s63, 16
    buffer_store_dword v30, off, s[24:27], s63
polled_68:
cl_ok_66:
    s_barrier
    s_add_u32 s42, s42, 1
    s_add_u32 s44, s44, 1
    s_barrier
    s_barrier
    s_barrier
    s_lshl_b32 s45, s36, 18
    s_lshl_b32 s49, s37, 11
    s_add_u32 s77, s45, s49
    s_add_u32 s77, s77, 25165824
    s_and_b32 s49, s37, 12
    s_lshr_b32 s49, 30292, s49
    s_and_b32 s49, s49, 15
    s_lshl_b32 s49, s49, 14
    s_add_u32 s78, s45, s49
    s_and_b32 s49, s37, 3
    s_lshl_b32 s49, s49, 12
    s_add_u32 s78, s78, s49
    s_add_u32 s78, s78, 12582912
    s_add_u32 s51, s77, 0
    buffer_store_dwordx4 v[240:243], v1, s[4:7], s51 offen offset:0 sc1
    buffer_store_dwordx4 v[240:243], v1, s[4:7], s51 offen offset:1024 sc1
    s_add_u32 s51, s77, 32768
    buffer_store_dwordx4 v[240:243], v1, s[4:7], s51 offen offset:0 sc1
    buffer_store_dwordx4 v[240:243], v1, s[4:7], s51 offen offset:1024 sc1
    s_barrier
    s_lshl_b32 s45, s36, 9
    s_add_u32 s45, s45, 35651584
    s_sub_u32 s48, s36, 1
    s_max_i32 s48, s48, 0
    s_lshl_b32 s46, s48, 9
    s_add_u32 s46, s46, 35651584
    buffer_load_dword v22, v5, s[4:7], s45 offen sc1
    s_add_u32 s51, s77, 65536
    buffer_store_dwordx4 v[240:243], v1, s[4:7], s51 offen offset:0 sc1
    buffer_store_dwordx4 v[240:243], v1, s[4:7], s51 offen offset:1024 sc1
    s_add_u32 s51, s77, 98304
    buffer_store_dwordx4 v[240:243], v1, s[4:7], s51 offen offset:0 sc1
    buffer_store_dwordx4 v[240:243], v1, s[4:7], s51 offen offset:1024 sc1
    s_waitcnt vmcnt(4)
    s_mov_b32 s98, 4059165169
    s_mov_b32 s99, 4059165169
    v_subrev_u32 v22, s44, v22
    v_cmp_gt_u32 vcc, 8, v22
    s_nop 0
    s_and_b64 s[100:101], vcc, s[98:99]
    s_cmp_eq_u64 s[100:101], s[98:99]
    s_cbranch_scc1 x_ok_69
    s_lshl_b32 s45, s36, 9
    s_add_u32 s45, s45, 35651584
    s_sub_u32 s48, s36, 1
    s_max_i32 s48, s48, 0
    s_lshl_b32 s46, s48, 9
    s_add_u32 s46, s46, 35651584
    s_mov_b32 s98, 4059165169
    s_mov_b32 s99, 4059165169
    s_mov_b32 s63, 0
poll_70:
    buffer_load_dword v22, v5, s[4:7], s45 offen sc1
    s_waitcnt vmcnt(0)
    v_subrev_u32 v22, s44, v22
    v_cmp_gt_u32 vcc, 8, v22
    s_nop 0
    s_and_b64 s[100:101], vcc, s[98:99]
    s_cmp_eq_u64 s[100:101], s[98:99]
    s_cbranch_scc1 polled_71
    s_add_u32 s63, s63, 1
    s_cmp_lt_u32 s63, 20000
    s_cbranch_scc1 poll_70
    v_mov_b32 v22, 258
    s_mov_b32 s63, 16
    buffer_store_dword v22, off, s[24:27], s63
polled_71:
x_ok_69:
    s_barrier
    s_add_u32 s51, s77, 131072
    buffer_store_dwordx4 v[240:243], v1, s[4:7], s51 offen offset:0 sc1
    buffer_store_dwordx4 v[240:243], v1, s[4:7], s51 offen offset:1024 sc1
    s_add_u32 s51, s77, 163840
    buffer_store_dwordx4 v[240:243], v1, s[4:7], s51 offen offset:0 sc1
    buffer_store_dwordx4 v[240:243], v1, s[4:7], s51 offen offset:1024 sc1
    s_barrier
    s_lshl_b32 s45, s36, 9
    s_add_u32 s45, s45, 35651584
    s_sub_u32 s48, s36, 1
    s_max_i32 s48, s48, 0
    s_lshl_b32 s46, s48, 9
    s_add_u32 s46, s46, 35651584
    buffer_load_dword v22, v5, s[4:7], s45 offen sc1
    s_add_u32 s51, s77, 196608
    buffer_store_dwordx4 v[240:243], v1, s[4:7], s51 offen offset:0 sc1
    buffer_store_dwordx4 v[240:243], v1, s[4:7], s51 offen offset:1024 sc1
    s_add_u32 s51, s77, 229376
    buffer_store_dwordx4 v[240:243], v1, s[4:7], s51 offen offset:0 sc1
    buffer_store_dwordx4 v[240:243], v1, s[4:7], s51 offen offset:1024 sc1
    s_barrier
    s_add_u32 s51, s78, 0
    buffer_store_dwordx4 v[240:243], v1, s[4:7], s51 offen offset:0 sc1
    buffer_store_dwordx4 v[240:243], v1, s[4:7], s51 offen offset:1024 sc1
    buffer_store_dwordx4 v[240:243], v1, s[4:7], s51 offen offset:2048 sc1
    buffer_store_dwordx4 v[240:243], v1, s[4:7], s51 offen offset:3072 sc1
    s_waitcnt vmcnt(8)
    s_mov_b32 s98, 4294967295
    s_mov_b32 s99, 4294967295
    v_subrev_u32 v22, s44, v22
    v_cmp_gt_u32 vcc, 8, v22
    s_nop 0
    s_and_b64 s[100:101], vcc, s[98:99]
    s_cmp_eq_u64 s[100:101], s[98:99]
    s_cbranch_scc1 x_ok_72
    s_lshl_b32 s45, s36, 9
    s_add_u32 s45, s45, 35651584
    s_sub_u32 s48, s36, 1
    s_max_i32 s48, s48, 0
    s_lshl_b32 s46, s48, 9
    s_add_u32 s46, s46, 35651584
    s_mov_b32 s98, 4294967295
    s_mov_b32 s99, 4294967295
    s_mov_b32 s63, 0
poll_73:
    buffer_load_dword v22, v5, s[4:7], s45 offen sc1
    s_waitcnt vmcnt(0)
    v_subrev_u32 v22, s44, v22
    v_cmp_gt_u32 vcc, 8, v22
    s_nop 0
    s_and_b64 s[100:101], vcc, s[98:99]
    s_cmp_eq_u64 s[100:101], s[98:99]
    s_cbranch_scc1 polled_74
    s_add_u32 s63, s63, 1
    s_cmp_lt_u32 s63, 20000
    s_cbranch_scc1 poll_73
    v_mov_b32 v22, 258
    s_mov_b32 s63, 16
    buffer_store_dword v22, off, s[24:27], s63
polled_74:
x_ok_72:
    s_barrier
    s_lshl_b32 s45, s42, 18
    s_lshl_b32 s49, s36, 14
    s_add_u32 s46, s45, s49
    s_add_u32 s46, s46, 33554432
    s_add_u32 s51, s46, 0
    buffer_load_dwordx4 v[32:35], v2, s[4:7], s51 offen offset:0 sc1
    buffer_load_dwordx4 v[48:51], v2, s[4:7], s51 offen offset:256 sc1
    s_add_u32 s51, s46, 4096
    buffer_load_dwordx4 v[36:39], v2, s[4:7], s51 offen offset:0 sc1
    buffer_load_dwordx4 v[52:55], v2, s[4:7], s51 offen offset:256 sc1
    s_barrier
    s_lshl_b32 s45, s42, 18
    s_lshl_b32 s49, s36, 14
    s_add_u32 s46, s45, s49
    s_add_u32 s46, s46, 33554432
    s_add_u32 s51, s46, 8192
    buffer_load_dwordx4 v[40:43], v2, s[4:7], s51 offen offset:0 sc1
    buffer_load_dwordx4 v[56:59], v2, s[4:7], s51 offen offset:256 sc1
    s_add_u32 s51, s46, 12288
    buffer_load_dwordx4 v[44:47], v2, s[4:7], s51 offen offset:0 sc1
    buffer_load_dwordx4 v[60:63], v2, s[4:7], s51 offen offset:256 sc1
    s_barrier
    s_lshl_b32 s45, s42, 18
    s_lshl_b32 s49, s36, 14
    s_add_u32 s46, s45, s49
    s_add_u32 s46, s46, 33554432
    s_add_u32 s51, s46, 0
    buffer_load_dwordx4 v[64:67], v2, s[4:7], s51 offen offset:512 sc1
    buffer_load_dwordx4 v[80:83], v2, s[4:7], s51 offen offset:768 sc1
    s_add_u32 s51, s46, 4096
    buffer_load_dwordx4 v[68:71], v2, s[4:7], s51 offen offset:512 sc1
    buffer_load_dwordx4 v[84:87], v2, s[4:7], s51 offen offset:768 sc1
    s_barrier
    s_waitcnt vmcnt(12)
    v_mov_b32 v20, s44
    s_mov_b64 exec, 1
    buffer_store_dword v20, off, s[4:7], s79 sc1
    s_mov_b64 exec, -1
    s_lshl_b32 s45, s42, 18
    s_lshl_b32 s49, s36, 14
    s_add_u32 s46, s45, s49
    s_add_u32 s46, s46, 33554432
    s_add_u32 s51, s46, 8192
    buffer_load_dwordx4 v[72:75], v2, s[4:7], s51 offen offset:512 sc1
    buffer_load_dwordx4 v[88:91], v2, s[4:7], s51 offen offset:768 sc1
    s_add_u32 s51, s46, 12288
    buffer_load_dwordx4 v[76:79], v2, s[4:7], s51 offen offset:512 sc1
    buffer_load_dwordx4 v[92:95], v2, s[4:7], s51 offen offset:768 sc1
    s_barrier
    s_lshl_b32 s49, s36, 17
    s_max_u32 s49, s49, 131072
    s_sub_u32 s49, s49, 131072
    s_lshl_b32 s45, s37, 13
    s_add_u32 s45, s45, s49
    s_add_u32 s45, s45, 62914560
    v_lshlrev_b32 v20, 7, v9
    buffer_load_dword v31, v20, s[4:7], s45 offen sc1
    s_barrier
    s_barrier
    s_waitcnt vmcnt(10)
    v_add_f32 v32, v32, v36
    v_add_f32 v33, v33, v37
    v_add_f32 v34, v34, v38
    v_add_f32 v35, v35, v39
    v_add_f32 v48, v48, v52
    v_add_f32 v49, v49, v53
    v_add_f32 v50, v50, v54
    v_add_f32 v51, v51, v55
    v_add_f32 v32, v32, v40
    v_add_f32 v33, v33, v41
    v_add_f32 v34, v34, v42
    v_add_f32 v35, v35, v43
    v_add_f32 v48, v48, v56
    v_add_f32 v49, v49, v57
    v_add_f32 v50, v50, v58
    v_add_f32 v51, v51, v59
    v_add_f32 v32, v32, v44
    v_add_f32 v33, v33, v45
    v_add_f32 v34, v34, v46
    v_add_f32 v35, v35, v47
    v_add_f32 v48, v48, v60
    v_add_f32 v49, v49, v61
    v_add_f32 v50, v50, v62
    v_add_f32 v51, v51, v63
    s_barrier
    s_waitcnt vmcnt(1)
    v_add_f32 v64, v64, v68
    v_add_f32 v65, v65, v69
    v_add_f32 v66, v66, v70
    v_add_f32 v67, v67, v71
    v_add_f32 v80, v80, v84
    v_add_f32 v81, v81, v85
    v_add_f32 v82, v82, v86
    v_add_f32 v83, v83, v87
    v_add_f32 v64, v64, v72
    v_add_f32 v65, v65, v73
    v_add_f32 v66, v66, v74
    v_add_f32 v67, v67, v75
    v_add_f32 v80, v80, v88
    v_add_f32 v81, v81, v89
    v_add_f32 v82, v82, v90
    v_add_f32 v83, v83, v91
    v_add_f32 v64, v64, v76
    v_add_f32 v65, v65, v77
    v_add_f32 v66, v66, v78
    v_add_f32 v67, v67, v79
    v_add_f32 v80, v80, v92
    v_add_f32 v81, v81, v93
    v_add_f32 v82, v82, v94
    v_add_f32 v83, v83, v95
    s_barrier
    v_permlane32_swap_b32 v32, v64
    v_permlane32_swap_b32 v33, v65
    v_permlane32_swap_b32 v34, v66
    v_permlane32_swap_b32 v35, v67
    v_permlane32_swap_b32 v48, v80
    v_permlane32_swap_b32 v49, v81
    v_permlane32_swap_b32 v50, v82
    v_permlane32_swap_b32 v51, v83
    v_add_f32 v32, v32, v64
    v_add_f32 v33, v33, v65
    v_add_f32 v34, v34, v66
    v_add_f32 v35, v35, v67
    v_add_f32 v48, v48, v80
    v_add_f32 v49, v49, v81
    v_add_f32 v50, v50, v82
    v_add_f32 v51, v51, v83
    v_permlane16_swap_b32 v32, v48
    v_permlane16_swap_b32 v33, v49
    v_permlane16_swap_b32 v34, v50
    v_permlane16_swap_b32 v35, v51
    v_add_f32 v32, v32, v48
    v_add_f32 v33, v33, v49
    v_add_f32 v34, v34, v50
    v_add_f32 v35, v35, v51
    s_barrier
    s_mov_b32 s45, 0x3a800000
    v_mul_f32 v32, s45, v32
    v_mul_f32 v34, s45, v34
    v_mul_f32 v33, s45, v33
    v_mul_f32 v35, s45, v35
    v_fma_f32 v33, -v32, v32, v33
    v_fma_f32 v35, -v34, v34, v35
    v_max_f32 v33, 0, v33
    v_max_f32 v35, 0, v35
    v_add_f32 v33, 0x3727c5ac, v33
    v_add_f32 v35, 0x3727c5ac, v35
    v_rsq_f32 v36, v33
    v_rsq_f32 v37, v35
    v_sub_f32 v38, 0, v32
    v_sub_f32 v39, 0, v34
    ds_write_b64 v26, v[38:39]
    ds_write_b64 v26, v[36:37] offset:1024
    s_waitcnt lgkmcnt(0)
    s_mov_b32 s45, 35676160
    buffer_load_dword v30, v29, s[4:7], s45 offen sc1
    s_barrier
    s_barrier
    s_waitcnt vmcnt(0)
    v_subrev_u32 v30, s44, v30
    v_cmp_gt_u32 vcc, 8, v30
    s_nop 0
    s_cmp_eq_u64 vcc, -1
    s_cbranch_scc1 cl_ok_75
    s_mov_b32 s45, 35676160
    s_mov_b32 s63, 0
poll_76:
    buffer_load_dword v30, v29, s[4:7], s45 offen sc1
    s_waitcnt vmcnt(0)
    v_subrev_u32 v30, s44, v30
    v_cmp_gt_u32 vcc, 8, v30
    s_nop 0
    s_cmp_eq_u64 vcc, -1
    s_cbranch_scc1 polled_77
    s_add_u32 s63, s63, 1
    s_cmp_lt_u32 s63, 20000
    s_cbranch_scc1 poll_76
    v_mov_b32 v30, 784
    s_mov_b32 s63, 16
    buffer_store_dword v30, off, s[24:27], s63
polled_77:
cl_ok_75:
    s_barrier
    s_add_u32 s42, s42, 1
    s_add_u32 s44, s44, 1
    s_barrier
    s_barrier
    s_barrier
    s_lshl_b32 s45, s36, 18
    s_lshl_b32 s49, s37, 11
    s_add_u32 s77, s45, s49
    s_add_u32 s77, s77, 29360128
    s_and_b32 s49, s37, 12
    s_lshr_b32 s49, 30292, s49
    s_and_b32 s49, s49, 15
    s_lshl_b32 s49, s49, 14
    s_add_u32 s78, s45, s49
    s_and_b32 s49, s37, 3
    s_lshl_b32 s49, s49, 12
    s_add_u32 s78, s78, s49
    s_add_u32 s78, s78, 16777216
    s_add_u32 s51, s77, 0
    buffer_store_dwordx4 v[240:243], v1, s[4:7], s51 offen offset:0 sc1
    buffer_store_dwordx4 v[240:243], v1, s[4:7], s51 offen offset:1024 sc1
    s_add_u32 s51, s77, 32768
    buffer_store_dwordx4 v[240:243], v1, s[4:7], s51 offen offset:0 sc1
    buffer_store_dwordx4 v[240:243], v1, s[4:7], s51 offen offset:1024 sc1
    s_barrier
    s_lshl_b32 s45, s36, 9
    s_add_u32 s45, s45, 35651584
    s_sub_u32 s48, s36, 1
    s_max_i32 s48, s48, 0
    s_lshl_b32 s46, s48, 9
    s_add_u32 s46, s46, 35651584
    buffer_load_dword v22, v5, s[4:7], s45 offen sc1
    s_add_u32 s51, s77, 65536
    buffer_store_dwordx4 v[240:243], v1, s[4:7], s51 offen offset:0 sc1
    buffer_store_dwordx4 v[240:243], v1, s[4:7], s51 offen offset:1024 sc1
    s_add_u32 s51, s77, 98304
    buffer_store_dwordx4 v[240:243], v1, s[4:7], s51 offen offset:0 sc1
    buffer_store_dwordx4 v[240:243], v1, s[4:7], s51 offen offset:1024 sc1
    s_waitcnt vmcnt(4)
    s_mov_b32 s98, 4059165169
    s_mov_b32 s99, 4059165169
    v_subrev_u32 v22, s44, v22
    v_cmp_gt_u32 vcc, 8, v22
    s_nop 0
    s_and_b64 s[100:101], vcc, s[98:99]
    s_cmp_eq_u64 s[100:101], s[98:99]
    s_cbranch_scc1 x_ok_78
    s_lshl_b32 s45, s36, 9
    s_add_u32 s45, s45, 35651584
    s_sub_u32 s48, s36, 1
    s_max_i32 s48, s48, 0
    s_lshl_b32 s46, s48, 9
    s_add_u32 s46, s46, 35651584
    s_mov_b32 s98, 4059165169
    s_mov_b32 s99, 4059165169
    s_mov_b32 s63, 0
poll_79:
    buffer_load_dword v22, v5, s[4:7], s45 offen sc1
    s_waitcnt vmcnt(0)
    v_subrev_u32 v22, s44, v22
    v_cmp_gt_u32 vcc, 8, v22
    s_nop 0
    s_and_b64 s[100:101], vcc, s[98:99]
    s_cmp_eq_u64 s[100:101], s[98:99]
    s_cbranch_scc1 polled_80
    s_add_u32 s63, s63, 1
    s_cmp_lt_u32 s63, 20000
    s_cbranch_scc1 poll_79
    v_mov_b32 v22, 258
    s_mov_b32 s63, 16
    buffer_store_dword v22, off, s[24:27], s63
polled_80:
x_ok_78:
    s_barrier
    s_add_u32 s51, s77, 131072
    buffer_store_dwordx4 v[240:243], v1, s[4:7], s51 offen offset:0 sc1
    buffer_store_dwordx4 v[240:243], v1, s[4:7], s51 offen offset:1024 sc1
    s_add_u32 s51, s77, 163840
    buffer_store_dwordx4 v[240:243], v1, s[4:7], s51 offen offset:0 sc1
    buffer_store_dwordx4 v[240:243], v1, s[4:7], s51 offen offset:1024 sc1
    s_barrier
    s_lshl_b32 s45, s36, 9
    s_add_u32 s45, s45, 35651584
    s_sub_u32 s48, s36, 1
    s_max_i32 s48, s48, 0
    s_lshl_b32 s46, s48, 9
    s_add_u32 s46, s46, 35651584
    buffer_load_dword v22, v5, s[4:7], s45 offen sc1
    s_add_u32 s51, s77, 196608
    buffer_store_dwordx4 v[240:243], v1, s[4:7], s51 offen offset:0 sc1
    buffer_store_dwordx4 v[240:243], v1, s[4:7], s51 offen offset:1024 sc1
    s_add_u32 s51, s77, 229376
    buffer_store_dwordx4 v[240:243], v1, s[4:7], s51 offen offset:0 sc1
    buffer_store_dwordx4 v[240:243], v1, s[4:7], s51 offen offset:1024 sc1
    s_barrier
    s_waitcnt vmcnt(4)
    s_mov_b32 s98, 4294967295
    s_mov_b32 s99, 4294967295
    v_subrev_u32 v22, s44, v22
    v_cmp_gt_u32 vcc, 8, v22
    s_nop 0
    s_and_b64 s[100:101], vcc, s[98:99]
    s_cmp_eq_u64 s[100:101], s[98:99]
    s_cbranch_scc1 x_ok_81
    s_lshl_b32 s45, s36, 9
    s_add_u32 s45, s45, 35651584
    s_sub_u32 s48, s36, 1
    s_max_i32 s48, s48, 0
    s_lshl_b32 s46, s48, 9
    s_add_u32 s46, s46, 35651584
    s_mov_b32 s98, 4294967295
    s_mov_b32 s99, 4294967295
    s_mov_b32 s63, 0
poll_82:
    buffer_load_dword v22, v5, s[4:7], s45 offen sc1
    s_waitcnt vmcnt(0)
    v_subrev_u32 v22, s44, v22
    v_cmp_gt_u32 vcc, 8, v22
    s_nop 0
    s_and_b64 s[100:101], vcc, s[98:99]
    s_cmp_eq_u64 s[100:101], s[98:99]
    s_cbranch_scc1 polled_83
    s_add_u32 s63, s63, 1
    s_cmp_lt_u32 s63, 20000
    s_cbranch_scc1 poll_82
    v_mov_b32 v22, 258
    s_mov_b32 s63, 16
    buffer_store_dword v22, off, s[24:27], s63
polled_83:
x_ok_81:
    s_barrier
    s_lshl_b32 s45, s42, 18
    s_lshl_b32 s49, s36, 14
    s_add_u32 s46, s45, s49
    s_add_u32 s46, s46, 33554432
    s_add_u32 s51, s46, 0
    buffer_load_dwordx4 v[32:35], v2, s[4:7], s51 offen offset:0 sc1
    buffer_load_dwordx4 v[48:51], v2, s[4:7], s51 offen offset:256 sc1
    s_add_u32 s51, s46, 4096
    buffer_load_dwordx4 v[36:39], v2, s[4:7], s51 offen offset:0 sc1
    buffer_load_dwordx4 v[52:55], v2, s[4:7], s51 offen offset:256 sc1
    s_barrier
    s_lshl_b32 s45, s42, 18
    s_lshl_b32 s49, s36, 14
    s_add_u32 s46, s45, s49
    s_add_u32 s46, s46, 33554432
    s_add_u32 s51, s46, 8192
    buffer_load_dwordx4 v[40:43], v2, s[4:7], s51 offen offset:0 sc1
    buffer_load_dwordx4 v[56:59], v2, s[4:7], s51 offen offset:256 sc1
    s_add_u32 s51, s46, 12288
    buffer_load_dwordx4 v[44:47], v2, s[4:7], s51 offen offset:0 sc1
    buffer_load_dwordx4 v[60:63], v2, s[4:7], s51 offen offset:256 sc1
    s_barrier
    s_lshl_b32 s45, s42, 18
    s_lshl_b32 s49, s36, 14
    s_add_u32 s46, s45, s49
    s_add_u32 s46, s46, 33554432
    s_add_u32 s51, s46, 0
    buffer_load_dwordx4 v[64:67], v2, s[4:7], s51 offen offset:512 sc1
    buffer_load_dwordx4 v[80:83], v2, s[4:7], s51 offen offset:768 sc1
    s_add_u32 s51, s46, 4096
    buffer_load_dwordx4 v[68:71], v2, s[4:7], s51 offen offset:512 sc1
    buffer_load_dwordx4 v[84:87], v2, s[4:7], s51 offen offset:768 sc1
    s_barrier
    s_waitcnt vmcnt(12)
    v_mov_b32 v20, s44
    s_mov_b64 exec, 1
    buffer_store_dword v20, off, s[4:7], s79 sc1
    s_mov_b64 exec, -1
    s_lshl_b32 s45, s42, 18
    s_lshl_b32 s49, s36, 14
    s_add_u32 s46, s45, s49
    s_add_u32 s46, s46, 33554432
    s_add_u32 s51, s46, 8192
    buffer_load_dwordx4 v[72:75], v2, s[4:7], s51 offen offset:512 sc1
    buffer_load_dwordx4 v[88:91], v2, s[4:7], s51 offen offset:768 sc1
    s_add_u32 s51, s46, 12288
    buffer_load_dwordx4 v[76:79], v2, s[4:7], s51 offen offset:512 sc1
    buffer_load_dwordx4 v[92:95], v2, s[4:7], s51 offen offset:768 sc1
    s_barrier
    s_lshl_b32 s49, s36, 17
    s_max_u32 s49, s49, 131072
    s_sub_u32 s49, s49, 131072
    s_lshl_b32 s45, s37, 13
    s_add_u32 s45, s45, s49
    s_add_u32 s45, s45, 65011712
    v_lshlrev_b32 v20, 7, v9
    buffer_load_dword v31, v20, s[4:7], s45 offen sc1
    s_barrier
    s_barrier
    s_waitcnt vmcnt(10)
    v_add_f32 v32, v32, v36
    v_add_f32 v33, v33, v37
    v_add_f32 v34, v34, v38
    v_add_f32 v35, v35, v39
    v_add_f32 v48, v48, v52
    v_add_f32 v49, v49, v53
    v_add_f32 v50, v50, v54
    v_add_f32 v51, v51, v55
    v_add_f32 v32, v32, v40
    v_add_f32 v33, v33, v41
    v_add_f32 v34, v34, v42
    v_add_f32 v35, v35, v43
    v_add_f32 v48, v48, v56
    v_add_f32 v49, v49, v57
    v_add_f32 v50, v50, v58
    v_add_f32 v51, v51, v59
    v_add_f32 v32, v32, v44
    v_add_f32 v33, v33, v45
    v_add_f32 v34, v34, v46
    v_add_f32 v35, v35, v47
    v_add_f32 v48, v48, v60
    v_add_f32 v49, v49, v61
    v_add_f32 v50, v50, v62
    v_add_f32 v51, v51, v63
    s_barrier
    s_waitcnt vmcnt(1)
    v_add_f32 v64, v64, v68
    v_add_f32 v65, v65, v69
    v_add_f32 v66, v66, v70
    v_add_f32 v67, v67, v71
    v_add_f32 v80, v80, v84
    v_add_f32 v81, v81, v85
    v_add_f32 v82, v82, v86
    v_add_f32 v83, v83, v87
    v_add_f32 v64, v64, v72
    v_add_f32 v65, v65, v73
    v_add_f32 v66, v66, v74
    v_add_f32 v67, v67, v75
    v_add_f32 v80, v80, v88
    v_add_f32 v81, v81, v89
    v_add_f32 v82, v82, v90
    v_add_f32 v83, v83, v91
    v_add_f32 v64, v64, v76
    v_add_f32 v65, v65, v77
    v_add_f32 v66, v66, v78
    v_add_f32 v67, v67, v79
    v_add_f32 v80, v80, v92
    v_add_f32 v81, v81, v93
    v_add_f32 v82, v82, v94
    v_add_f32 v83, v83, v95
    s_barrier
    v_permlane32_swap_b32 v32, v64
    v_permlane32_swap_b32 v33, v65
    v_permlane32_swap_b32 v34, v66
    v_permlane32_swap_b32 v35, v67
    v_permlane32_swap_b32 v48, v80
    v_permlane32_swap_b32 v49, v81
    v_permlane32_swap_b32 v50, v82
    v_permlane32_swap_b32 v51, v83
    v_add_f32 v32, v32, v64
    v_add_f32 v33, v33, v65
    v_add_f32 v34, v34, v66
    v_add_f32 v35, v35, v67
    v_add_f32 v48, v48, v80
    v_add_f32 v49, v49, v81
    v_add_f32 v50, v50, v82
    v_add_f32 v51, v51, v83
    v_permlane16_swap_b32 v32, v48
    v_permlane16_swap_b32 v33, v49
    v_permlane16_swap_b32 v34, v50
    v_permlane16_swap_b32 v35, v51
    v_add_f32 v32, v32, v48
    v_add_f32 v33, v33, v49
    v_add_f32 v34, v34, v50
    v_add_f32 v35, v35, v51
    s_barrier
    s_mov_b32 s45, 0x3a800000
    v_mul_f32 v32, s45, v32
    v_mul_f32 v34, s45, v34
    v_mul_f32 v33, s45, v33
    v_mul_f32 v35, s45, v35
    v_fma_f32 v33, -v32, v32, v33
    v_fma_f32 v35, -v34, v34, v35
    v_max_f32 v33, 0, v33
    v_max_f32 v35, 0, v35
    v_add_f32 v33, 0x3727c5ac, v33
    v_add_f32 v35, 0x3727c5ac, v35
    v_rsq_f32 v36, v33
    v_rsq_f32 v37, v35
    v_sub_f32 v38, 0, v32
    v_sub_f32 v39, 0, v34
    ds_write_b64 v26, v[38:39]
    ds_write_b64 v26, v[36:37] offset:1024
    s_waitcnt lgkmcnt(0)
    s_mov_b32 s45, 35676160
    buffer_load_dword v30, v29, s[4:7], s45 offen sc1
    s_barrier
    s_barrier
    s_waitcnt vmcnt(0)
    v_subrev_u32 v30, s44, v30
    v_cmp_gt_u32 vcc, 8, v30
    s_nop 0
    s_cmp_eq_u64 vcc, -1
    s_cbranch_scc1 cl_ok_84
    s_mov_b32 s45, 35676160
    s_mov_b32 s63, 0
poll_85:
    buffer_load_dword v30, v29, s[4:7], s45 offen sc1
    s_waitcnt vmcnt(0)
    v_subrev_u32 v30, s44, v30
    v_cmp_gt_u32 vcc, 8, v30
    s_nop 0
    s_cmp_eq_u64 vcc, -1
    s_cbranch_scc1 polled_86
    s_add_u32 s63, s63, 1
    s_cmp_lt_u32 s63, 20000
    s_cbranch_scc1 poll_85
    v_mov_b32 v30, 784
    s_mov_b32 s63, 16
    buffer_store_dword v30, off, s[24:27], s63
polled_86:
cl_ok_84:
    s_barrier
    s_endpgm
k_done:
    s_endpgm
.section .rodata,"a"
.p2align 6
.amdhsa_kernel interleave_layers__sliding_local_dilated__sliding_local_dilated__prompt_kernel
  .amdhsa_next_free_vgpr 256
  .amdhsa_next_free_sgpr 102
  .amdhsa_accum_offset 256
  .amdhsa_group_segment_fixed_size 0
  .amdhsa_kernarg_size 72
  .amdhsa_float_denorm_mode_32 3
  .amdhsa_user_sgpr_count 2
  .amdhsa_user_sgpr_kernarg_segment_ptr 1
  .amdhsa_system_sgpr_workgroup_id_x 1
.end_amdhsa_kernel
```
